```python
import torch

def _softmax(x, axis=-1):
    return torch.softmax(x, dim=axis)

def _gelu(x):
    return torch.nn.functional.gelu(x, approximate='tanh')

def _silu(x):
    return torch.nn.functional.silu(x)

def _sigmoid(x):
    return torch.sigmoid(x)

def _layernorm(x, axis=-1, eps=1e-05):
    m = x.mean(dim=axis, keepdim=True)
    v = x.var(dim=axis, keepdim=True, unbiased=False)
    return (x - m) / torch.sqrt(v + eps)

def _scatter_add(tgt, idx, src, axis=0):
    return tgt.clone().index_add_(axis, idx, src)

def _segment_sum(src, seg, n):
    out = torch.zeros((n,) + src.shape[1:], dtype=src.dtype)
    return out.index_add_(0, seg, src)

def _pad(x, pw):
    flat = tuple((v for pair in reversed(pw) for v in pair))
    return torch.nn.functional.pad(x, flat)
kernel_name = 'adaLN_cond__linear_kernel_hedgehog__mixer_gmlp__prompt'

def setup_inputs():

    _w = lambda a: (lambda t: t.to(torch.bfloat16) if t.is_floating_point() else t)(torch.as_tensor(a))

    def _A_setup():
        B, S, D, H = (1, 2048, 448, 16)
        Dh = D // H
        return {'x': _w((lambda *s: torch.randn(*s, dtype=torch.bfloat16) * 0.05)(B, S, D)), 'wqkv': _w((lambda *s: torch.randn(*s, dtype=torch.bfloat16) * 0.4)(D, 3 * D)), 'w_phi': _w((lambda *s: torch.randn(*s, dtype=torch.bfloat16) * 0.4)(H, Dh, Dh) * Dh ** (-0.5)), 'wo': _w((lambda *s: torch.randn(*s, dtype=torch.bfloat16) * 0.1)(D, D))}
    _A_in = _A_setup()

    def _B_setup():
        B, S, D, F = (1, 2048, 448, 1792)
        Fh = F // 2
        return {'x': _w((lambda *s: torch.randn(*s, dtype=torch.bfloat16) * 0.05)(B, S, D)), 'w_in': _w((lambda *s: torch.randn(*s, dtype=torch.bfloat16) * 0.4)(D, 2 * Fh)), 'w_sp': _w(0.01 * (lambda *s: torch.randn(*s, dtype=torch.bfloat16) * 0.4)(S, S)), 'b_sp': _w(1.0 + 0.01 * (lambda *s: torch.randn(*s, dtype=torch.bfloat16) * 0.05)(S)), 'w_out': _w((lambda *s: torch.randn(*s, dtype=torch.bfloat16) * 0.05)(Fh, D))}
    _B_in = _B_setup()
    return {'A_x': _A_in['x'], 'A_wqkv': _A_in['wqkv'], 'A_w_phi': _A_in['w_phi'], 'A_wo': _A_in['wo'], 'B_x': _B_in['x'], 'B_w_in': _B_in['w_in'], 'B_w_sp': _B_in['w_sp'], 'B_b_sp': _B_in['b_sp'], 'B_w_out': _B_in['w_out'], 'c': _w((lambda *s: torch.randn(*s, dtype=torch.bfloat16) * 0.2)(1, 448) * 8.0), 'w_mod': _w((lambda *s: torch.randn(*s, dtype=torch.bfloat16) * 0.2)(448, 6 * 448) * 448 ** (-0.5) * 8.0)}

def reference(A_x, A_wqkv, A_w_phi, A_wo, B_x, B_w_in, B_w_sp, B_b_sp, B_w_out, c, w_mod):

    def _A_ref(x, wqkv, w_phi, wo):
        B, S, D = x.shape
        H = 16
        Dh = D // H
        qkv = (lambda x, *d: x.permute(*d))((x @ wqkv).reshape(B, S, 3, H, Dh), 2, 0, 3, 1, 4)
        q, k, v = (qkv[0], qkv[1], qkv[2])
        pq = torch.einsum('bhsd,hdf->bhsf', q, w_phi)
        pk = torch.einsum('bhsd,hdf->bhsf', k, w_phi)
        phi_q = torch.concatenate([_softmax(pq, axis=-1), _softmax(-pq, axis=-1)], axis=-1)
        phi_k = torch.concatenate([_softmax(pk, axis=-1), _softmax(-pk, axis=-1)], axis=-1)
        kv = torch.einsum('bhsf,bhsd->bhfd', phi_k, v)
        z = torch.einsum('bhsf->bhf', phi_k)
        num = torch.einsum('bhqf,bhfd->bhqd', phi_q, kv)
        den = torch.einsum('bhqf,bhf->bhq', phi_q, z)[..., None] + 1e-06
        o = num / den
        return (lambda x, *d: x.permute(*d))(o, 0, 2, 1, 3).reshape(B, S, D) @ wo

    def _B_ref(x, w_in, w_sp, b_sp, w_out):
        B, S, D = x.shape
        F = w_in.shape[-1]
        Fh = F // 2
        z = _gelu(torch.einsum('bsd,df->bsf', x, w_in))
        z1 = z[..., :Fh].clone()
        z2 = _layernorm(z[..., Fh:], axis=-1)
        g = torch.einsum('ts,bsf->btf', w_sp, z2) + b_sp[None, :, None]
        return torch.einsum('bsf,fd->bsd', z1 * g, w_out)
    x = A_x
    mod = (_silu(c) @ w_mod).reshape(c.shape[0], 6, 1, -1)
    sa, ca, ga, sb, cb, gb = (mod[:, 0].clone(), mod[:, 1].clone(), mod[:, 2].clone(), mod[:, 3].clone(), mod[:, 4].clone(), mod[:, 5].clone())
    h = _layernorm(x, axis=-1) * (1 + ca) + sa
    x = x + ga * _A_ref(h, A_wqkv, A_w_phi, A_wo)
    h = _layernorm(x, axis=-1) * (1 + cb) + sb
    x = x + gb * _B_ref(h, B_w_in, B_w_sp, B_b_sp, B_w_out)
    return x
```

```asm
; @launch grid=(256,1,1) block=(256,1,1) lds=163840
.amdgcn_target "amdgcn-amd-amdhsa--gfx950"
.text
.globl adaLN_cond__linear_kernel_hedgehog__mixer_gmlp__prompt_kernel
.p2align 8
.type adaLN_cond__linear_kernel_hedgehog__mixer_gmlp__prompt_kernel,@function
adaLN_cond__linear_kernel_hedgehog__mixer_gmlp__prompt_kernel:
    s_cmp_ge_u32 s2, 256
    s_cbranch_scc1 L_EXIT
    s_load_dwordx4 s[4:7], s[0:1], 0
    s_load_dwordx4 s[36:39], s[0:1], 72
    s_load_dwordx2 s[48:49], s[0:1], 104
    s_getpc_b64 s[62:63]
L_PC:
    s_lshr_b32 s54, s2, 3
    s_mul_i32 s60, s54, 12
    v_min_u32_e64 v4, 11, v0
    v_add_lshl_u32 v4, v4, s60, 7
    v_min_u32 v4, L_CODE_END-L_PC-4, v4
    global_load_dword v5, v4, s[62:63]
    v_lshrrev_b32 v1, 6, v0
    v_and_b32 v0, 63, v0
    v_readfirstlane_b32 s52, v1
    s_and_b32 s53, s2, 7
    s_lshr_b32 s60, s2, 6
    s_lshl2_add_u32 s57, s53, s60
    s_lshr_b32 s55, s57, 1
    s_and_b32 s58, s54, 7
    s_mov_b32 s43, 0x20000
    s_mov_b32 s42, 2408448
    s_mov_b32 s11, s43
    s_and_b32 s64, s57, 1
    s_lshl2_add_u32 s65, s64, s52
    s_mul_i32 s65, s65, 7
    s_movk_i32 s63, 5376
    v_lshrrev_b32 v4, 3, v0
    v_mul_u32_u24 v6, s63, v4
    s_cmp_eq_u32 s58, 7
    s_cselect_b32 s60, 0, s58
    s_add_u32 s65, s65, s60
    s_mulk_i32 s65, 336
    s_add_u32 s65, s65, s55
    s_lshl_b32 s65, s65, 7
    s_cmp_eq_u32 s58, 7
    s_cbranch_scc0 L_R1
    v_xor_b32 v2, v4, v0
    v_and_b32 v2, 6, v2
    v_and_b32 v4, 1, v0
    v_add_u32_e64 v2, v2, v4
    v_lshl_add_u32 v4, v2, 4, v6
    v_lshlrev_b32_e64 v10, 2, v0
    s_mul_i32 m0, s52, 7168
    s_add_u32 m0, m0, 116736
    s_mov_b32 s60, 41984
    s_lshl_b32 s61, s52, 8
    s_waitcnt lgkmcnt(0)
    s_mov_b64 s[40:41], s[38:39]
    s_movk_i32 s38, 896
    s_mov_b32 s39, s43
    buffer_load_dword v24, v10, s[36:39], s61 offen
    buffer_load_dwordx4 v4, s[40:43], s65 offen offset:0 lds
    s_add_u32 s65, s65, s60
    buffer_load_dwordx4 v4, s[40:43], s65 offen offset:1024 lds
    s_add_u32 s65, s65, s60
    buffer_load_dwordx4 v4, s[40:43], s65 offen offset:2048 lds
    s_add_u32 s65, s65, s60
    buffer_load_dwordx4 v4, s[40:43], s65 offen offset:3072 lds
    s_add_u32 s65, s65, s60
    s_addk_i32 m0, 4096
    s_addk_i32 s65, 4096
    buffer_load_dwordx4 v4, s[40:43], s65 offen offset:0 lds
    s_add_u32 s65, s65, s60
    buffer_load_dwordx4 v4, s[40:43], s65 offen offset:1024 lds
    s_add_u32 s65, s65, s60
    buffer_load_dwordx4 v4, s[40:43], s65 offen offset:2048 lds
    s_branch L_G0
L_R1:
    s_bitcmp0_b32 s58, 0
    s_cbranch_scc1 L_R2
    s_and_b32 s73, s57, -4
    s_add_u32 s73, s73, s52
    s_mul_i32 s61, s73, 48
    s_lshr_b32 s62, s58, 1
    s_add_u32 s61, s61, s62
    s_and_b32 s62, s57, 3
    s_lshl2_add_u32 s61, s61, s62
    s_mulk_i32 s61, 224
    s_lshr_b32 s63, s63, 1
    v_lshrrev_b32 v4, 4, v0
    v_mul_u32_u24 v4, s63, v4
    v_and_b32 v2, 15, v0
    v_min_u32_e64 v2, 13, v2
    v_lshl_add_u32 v4, v2, 4, v4
    s_lshl_b32 m0, s52, 12
    s_add_u32 m0, m0, 116736
    s_lshr_b32 s10, s42, 1
    s_waitcnt lgkmcnt(0)
    s_mov_b64 s[8:9], s[6:7]
    buffer_load_dwordx4 v4, s[8:11], s61 offen offset:0 lds
    s_addk_i32 s61, 9728
    buffer_load_dwordx4 v4, s[8:11], s61 offen offset:1024 lds
    s_addk_i32 s61, 9728
    buffer_load_dwordx4 v4, s[8:11], s61 offen offset:2048 lds
    s_addk_i32 s61, 9728
    buffer_load_dwordx4 v4, s[8:11], s61 offen offset:3072 lds
L_R2:
    s_waitcnt lgkmcnt(0)
    s_mov_b64 s[40:41], s[38:39]
    buffer_load_dword v5, v6, s[40:43], s65 offen
L_G0:
    s_load_dword s59, s[48:49], 0
    s_and_b32 s71, s54, 15
    s_lshr_b32 s72, s71, 1
    s_mov_b32 s6, 1835008
    s_mov_b32 s7, s43
    s_bitcmp0_b32 s58, 0
    s_cselect_b64 vcc, 1, 0
    s_cbranch_scc0 L_XD
    s_lshl3_add_u32 s61, s55, s72
    s_lshl2_add_u32 s61, s61, s52
    s_mulk_i32 s61, 3584
    s_addk_i32 s61, 2688
    s_mul_i32 m0, s52, 4224
    s_add_u32 m0, m0, 119904
    v_min_u32 v4, 55, v0
    v_lshlrev_b32_e64 v4, 4, v4
    buffer_load_dwordx4 v4, s[4:7], s61 offen lds
    s_addk_i32 m0, -1056
    s_addk_i32 s61, -896
    buffer_load_dwordx4 v4, s[4:7], s61 offen lds
    s_addk_i32 m0, -1056
    s_addk_i32 s61, -896
    buffer_load_dwordx4 v4, s[4:7], s61 offen lds
    s_addk_i32 m0, -1056
    s_addk_i32 s61, -896
    buffer_load_dwordx4 v4, s[4:7], s61 offen lds
L_XD:
    s_load_dwordx2 s[12:13], s[0:1], 16
    s_load_dwordx2 s[28:29], s[0:1], 56
    s_load_dwordx2 s[16:17], s[0:1], 24
    s_load_dwordx2 s[20:21], s[0:1], 40
    s_load_dwordx2 s[24:25], s[0:1], 48
    s_load_dwordx2 s[32:33], s[0:1], 64
    s_load_dwordx2 s[44:45], s[0:1], 88
    v_lshlrev_b32 v7, 4, v0
    s_mov_b32 s39, s43
    s_mov_b32 s65, s55
    s_mov_b32 s56, s71
    s_lshr_b32 s63, s58, 1
    s_and_b32 s73, s57, -4
    s_add_u32 s73, s73, s52
    s_mul_i32 s60, s63, 7
    s_lshr_b32 s74, s73, 2
    s_add_u32 s74, s74, s60
    s_lshl1_add_u32 s60, s73, s63
    s_add_u32 s60, s60, 27
    s_cmp_eq_u32 s63, 0
    s_cselect_b32 s73, s73, s60
    s_mul_i32 s73, s73, 896
    s_and_b32 s62, s57, 3
    s_mul_i32 s60, s62, 301056
    s_add_u32 s73, s73, s60
    s_add_u32 s73, s73, 524288
    s_lshl_b32 s62, s62, 5
    s_add_u32 s74, s74, s62
    s_lshl_b32 s74, s74, 7
    s_add_u32 s74, s74, 65536
    s_cmp_eq_u32 s58, 7
    s_cselect_b32 s63, 28, s57
    s_cmp_lt_u32 s63, 28
    s_cselect_b32 s73, s73, 33554432
    s_cselect_b32 s74, s74, 33554432
    s_lshl_b32 s67, s52, 13
    s_mov_b32 s50, 33554432
    s_mov_b32 s51, s43
    s_mov_b32 s14, 25088
    s_mov_b32 s15, s43
    s_mov_b32 s30, 4096
    s_mov_b32 s31, s43
    s_mov_b32 s18, 401408
    s_mov_b32 s19, s43
    s_mov_b32 s22, 1605632
    s_mov_b32 s23, s43
    s_mov_b32 s26, 8388608
    s_mov_b32 s27, s43
    s_mov_b32 s34, 802816
    s_mov_b32 s35, s43
    s_mov_b32 s46, 1835008
    s_mov_b32 s47, s43
    v_and_b32 v3, 3, v0
    s_lshl_b32 s60, s52, 3
    s_add_u32 s60, s60, s53
    s_lshl_b32 s60, s60, 9
    s_add_u32 s60, s60, 16384
    v_lshl_add_u32 v4, v3, 7, s60
    s_lshl2_add_u32 s60, s57, s52
    s_lshl_b32 s60, s60, 8
    s_add_u32 s60, s60, s58
    s_lshl_b32 s60, s60, 7
    s_add_u32 s60, s60, 2127872
    v_writelane_b32 v4, s60, 4
    s_cmp_eq_u32 s58, 7
    s_cselect_b32 s60, s50, 0
    buffer_load_dword v5, v4, s[48:51], s60 offen sc1
    s_lshr_b32 s60, s71, 3
    s_sub_u32 s71, s71, s60
    s_add_u32 s67, s67, 131072
    s_mov_b32 s68, 0
    s_mov_b32 s69, -1
    s_mov_b32 s70, 0xffff0000
    s_getreg_b32 s87, hwreg(HW_REG_XCC_ID, 0, 4)
    s_mul_i32 s82, s56, 75264
    s_mul_i32 s93, s52, 6144
    s_add_u32 s83, s82, s93
    s_waitcnt lgkmcnt(0)
    s_add_u32 s59, s59, 2
    s_cmp_eq_u32 s52, 0
    s_cbranch_scc0 L_XP1
    s_lshl_b32 s60, s53, 5
    s_add_u32 s60, s60, s54
    s_lshl_b32 s60, s60, 3
    s_add_u32 s60, s60, 32768
    v_mov_b32_e64 v240, s87
    v_mov_b32 v241, s59
    s_mov_b64 exec, 1
    buffer_store_dwordx2 v[240:241], off, s[48:51], s60 sc1
    s_mov_b64 exec, -1
L_XP1:
    s_cmp_eq_u32 s58, 7
    s_cbranch_scc1 L_SP0
    s_mul_i32 s60, s56, 1568
    s_lshl_b32 s61, s52, 9
    s_add_u32 m0, s61, 146432
    v_add_u32_e64 v4, s61, v7
    v_subrev_u32 v6, 1568, v4
    v_ashrrev_i32_e64 v6, 31, v6
    v_bfi_b32 v4, v6, v4, s14
    s_mov_b32 exec_hi, 0
    buffer_load_dwordx4 v4, s[12:15], s60 offen lds
    s_mov_b32 exec_hi, -1
    s_cbranch_vccz L_RW
    s_lshr_b32 s60, s72, 1
    s_lshl2_add_u32 s60, s55, s60
    s_lshr_b32 s61, s52, 1
    s_lshl1_add_u32 s60, s60, s61
    s_lshl_b32 s60, s60, 15
    s_and_b32 s61, s52, 1
    s_mul_i32 s61, s61, 7168
    s_add_u32 s60, s60, s61
    s_and_b32 s61, s72, 1
    s_lshl_b32 s61, s61, 8
    s_add_u32 s60, s60, s61
    s_add_u32 s60, s60, 2113536
    v_min_u32 v4, 27, v0
    v_lshrrev_b32 v6, 1, v4
    v_and_b32 v4, 1, v4
    v_lshlrev_b32_e64 v4, 7, v4
    v_lshl_add_u32 v4, v6, 9, v4
    buffer_load_dword v5, v4, s[48:51], s60 offen sc1
L_RW:
    s_cbranch_vccnz L_WLD
    v_lshrrev_b32 v3, 5, v0
    v_bfe_u32 v4, v0, 2, 2
    v_lshl_add_u32 v4, v3, 3, v4
    v_lshlrev_b32_e64 v4, 8, v4
    v_bfe_u32 v6, v0, 4, 1
    v_lshl_add_u32 v4, v6, 5, v4
    v_and_b32_e64 v6, 3, v0
    v_lshl_add_u32 v4, v6, 3, v4
    s_lshl_b32 s60, s52, 12
    s_add_u32 s60, s60, 116736
    v_add_u32 v4, s60, v4
    v_and_b32_e64 v6, 31, v0
    v_mul_u32_u24 v2, 448, v3
    v_lshl_add_u32 v2, v6, 4, v2
    s_waitcnt vmcnt(3)
    s_nop 0
    ds_read_b64_tr_b16 v[8:9], v4 offset:0
    ds_read_b64_tr_b16 v[10:11], v4 offset:1024
    ds_read_b64_tr_b16 v[12:13], v4 offset:56
    ds_read_b64_tr_b16 v[14:15], v4 offset:1080
    ds_read_b64_tr_b16 v[16:17], v4 offset:112
    ds_read_b64_tr_b16 v[18:19], v4 offset:1136
    ds_read_b64_tr_b16 v[20:21], v4 offset:168
    ds_read_b64_tr_b16 v[22:23], v4 offset:1192
    s_mov_b32 exec_lo, 0x0fffffff
    s_mov_b32 exec_hi, 0x0fffffff
    s_waitcnt lgkmcnt(6)
    buffer_store_dwordx4 v[8:11], v2, s[48:51], s73 offen sc1
    s_add_u32 s73, s73, 75264
    s_waitcnt lgkmcnt(4)
    buffer_store_dwordx4 v[12:15], v2, s[48:51], s73 offen sc1
    s_add_u32 s73, s73, 75264
    s_waitcnt lgkmcnt(2)
    buffer_store_dwordx4 v[16:19], v2, s[48:51], s73 offen sc1
    s_add_u32 s73, s73, 75264
    s_waitcnt lgkmcnt(0)
    buffer_store_dwordx4 v[20:23], v2, s[48:51], s73 offen sc1
    s_add_u32 s73, s73, 75264
    s_mov_b64 exec, -1
    s_branch L_WLD
    s_waitcnt lgkmcnt(0)
L_SP0:
    v_lshrrev_b32 v1, 4, v0
    v_bfe_u32 v11, v0, 2, 2
    v_and_b32_e64 v6, 3, v0
    v_lshl_add_u32 v4, v1, 2, v11
    v_bfe_u32 v8, v4, 1, 2
    v_lshlrev_b32_e64 v4, 7, v4
    v_lshl_add_u32 v4, v8, 5, v4
    v_lshl_add_u32 v8, v6, 3, v4
    s_lshl_b32 s60, s52, 5
    v_xor_b32 v8, s60, v8
    v_add_u32 v8, 116736, v8
    s_mul_i32 s60, s64, 448
    s_add_u32 s60, s60, 145408
    v_lshl_add_u32 v9, v1, 3, s60
    s_lshl_b32 s60, s52, 8
    s_add_u32 s60, s60, 145408
    v_add_u32 v10, s60, v10
    s_lshl2_add_u32 s61, s65, s52
    s_lshl_b32 s61, s61, 6
    s_mul_i32 s60, s64, 3584
    s_add_u32 s61, s61, s60
    s_add_u32 s61, s61, 40960
    v_lshlrev_b32 v4, 4, v1
    v_mov_b32_e64 v19, s59
    s_mov_b32 s62, 0x07060501
    s_mov_b32 s63, 0x07060502
    s_mov_b32 s60, 0x07060503
    s_waitcnt vmcnt(8)
    v_lshlrev_b32 v28, 16, v24
    v_and_b32_e64 v29, s70, v24
    v_mul_f32 v30, 0xbfb8aa3b, v28
    v_mul_f32 v31, 0xbfb8aa3b, v29
    v_exp_f32_e64 v30, v30
    v_exp_f32 v31, v31
    s_nop 0
    v_pk_add_f32 v[30:31], v[30:31], 1.0 op_sel_hi:[1,0]
    v_rcp_f32_e64 v30, v30
    v_rcp_f32 v31, v31
    s_nop 0
    v_pk_mul_f32 v[30:31], v[30:31], v[28:29]
    v_cvt_pk_bf16_f32 v24, v30, v31
    ds_write_b32 v10, v24
    s_waitcnt vmcnt(1)
    s_waitcnt lgkmcnt(0)
    s_barrier
    s_nop 0
    ds_read_b64 v[48:49], v9 offset:0
    ds_read_b64_tr_b16 v[80:81], v8 offset:0
    ds_read_b64 v[50:51], v9 offset:32
    ds_read_b64_tr_b16 v[82:83], v8 offset:2048
    ds_read_b64 v[52:53], v9 offset:64
    ds_read_b64_tr_b16 v[84:85], v8 offset:4096
    ds_read_b64 v[54:55], v9 offset:96
    ds_read_b64_tr_b16 v[86:87], v8 offset:6144
    ds_read_b64 v[56:57], v9 offset:128
    ds_read_b64_tr_b16 v[88:89], v8 offset:8192
    ds_read_b64 v[58:59], v9 offset:160
    ds_read_b64_tr_b16 v[90:91], v8 offset:10240
    ds_read_b64 v[60:61], v9 offset:192
    ds_read_b64_tr_b16 v[92:93], v8 offset:12288
    ds_read_b64 v[62:63], v9 offset:224
    ds_read_b64_tr_b16 v[94:95], v8 offset:14336
    ds_read_b64 v[64:65], v9 offset:256
    ds_read_b64_tr_b16 v[96:97], v8 offset:16384
    ds_read_b64 v[66:67], v9 offset:288
    ds_read_b64_tr_b16 v[98:99], v8 offset:18432
    ds_read_b64 v[68:69], v9 offset:320
    ds_read_b64_tr_b16 v[100:101], v8 offset:20480
    ds_read_b64 v[70:71], v9 offset:352
    ds_read_b64_tr_b16 v[102:103], v8 offset:22528
    ds_read_b64 v[72:73], v9 offset:384
    ds_read_b64_tr_b16 v[104:105], v8 offset:24576
    ds_read_b64 v[74:75], v9 offset:416
    ds_read_b64_tr_b16 v[106:107], v8 offset:26624
    s_waitcnt lgkmcnt(15)
    v_mfma_f32_16x16x32_bf16 v[12:15], v[80:83], v[48:51], 0
    s_waitcnt lgkmcnt(15)
    v_mfma_f32_16x16x32_bf16 v[12:15], v[84:87], v[52:55], v[12:15]
    s_waitcnt lgkmcnt(15)
    v_mfma_f32_16x16x32_bf16 v[12:15], v[88:91], v[56:59], v[12:15]
    s_waitcnt lgkmcnt(12)
    v_mfma_f32_16x16x32_bf16 v[12:15], v[92:95], v[60:63], v[12:15]
    s_waitcnt lgkmcnt(8)
    v_mfma_f32_16x16x32_bf16 v[12:15], v[96:99], v[64:67], v[12:15]
    s_waitcnt lgkmcnt(4)
    v_mfma_f32_16x16x32_bf16 v[12:15], v[100:103], v[68:71], v[12:15]
    s_waitcnt lgkmcnt(0)
    v_mfma_f32_16x16x32_bf16 v[12:15], v[104:107], v[72:75], v[12:15]
    s_cmp_lt_u32 s65, 14
    s_cbranch_scc0 SK_1
    s_mov_b32 exec_lo, 0x00010001
    s_mov_b32 exec_hi, 0x00010001
    s_nop 3
    v_perm_b32 v16, v12, v15, s62
    v_perm_b32 v17, v13, v15, s63
    v_perm_b32 v18, v14, v15, s60
    buffer_store_dwordx4 v[16:19], v4, s[48:51], s61 offen sc1
    s_mov_b64 exec, -1
SK_1:
    s_mul_i32 s60, s56, 1568
    s_lshl_b32 s61, s52, 9
    s_add_u32 m0, s61, 146432
    v_add_u32_e64 v4, s61, v7
    v_subrev_u32 v6, 1568, v4
    v_ashrrev_i32_e64 v6, 31, v6
    v_bfi_b32 v4, v6, v4, s14
    s_mov_b32 exec_hi, 0
    buffer_load_dwordx4 v4, s[12:15], s60 offen lds
    s_mov_b32 exec_hi, -1
L_WLD:
    v_lshrrev_b32 v1, 4, v0
    v_lshrrev_b32 v3, 5, v0
    v_bfe_u32 v12, v0, 2, 2
    v_and_b32_e64 v6, 3, v0
    v_lshl_add_u32 v4, v1, 2, v12
    v_bfe_u32 v8, v4, 1, 2
    v_lshlrev_b32_e64 v4, 7, v4
    v_lshl_add_u32 v4, v8, 5, v4
    v_lshl_add_u32 v8, v6, 3, v4
    v_xor_b32 v9, 32, v8
    v_xor_b32 v10, 64, v8
    v_xor_b32 v11, 96, v8
    v_lshrrev_b32 v237, 3, v0
    v_and_b32 v238, 7, v0
    v_and_b32 v14, 6, v237
    v_xor_b32 v14, v14, v238
    v_lshlrev_b32 v14, 4, v14
    s_cmp_eq_u32 s58, 7
    s_cselect_b32 s36, s40, s20
    s_cselect_b32 s8, s20, s16
    s_cselect_b32 s37, s41, s21
    s_cselect_b32 s9, s21, s17
    s_cselect_b32 s38, s42, s22
    s_cselect_b32 s10, s22, s18
    s_cselect_b32 s62, 6, 4
    s_cselect_b32 s86, 4, 1
    s_cselect_b32 s63, s57, s71
    s_add_u32 s63, s63, 14
    s_mul_i32 s62, s62, 896
    s_mul_i32 s86, s86, 896
    v_mad_u32_u24 v15, v237, s62, v14
    v_mad_u32_u24 v14, v237, s86, v14
    s_lshl_b32 s81, s62, 3
    s_mul_i32 s91, s52, 14
    s_mul_i32 s90, s91, s81
    s_lshl_b32 s63, s63, 7
    s_add_u32 s90, s90, s63
    s_lshl_b32 s91, s91, 10
    v_lshlrev_b32_e64 v238, 4, v238
    v_lshl_add_u32 v237, v237, 9, v238
    v_and_b32 v4, 15, v0
    v_xor_b32 v12, v4, v1
    v_lshlrev_b32_e64 v12, 4, v12
    v_lshl_add_u32 v16, v1, 12, v12
    v_lshl_add_u32 v20, v4, 8, v12
    s_sub_u32 s60, s67, 49152
    v_add_u32_e64 v20, s60, v20
    v_xor_b32 v17, 16448, v16
    v_xor_b32_e64 v21, 64, v20
    v_xor_b32 v18, 32896, v16
    v_xor_b32 v22, 128, v20
    v_xor_b32 v19, 49344, v16
    v_xor_b32 v23, 192, v20
    v_lshlrev_b32 v4, 1, v4
    s_lshl2_add_u32 s60, s57, s52
    s_lshl_b32 s60, s60, 5
    v_mov_b32 v252, 0
    buffer_load_short_d16_hi v252, v4, s[28:31], s60 offen
    s_and_b32 s61, s53, 1
    s_lshl_b32 s61, s61, 11
    s_lshl2_add_u32 s94, s57, s52
    s_lshl_b32 s94, s94, 16
    s_add_u32 s94, s94, s61
    v_subrev_u32 v17, 1024, v17
    v_subrev_u32 v18, 2048, v18
    v_subrev_u32 v19, 3072, v19
    s_lshl_b32 s63, s53, 8
    s_add_u32 s63, s63, 32768
    v_and_b32 v6, 31, v0
    v_lshlrev_b32 v6, 3, v6
    s_lshr_b32 s84, s56, 2
    s_lshl_b32 s84, s84, 12
    s_add_u32 s84, s84, 65536
    v_min_u32 v243, 20, v0
    v_lshlrev_b32 v243, 7, v243
    v_lshrrev_b32_e64 v4, 3, v0
    v_mul_u32_u24 v4, 896, v4
    v_add_u32 v4, v4, v238
    s_lshl2_add_u32 s66, s57, s52
    s_mul_i32 s66, s66, 112
    s_add_u32 s66, s66, s58
    s_lshl_b32 m0, s52, 11
    s_lshl_b32 s66, s66, 7
    buffer_load_dwordx4 v4, s[4:7], s66 offen lds
    s_addk_i32 s66, 6144
    buffer_load_dwordx4 v4, s[4:7], s66 offen offset:1024 lds
    s_cbranch_vccz SK_2
    v_and_b32 v4, 15, v0
    v_mul_u32_u24 v128, 1056, v4
    v_lshl_add_u32 v128, v1, 4, v128
    v_add_u32 v128, 116736, v128
    s_lshl_b32 s60, s52, 6
    v_add_u32 v144, s60, v128
    s_add_u32 s61, s52, 12
    s_min_u32 s61, s61, 13
    s_lshl_b32 s62, s61, 6
    v_add_u32 v145, s62, v128
    v_mov_b32 v132, 0x3f803f80
    v_mov_b32 v133, 0x3f803f80
    v_mov_b32 v134, 0x3f803f80
    v_mov_b32 v135, 0x3f803f80
    v_lshlrev_b32_e64 v131, 5, v1
    v_add_u32 v131, 150016, v131
    s_lshl_b32 s60, s60, 1
    s_lshl_b32 s62, s62, 1
    v_add_u32 v129, s60, v131
    v_add_u32 v130, s62, v131
    v_lshlrev_b32_e64 v131, 4, v4
    v_lshl_add_u32 v131, v1, 9, v131
    s_lshr_b32 s60, s72, 1
    s_lshl2_add_u32 s60, s55, s60
    s_lshl_b32 s60, s60, 16
    s_and_b32 s62, s72, 1
    s_lshl_b32 s62, s62, 8
    s_add_u32 s60, s60, s62
    s_add_u32 s60, s60, 2113536
    s_lshl_b32 s62, s52, 11
    s_add_u32 s77, s60, s62
    s_cmp_eq_u32 s52, 3
    s_cselect_b32 s62, 18432, 0
    s_add_u32 s62, s62, s77
    s_add_u32 s78, s62, 8192
    s_add_u32 s79, s77, 34816
    s_lshl_b32 s61, s61, 11
    s_add_u32 s60, s60, s61
    s_add_u32 s80, s60, 18432
    s_lshl_b32 s60, s52, 6
    v_add_u32 v146, s60, v0
    v_min_u32 v146, 223, v146
    v_lshlrev_b32_e64 v146, 4, v146
    s_mov_b32 s61, 40960
    v_add_u32 v4, 151808, v146
    v_add_u32 v148, 148224, v146
    s_mov_b32 s62, 1792
    v_cmp_gt_u32 s[64:65], s62, v146
    s_nop 1
    v_cndmask_b32 v4, v148, v4, s[64:65]
    v_cndmask_b32 v148, 1.0, 0, s[64:65]
    s_lshl_b32 s60, s55, 6
    s_add_u32 s60, s60, s72
    s_lshl_b32 s60, s60, 2
    s_add_u32 s60, s60, 16512
    s_mov_b32 s75, 0x0c04000c
    s_mov_b32 s76, 0x0402010c
    s_add_u32 m0, s91, 58368
    s_nop 0
    buffer_load_dwordx4 v15, s[36:39], s90 offen lds
    s_add_u32 m0, s91, 59392
    s_add_u32 s90, s90, s81
    buffer_load_dwordx4 v15, s[36:39], s90 offen lds
    s_add_u32 m0, s91, 60416
    s_add_u32 s90, s90, s81
    buffer_load_dwordx4 v15, s[36:39], s90 offen lds
    s_add_u32 m0, s91, 61440
    s_add_u32 s90, s90, s81
    buffer_load_dwordx4 v15, s[36:39], s90 offen lds
    s_add_u32 m0, s91, 62464
    s_add_u32 s90, s90, s81
    buffer_load_dwordx4 v15, s[36:39], s90 offen lds
    s_waitcnt vmcnt(11)
    s_barrier
    s_nop 0
    ds_read_b128 v[24:27], v128 offset:0
    ds_read_b128 v[28:31], v128 offset:64
    ds_read_b128 v[32:35], v128 offset:128
    ds_read_b128 v[36:39], v128 offset:192
    ds_read_b128 v[40:43], v128 offset:256
    ds_read_b128 v[44:47], v128 offset:320
    ds_read_b128 v[48:51], v128 offset:384
    ds_read_b128 v[52:55], v128 offset:448
    ds_read_b128 v[56:59], v128 offset:512
    ds_read_b128 v[60:63], v128 offset:576
    ds_read_b128 v[64:67], v128 offset:640
    ds_read_b128 v[68:71], v128 offset:704
    ds_read_b128 v[72:75], v128 offset:768
    ds_read_b128 v[76:79], v128 offset:832
    ds_read_b128 v[100:103], v144 offset:0
    ds_read_b128 v[108:111], v144 offset:256
    ds_read_b128 v[116:119], v144 offset:512
    ds_read_b128 v[124:127], v145 offset:0
    s_waitcnt lgkmcnt(15)
    v_mfma_f32_16x16x32_bf16 v[136:139], v[24:27], v[24:27], 0
    v_mfma_f32_16x16x32_bf16 v[140:143], v[132:135], v[24:27], 0
    s_add_u32 m0, s91, 63488
    s_add_u32 s90, s90, s81
    buffer_load_dwordx4 v15, s[36:39], s90 offen lds
    s_waitcnt lgkmcnt(15)
    v_mfma_f32_16x16x32_bf16 v[136:139], v[28:31], v[28:31], v[136:139]
    v_mfma_f32_16x16x32_bf16 v[140:143], v[132:135], v[28:31], v[140:143]
    s_add_u32 m0, s91, 64512
    s_add_u32 s90, s90, s81
    buffer_load_dwordx4 v15, s[36:39], s90 offen lds
    s_waitcnt lgkmcnt(11)
    v_mfma_f32_16x16x32_bf16 v[136:139], v[32:35], v[32:35], v[136:139]
    v_mfma_f32_16x16x32_bf16 v[140:143], v[132:135], v[32:35], v[140:143]
    s_add_u32 m0, s91, 65536
    s_add_u32 s90, s90, s81
    buffer_load_dwordx4 v15, s[36:39], s90 offen lds
    v_mfma_f32_16x16x32_bf16 v[136:139], v[36:39], v[36:39], v[136:139]
    v_mfma_f32_16x16x32_bf16 v[140:143], v[132:135], v[36:39], v[140:143]
    s_add_u32 m0, s91, 66560
    s_add_u32 s90, s90, s81
    buffer_load_dwordx4 v15, s[36:39], s90 offen lds
    v_mfma_f32_16x16x32_bf16 v[136:139], v[40:43], v[40:43], v[136:139]
    v_mfma_f32_16x16x32_bf16 v[140:143], v[132:135], v[40:43], v[140:143]
    s_add_u32 m0, s91, 67584
    s_add_u32 s90, s90, s81
    buffer_load_dwordx4 v15, s[36:39], s90 offen lds
    v_mfma_f32_16x16x32_bf16 v[136:139], v[44:47], v[44:47], v[136:139]
    v_mfma_f32_16x16x32_bf16 v[140:143], v[132:135], v[44:47], v[140:143]
    s_add_u32 m0, s91, 68608
    s_add_u32 s90, s90, s81
    buffer_load_dwordx4 v15, s[36:39], s90 offen lds
    v_mfma_f32_16x16x32_bf16 v[136:139], v[48:51], v[48:51], v[136:139]
    s_waitcnt lgkmcnt(0)
    v_lshlrev_b32 v96, 16, v100
    v_and_b32 v97, s70, v100
    v_mfma_f32_16x16x32_bf16 v[140:143], v[132:135], v[48:51], v[140:143]
    v_lshlrev_b32 v98, 16, v101
    v_and_b32 v99, s70, v101
    s_add_u32 m0, s91, 69632
    s_add_u32 s90, s90, s81
    buffer_load_dwordx4 v15, s[36:39], s90 offen lds
    v_mfma_f32_16x16x32_bf16 v[136:139], v[52:55], v[52:55], v[136:139]
    v_lshlrev_b32 v100, 16, v102
    v_and_b32_e64 v101, s70, v102
    v_mfma_f32_16x16x32_bf16 v[140:143], v[132:135], v[52:55], v[140:143]
    v_lshlrev_b32 v102, 16, v103
    v_and_b32 v103, s70, v103
    s_add_u32 m0, s91, 70656
    s_add_u32 s90, s90, s81
    buffer_load_dwordx4 v15, s[36:39], s90 offen lds
    v_mfma_f32_16x16x32_bf16 v[136:139], v[56:59], v[56:59], v[136:139]
    v_lshlrev_b32 v104, 16, v108
    v_and_b32_e64 v105, s70, v108
    v_mfma_f32_16x16x32_bf16 v[140:143], v[132:135], v[56:59], v[140:143]
    v_lshlrev_b32 v106, 16, v109
    v_and_b32 v107, s70, v109
    s_add_u32 m0, s91, 71680
    s_add_u32 s90, s90, s81
    buffer_load_dwordx4 v15, s[36:39], s90 offen lds
    v_mfma_f32_16x16x32_bf16 v[136:139], v[60:63], v[60:63], v[136:139]
    v_lshlrev_b32 v108, 16, v110
    v_and_b32_e64 v109, s70, v110
    v_mfma_f32_16x16x32_bf16 v[140:143], v[132:135], v[60:63], v[140:143]
    v_lshlrev_b32 v110, 16, v111
    v_and_b32 v111, s70, v111
    v_mfma_f32_16x16x32_bf16 v[136:139], v[64:67], v[64:67], v[136:139]
    v_lshlrev_b32 v112, 16, v116
    v_and_b32 v113, s70, v116
    v_mfma_f32_16x16x32_bf16 v[140:143], v[132:135], v[64:67], v[140:143]
    v_lshlrev_b32 v114, 16, v117
    v_and_b32 v115, s70, v117
    v_mfma_f32_16x16x32_bf16 v[136:139], v[68:71], v[68:71], v[136:139]
    v_lshlrev_b32 v116, 16, v118
    v_and_b32 v117, s70, v118
    v_mfma_f32_16x16x32_bf16 v[140:143], v[132:135], v[68:71], v[140:143]
    v_lshlrev_b32 v118, 16, v119
    v_and_b32 v119, s70, v119
    v_mfma_f32_16x16x32_bf16 v[136:139], v[72:75], v[72:75], v[136:139]
    v_lshlrev_b32 v120, 16, v124
    v_and_b32 v121, s70, v124
    v_mfma_f32_16x16x32_bf16 v[140:143], v[132:135], v[72:75], v[140:143]
    v_lshlrev_b32 v122, 16, v125
    v_and_b32 v123, s70, v125
    v_mfma_f32_16x16x32_bf16 v[136:139], v[76:79], v[76:79], v[136:139]
    v_lshlrev_b32 v124, 16, v126
    v_and_b32 v125, s70, v126
    v_mfma_f32_16x16x32_bf16 v[140:143], v[132:135], v[76:79], v[140:143]
    v_lshlrev_b32 v126, 16, v127
    v_and_b32 v127, s70, v127
    v_and_b32 v2, 15, v0
    v_lshlrev_b32 v2, 7, v2
    v_lshl_add_u32 v2, v1, 3, v2
    s_lshl_b32 s66, s52, 11
    v_add_u32 v2, s66, v2
    s_waitcnt vmcnt(14)
    s_nop 0
    ds_read_b64 a[240:241], v2 offset:0
    ds_read_b64 a[242:243], v2 offset:32
    ds_read_b64 a[244:245], v2 offset:64
    ds_read_b64 a[246:247], v2 offset:96
    buffer_load_dwordx2 v[240:241], v6, s[48:51], s63 offen sc1
    s_mov_b32 s64, 0xaaaaaaaa
    s_mov_b32 s65, 0xaaaaaaaa
    v_cndmask_b32 v136, v136, v137, s[64:65]
    v_cndmask_b32 v138, v138, v139, s[64:65]
    s_mov_b32 s64, 0xcccccccc
    s_mov_b32 s65, 0xcccccccc
    v_cndmask_b32 v136, v136, v138, s[64:65]
    s_mov_b32 s64, 0x00f0000f
    s_mov_b32 s65, 0xf0000f00
    v_cndmask_b32 v136, 0, v136, s[64:65]
    v_mov_b32 v137, v136
    s_nop 1
    v_permlane32_swap_b32 v136, v137
    v_add_f32 v136, v136, v137
    v_mov_b32_e64 v137, v136
    v_mul_f32 v140, 0x3b124925, v140
    s_nop 0
    v_permlane16_swap_b32 v136, v137
    v_add_f32_e64 v136, v136, v137
    v_mul_f32 v136, 0x3b124925, v136
    v_fma_f32 v136, -v140, v140, v136
    v_max_f32_e64 v136, 0, v136
    v_add_f32 v136, 0x3727c5ac, v136
    v_rsq_f32 v136, v136
    s_nop 0
    v_mul_f32_e64 v140, -v140, v136
    buffer_load_dwordx4 v[152:155], v146, s[48:51], s61 offen sc1
    buffer_load_dwordx4 v[156:159], v146, s[48:51], s61 offen offset:3584 sc1
    v_pk_fma_f32 v[96:97], v[96:97], v[136:137], v[140:141] op_sel_hi:[1,0,0]
    v_pk_fma_f32 v[98:99], v[98:99], v[136:137], v[140:141] op_sel_hi:[1,0,0]
    v_pk_fma_f32 v[100:101], v[100:101], v[136:137], v[140:141] op_sel_hi:[1,0,0]
    v_pk_fma_f32 v[102:103], v[102:103], v[136:137], v[140:141] op_sel_hi:[1,0,0]
    v_pk_fma_f32 v[104:105], v[104:105], v[136:137], v[140:141] op_sel_hi:[1,0,0]
    v_pk_fma_f32 v[106:107], v[106:107], v[136:137], v[140:141] op_sel_hi:[1,0,0]
    v_pk_fma_f32 v[108:109], v[108:109], v[136:137], v[140:141] op_sel_hi:[1,0,0]
    v_pk_fma_f32 v[110:111], v[110:111], v[136:137], v[140:141] op_sel_hi:[1,0,0]
    v_pk_fma_f32 v[112:113], v[112:113], v[136:137], v[140:141] op_sel_hi:[1,0,0]
    v_pk_fma_f32 v[114:115], v[114:115], v[136:137], v[140:141] op_sel_hi:[1,0,0]
    v_pk_fma_f32 v[116:117], v[116:117], v[136:137], v[140:141] op_sel_hi:[1,0,0]
    v_pk_fma_f32 v[118:119], v[118:119], v[136:137], v[140:141] op_sel_hi:[1,0,0]
    v_pk_fma_f32 v[120:121], v[120:121], v[136:137], v[140:141] op_sel_hi:[1,0,0]
    v_pk_fma_f32 v[122:123], v[122:123], v[136:137], v[140:141] op_sel_hi:[1,0,0]
    v_pk_fma_f32 v[124:125], v[124:125], v[136:137], v[140:141] op_sel_hi:[1,0,0]
    v_pk_fma_f32 v[126:127], v[126:127], v[136:137], v[140:141] op_sel_hi:[1,0,0]
    s_waitcnt vmcnt(0)
    v_xor_b32 v155, s59, v155
    v_bitop3_b32 v155, v155, v159, s59 bitop3:0xf6
    v_cmp_ne_u32 s[64:65], 0, v155
    s_nop 0
    s_cmp_eq_u64 s[64:65], 0
    s_cbranch_scc1 L_PAD
    s_mov_b32 s66, 0
L_PAL:
    s_add_u32 s66, s66, 1
    s_cmp_gt_u32 s66, 0x40000
    s_cbranch_scc1 L_PAD
    s_sleep 3
L_PAF:
    buffer_load_dwordx4 v[152:155], v146, s[48:51], s61 offen sc1
    buffer_load_dwordx4 v[156:159], v146, s[48:51], s61 offen offset:3584 sc1
    s_waitcnt vmcnt(0)
    v_xor_b32_e64 v155, s59, v155
    v_bitop3_b32 v155, v155, v159, s59 bitop3:0xf6
    v_cmp_ne_u32 s[64:65], 0, v155
    s_nop 0
    s_cmp_eq_u64 s[64:65], 0
    s_cbranch_scc0 L_PAL
L_PAD:
    s_nop 0
    buffer_load_dword v242, v243, s[48:51], s84 offen sc1
    v_perm_b32 v155, v153, v152, s75
    v_perm_b32 v155, v154, v155, s76
    v_perm_b32 v159, v157, v156, s75
    v_perm_b32 v159, v158, v159, s76
    v_pk_add_f32 v[152:153], v[152:153], v[156:157]
    v_pk_add_f32 v[154:155], v[154:155], v[158:159]
    v_cvt_pk_bf16_f32 v152, v152, v153
    v_cvt_pk_bf16_f32 v153, v154, v155
    v_lshlrev_b32 v156, 16, v152
    v_and_b32 v157, s70, v152
    v_lshlrev_b32 v158, 16, v153
    v_and_b32 v159, s70, v153
    v_pk_add_f32 v[156:157], v[156:157], v[148:149] op_sel_hi:[1,0]
    v_pk_add_f32 v[158:159], v[158:159], v[148:149] op_sel_hi:[1,0]
    v_cvt_pk_bf16_f32 v152, v156, v157
    v_cvt_pk_bf16_f32 v153, v158, v159
    v_lshlrev_b32 v156, 16, v152
    v_and_b32 v157, s70, v152
    v_lshlrev_b32 v158, 16, v153
    v_and_b32 v159, s70, v153
    ds_write_b128 v4, v[156:159]
    v_cmp_ne_u32 s[64:65], s59, v241
    s_nop 0
    s_cmp_eq_u64 s[64:65], 0
    s_cbranch_scc0 L_PX0
L_PX0D:
    v_cmp_ne_u32 s[64:65], s87, v240
    s_nop 0
    s_cmp_eq_u64 s[64:65], 0
    s_cselect_b32 s87, 1, 0
    s_waitcnt lgkmcnt(0)
    s_barrier
    ds_read_b128 v[24:27], v129 offset:0
    ds_read_b128 v[28:31], v129 offset:16
    ds_read_b128 v[32:35], v129 offset:1792
    ds_read_b128 v[36:39], v129 offset:1808
    ds_read_b128 v[40:43], v129 offset:512
    ds_read_b128 v[44:47], v129 offset:528
    ds_read_b128 v[48:51], v129 offset:2304
    ds_read_b128 v[52:55], v129 offset:2320
    ds_read_b128 v[56:59], v129 offset:1024
    ds_read_b128 v[60:63], v129 offset:1040
    ds_read_b128 v[64:67], v129 offset:2816
    ds_read_b128 v[68:71], v129 offset:2832
    ds_read_b128 v[72:75], v130 offset:0
    ds_read_b128 v[76:79], v130 offset:16
    ds_read_b128 v[80:83], v130 offset:1792
    ds_read_b128 v[84:87], v130 offset:1808
    s_waitcnt lgkmcnt(7)
    s_nop 0
    v_pk_fma_f32 v[96:97], v[96:97], v[24:25], v[32:33]
    v_pk_fma_f32 v[98:99], v[98:99], v[26:27], v[34:35]
    v_pk_fma_f32 v[100:101], v[100:101], v[28:29], v[36:37]
    v_pk_fma_f32 v[102:103], v[102:103], v[30:31], v[38:39]
    v_cvt_pk_bf16_f32 v96, v96, v97
    v_cvt_pk_bf16_f32 v97, v98, v99
    v_cvt_pk_bf16_f32 v98, v100, v101
    v_cvt_pk_bf16_f32 v99, v102, v103
    s_cmp_eq_u32 s87, 0
    s_cbranch_scc1 WT_3
    buffer_store_dwordx4 v[96:99], v131, s[48:51], s77 offen
WB_4:
    v_pk_fma_f32 v[104:105], v[104:105], v[40:41], v[48:49]
    v_pk_fma_f32 v[106:107], v[106:107], v[42:43], v[50:51]
    v_pk_fma_f32 v[108:109], v[108:109], v[44:45], v[52:53]
    v_pk_fma_f32 v[110:111], v[110:111], v[46:47], v[54:55]
    v_cvt_pk_bf16_f32 v104, v104, v105
    v_cvt_pk_bf16_f32 v105, v106, v107
    v_cvt_pk_bf16_f32 v106, v108, v109
    v_cvt_pk_bf16_f32 v107, v110, v111
    s_cmp_eq_u32 s87, 0
    s_cbranch_scc1 WT_5
    buffer_store_dwordx4 v[104:107], v131, s[48:51], s78 offen
WB_6:
    s_waitcnt lgkmcnt(0)
    s_nop 0
    v_pk_fma_f32 v[112:113], v[112:113], v[56:57], v[64:65]
    v_pk_fma_f32 v[114:115], v[114:115], v[58:59], v[66:67]
    v_pk_fma_f32 v[116:117], v[116:117], v[60:61], v[68:69]
    v_pk_fma_f32 v[118:119], v[118:119], v[62:63], v[70:71]
    v_cvt_pk_bf16_f32 v112, v112, v113
    v_cvt_pk_bf16_f32 v113, v114, v115
    v_cvt_pk_bf16_f32 v114, v116, v117
    v_cvt_pk_bf16_f32 v115, v118, v119
    s_cmp_eq_u32 s87, 0
    s_cbranch_scc1 WT_7
    buffer_store_dwordx4 v[112:115], v131, s[48:51], s79 offen
WB_8:
    v_pk_fma_f32 v[120:121], v[120:121], v[72:73], v[80:81]
    v_pk_fma_f32 v[122:123], v[122:123], v[74:75], v[82:83]
    v_pk_fma_f32 v[124:125], v[124:125], v[76:77], v[84:85]
    v_pk_fma_f32 v[126:127], v[126:127], v[78:79], v[86:87]
    v_cvt_pk_bf16_f32 v120, v120, v121
    v_cvt_pk_bf16_f32 v121, v122, v123
    v_cvt_pk_bf16_f32 v122, v124, v125
    v_cvt_pk_bf16_f32 v123, v126, v127
    s_cmp_eq_u32 s87, 0
    s_cbranch_scc1 WT_9
    buffer_store_dwordx4 v[120:123], v131, s[48:51], s80 offen
WB_10:
    s_waitcnt vmcnt(4)
    v_cmp_ne_u32 s[64:65], s59, v242
    s_nop 0
    s_cmp_eq_u64 s[64:65], 0
    s_cselect_b32 s73, 1, 0
    s_cbranch_scc0 SK_11
    s_add_u32 m0, s93, 0
    s_add_u32 s92, s83, 549376
    buffer_load_dwordx4 v7, s[48:51], s92 offen offset:0 sc1 lds
    buffer_load_dwordx4 v7, s[48:51], s92 offen offset:1024 sc1 lds
    buffer_load_dwordx4 v7, s[48:51], s92 offen offset:2048 sc1 lds
    buffer_load_dwordx4 v7, s[48:51], s92 offen offset:3072 sc1 lds
SK_11:
SK_2:
    s_cbranch_vccnz SK_12
    s_add_u32 m0, s91, 58368
    s_nop 0
    buffer_load_dwordx4 v15, s[36:39], s90 offen lds
    s_add_u32 m0, s91, 59392
    s_add_u32 s90, s90, s81
    buffer_load_dwordx4 v15, s[36:39], s90 offen lds
    s_add_u32 m0, s91, 60416
    s_add_u32 s90, s90, s81
    buffer_load_dwordx4 v15, s[36:39], s90 offen lds
    s_add_u32 m0, s91, 61440
    s_add_u32 s90, s90, s81
    buffer_load_dwordx4 v15, s[36:39], s90 offen lds
    s_waitcnt vmcnt(7)
    s_barrier
    s_cmp_eq_u32 s52, 0
    s_cbranch_scc0 SK_13
    v_mov_b32 v4, s59
    s_mov_b64 exec, 1
    buffer_store_dword v4, off, s[48:51], s74 sc1
    s_mov_b64 exec, -1
SK_13:
    s_add_u32 m0, s91, 62464
    s_add_u32 s90, s90, s81
    buffer_load_dwordx4 v15, s[36:39], s90 offen lds
    s_add_u32 m0, s91, 63488
    s_add_u32 s90, s90, s81
    buffer_load_dwordx4 v15, s[36:39], s90 offen lds
    s_add_u32 m0, s91, 64512
    s_add_u32 s90, s90, s81
    buffer_load_dwordx4 v15, s[36:39], s90 offen lds
    s_add_u32 m0, s91, 65536
    s_add_u32 s90, s90, s81
    buffer_load_dwordx4 v15, s[36:39], s90 offen lds
    s_add_u32 m0, s91, 66560
    s_add_u32 s90, s90, s81
    buffer_load_dwordx4 v15, s[36:39], s90 offen lds
    s_add_u32 m0, s91, 67584
    s_add_u32 s90, s90, s81
    buffer_load_dwordx4 v15, s[36:39], s90 offen lds
    s_add_u32 m0, s91, 68608
    s_add_u32 s90, s90, s81
    buffer_load_dwordx4 v15, s[36:39], s90 offen lds
    s_add_u32 m0, s91, 69632
    s_add_u32 s90, s90, s81
    buffer_load_dwordx4 v15, s[36:39], s90 offen lds
    s_add_u32 m0, s91, 70656
    s_add_u32 s90, s90, s81
    buffer_load_dwordx4 v15, s[36:39], s90 offen lds
    s_add_u32 m0, s91, 71680
    s_add_u32 s90, s90, s81
    buffer_load_dwordx4 v15, s[36:39], s90 offen lds
    s_mov_b32 s66, 0
L_PXL:
    s_add_u32 s66, s66, 1
    s_cmp_gt_u32 s66, 0x40000
    s_cbranch_scc1 L_PXD
L_PXF:
    buffer_load_dwordx2 v[240:241], v6, s[48:51], s63 offen sc1
    s_waitcnt vmcnt(0)
    v_cmp_ne_u32 s[64:65], s59, v241
    s_nop 0
    s_cmp_eq_u64 s[64:65], 0
    s_cbranch_scc0 L_PXL
L_PXD:
    v_cmp_ne_u32 s[64:65], s87, v240
    s_nop 0
    s_cmp_eq_u64 s[64:65], 0
    s_cselect_b32 s87, 1, 0
    v_and_b32 v2, 15, v0
    v_lshlrev_b32 v2, 7, v2
    v_lshl_add_u32 v2, v1, 3, v2
    s_lshl_b32 s66, s52, 11
    v_add_u32 v2, s66, v2
    ds_read_b64 a[240:241], v2 offset:0
    ds_read_b64 a[242:243], v2 offset:32
    ds_read_b64 a[244:245], v2 offset:64
    ds_read_b64 a[246:247], v2 offset:96
    s_waitcnt lgkmcnt(0)
    s_barrier
SK_12:
    v_bfe_u32 v5, v0, 2, 2
    v_and_b32_e64 v6, 3, v0
    v_bfe_u32 v12, v0, 4, 1
    v_lshlrev_b32_e64 v13, 5, v12
    v_lshl_add_u32 v13, v6, 3, v13
    v_and_b32 v4, 31, v0
    v_min_u32 v4, 27, v4
    v_mul_u32_u24 v253, 448, v3
    v_lshl_add_u32 v4, v4, 4, v253
    v_add_u32_e64 v253, 0, v4
    v_add_u32 v247, 116736, v4
    v_lshl_add_u32 v4, v3, 2, v5
    v_mad_u32_u24 v4, v4, 56, v13
    v_add_u32 v244, 146432, v4
    v_and_b32_e64 v4, 31, v0
    v_mul_u32_u24 v4, 136, v4
    v_lshl_add_u32 v4, v3, 3, v4
    s_mul_i32 s61, s52, 4352
    s_add_u32 s61, s61, 40960
    v_add_u32 v232, s61, v4
    v_and_b32 v4, 15, v0
    v_lshlrev_b32_e64 v13, 4, v4
    v_lshl_add_u32 v233, v12, 10, v13
    v_lshl_add_u32 v233, v3, 8, v233
    s_lshl_b32 s61, s52, 11
    s_add_u32 s61, s61, 153600
    v_add_u32 v233, s61, v233
    v_lshl_add_u32 v234, v12, 2, v5
    v_lshl_add_u32 v234, v3, 4, v234
    v_mul_u32_u24 v234, 136, v234
    v_lshl_add_u32 v234, v6, 3, v234
    s_lshl_b32 s61, s52, 5
    s_add_u32 s61, s61, 40960
    v_add_u32 v234, s61, v234
    v_add_u32 v235, 120320, v7
    v_lshl_add_u32 v236, v1, 13, v13
    s_and_b32 s61, s52, 1
    s_sub_u32 s61, 3, s61
    v_min_u32_e64 v238, s61, v1
    v_lshl_add_u32 v238, v238, 9, v13
    v_lshl_add_u32 v239, v12, 9, v13
    v_lshl_add_u32 v239, v3, 3, v239
    s_lshl_b32 s61, s52, 10
    s_add_u32 s61, s61, 120320
    v_add_u32 v239, s61, v239
    v_lshl_add_u32 v246, v12, 15, v13
    v_lshl_add_u32 v246, v3, 8, v246
    s_lshl2_add_u32 s85, s55, s52
    s_lshl_b32 s85, s85, 16
    s_add_u32 s85, s85, 2113536
    s_lshl_b32 s61, s55, 8
    s_lshl3_add_u32 s61, s52, s61
    s_add_u32 s61, s61, 16512
    v_and_b32_e64 v12, 1, v0
    v_lshl_add_u32 v12, v12, 2, s61
    s_cbranch_vccz SK_14
    s_waitcnt vmcnt(4)
    s_cmp_eq_u32 s73, 1
    s_cbranch_scc1 L_HD
    s_waitcnt vmcnt(0)
L_HD:
    s_barrier
    s_cmp_eq_u32 s52, 0
    s_cbranch_scc0 SK_15
    v_mov_b32 v5, s59
    s_mov_b64 exec, 1
    s_cmp_eq_u32 s87, 0
    s_cbranch_scc1 WT_16
    buffer_store_dword v5, off, s[48:51], s60
WB_17:
    s_mov_b64 exec, -1
SK_15:
    s_cmp_eq_u32 s73, 1
    s_cbranch_scc1 SK_18
    s_mov_b32 s66, 0
    s_branch L_PWF
L_PWL:
    s_add_u32 s66, s66, 1
    s_cmp_gt_u32 s66, 0x40000
    s_cbranch_scc1 L_PWD
    s_sleep 3
L_PWF:
    buffer_load_dword v242, v243, s[48:51], s84 offen sc1
    s_waitcnt vmcnt(0)
    v_cmp_ne_u32 s[64:65], s59, v242
    s_nop 0
    s_cmp_eq_u64 s[64:65], 0
    s_cbranch_scc0 L_PWL
L_PWD:
    s_add_u32 m0, s93, 0
    s_nop 0
    s_add_u32 s92, s83, 549376
    buffer_load_dwordx4 v7, s[48:51], s92 offen offset:0 sc1 lds
    buffer_load_dwordx4 v7, s[48:51], s92 offen offset:1024 sc1 lds
    buffer_load_dwordx4 v7, s[48:51], s92 offen offset:2048 sc1 lds
    buffer_load_dwordx4 v7, s[48:51], s92 offen offset:3072 sc1 lds
SK_18:
SK_14:
    s_cbranch_vccnz SK_19
    s_mov_b32 s66, 0
    s_branch L_PW2F
L_PW2L:
    s_add_u32 s66, s66, 1
    s_cmp_gt_u32 s66, 0x40000
    s_cbranch_scc1 L_PW2D
    s_sleep 3
L_PW2F:
    buffer_load_dword v242, v243, s[48:51], s84 offen sc1
    s_waitcnt vmcnt(0)
    v_cmp_ne_u32 s[64:65], s59, v242
    s_nop 0
    s_cmp_eq_u64 s[64:65], 0
    s_cbranch_scc0 L_PW2L
L_PW2D:
    s_add_u32 m0, s93, 0
    s_nop 0
    s_add_u32 s92, s83, 549376
    buffer_load_dwordx4 v7, s[48:51], s92 offen offset:0 sc1 lds
    buffer_load_dwordx4 v7, s[48:51], s92 offen offset:1024 sc1 lds
    buffer_load_dwordx4 v7, s[48:51], s92 offen offset:2048 sc1 lds
    buffer_load_dwordx4 v7, s[48:51], s92 offen offset:3072 sc1 lds
SK_19:
    s_add_u32 m0, s93, 4096
    s_add_u32 s92, s83, 553472
    buffer_load_dwordx4 v7, s[48:51], s92 offen offset:0 sc1 lds
    buffer_load_dwordx4 v7, s[48:51], s92 offen offset:1024 sc1 lds
    buffer_load_dword v13, v12, s[48:51], 0 offen sc1
    s_add_u32 m0, s93, 24576
    s_add_u32 s92, s83, 573952
    buffer_load_dwordx4 v7, s[48:51], s92 offen offset:0 sc1 lds
    buffer_load_dwordx4 v7, s[48:51], s92 offen offset:1024 sc1 lds
    s_waitcnt vmcnt(2)
    v_cmp_ne_u32 s[64:65], s59, v13
    s_nop 0
    s_cmp_eq_u64 s[64:65], 0
    s_cbranch_scc1 L_PHD
    s_mov_b32 s66, 0
L_PHL:
    s_add_u32 s66, s66, 1
    s_cmp_gt_u32 s66, 0x40000
    s_cbranch_scc1 L_PHD
L_PHF:
    buffer_load_dword v13, v12, s[48:51], 0 offen sc1
    s_waitcnt vmcnt(0)
    v_cmp_ne_u32 s[64:65], s59, v13
    s_nop 0
    s_cmp_eq_u64 s[64:65], 0
    s_cbranch_scc0 L_PHL
L_PHD:
    s_nop 0
    buffer_load_dwordx4 v[24:27], v7, s[48:51], s85 offen offset:0 sc1
    buffer_load_dwordx4 v[28:31], v7, s[48:51], s85 offen offset:1024 sc1
    buffer_load_dwordx4 v7, s[48:51], s92 offen offset:2048 sc1 lds
    buffer_load_dwordx4 v[32:35], v7, s[48:51], s85 offen offset:2048 sc1
    buffer_load_dwordx4 v[36:39], v7, s[48:51], s85 offen offset:3072 sc1
    s_add_u32 s85, s85, 4096
    buffer_load_dwordx4 v7, s[48:51], s92 offen offset:3072 sc1 lds
    buffer_load_dwordx4 v[40:43], v7, s[48:51], s85 offen offset:0 sc1
    buffer_load_dwordx4 v[44:47], v7, s[48:51], s85 offen offset:1024 sc1
    s_add_u32 m0, s93, 28672
    s_add_u32 s92, s83, 578048
    buffer_load_dwordx4 v7, s[48:51], s92 offen offset:0 sc1 lds
    s_barrier
    s_nop 0
    ds_read_b128 v[200:203], v253 offset:0
    ds_read_b128 v[204:207], v253 offset:896
    ds_read_b128 v[208:211], v253 offset:1792
    ds_read_b128 v[212:215], v253 offset:2688
    ds_read_b128 v[216:219], v253 offset:3584
    ds_read_b128 v[220:223], v253 offset:4480
    s_waitcnt vmcnt(8) lgkmcnt(5)
    v_mfma_f32_32x32x16_bf16 v[136:151], v[200:203], v[24:27], 0
    buffer_load_dwordx4 v[48:51], v7, s[48:51], s85 offen offset:2048 sc1
    ds_read_b128 v[224:227], v253 offset:5376
    s_waitcnt lgkmcnt(5)
    v_mfma_f32_32x32x16_bf16 v[152:167], v[24:27], v[204:207], 0
    ds_read_b128 v[228:231], v253 offset:6272
    s_cmp_lt_u32 s58, 7
    s_cselect_b64 vcc, 1, 0
    ds_read_b64_tr_b16 a[248:249], v244 offset:0
    s_waitcnt vmcnt(8) lgkmcnt(6)
    v_mfma_f32_32x32x16_bf16 v[136:151], v[208:211], v[28:31], v[136:151]
    buffer_load_dwordx4 v[52:55], v7, s[48:51], s85 offen offset:3072 sc1
    s_add_u32 s85, s85, 4096
    buffer_load_dwordx4 v7, s[48:51], s92 offen offset:1024 sc1 lds
    ds_read_b128 v[200:203], v253 offset:7168
    s_waitcnt lgkmcnt(6)
    v_mfma_f32_32x32x16_bf16 v[152:167], v[28:31], v[212:215], v[152:167]
    ds_read_b128 v[204:207], v253 offset:8064
    ds_read_b64_tr_b16 a[250:251], v244 offset:448
    ds_read_b64_tr_b16 a[252:253], v244 offset:896
    ds_read_b64_tr_b16 a[254:255], v244 offset:1344
    s_waitcnt vmcnt(8) lgkmcnt(9)
    v_mfma_f32_32x32x16_bf16 v[136:151], v[216:219], v[32:35], v[136:151]
    buffer_load_dwordx4 v[56:59], v7, s[48:51], s85 offen offset:0 sc1
    ds_read_b128 v[208:211], v253 offset:8960
    s_waitcnt lgkmcnt(9)
    v_mfma_f32_32x32x16_bf16 v[152:167], v[32:35], v[220:223], v[152:167]
    ds_read_b128 v[212:215], v253 offset:9856
    v_mov_b32 v244, 0x3f803f80
    v_mov_b32_e64 v245, v244
    s_mov_b32 exec_lo, 0x10000000
    s_mov_b32 exec_hi, 0x10000000
    ds_write_b64 v233, v[244:245] offset:0
    ds_write_b64 v233, v[244:245] offset:8
    ds_write_b64 v233, v[244:245] offset:512
    ds_write_b64 v233, v[244:245] offset:520
    s_mov_b64 exec, -1
    s_waitcnt vmcnt(8) lgkmcnt(11)
    v_mfma_f32_32x32x16_bf16 v[136:151], v[224:227], v[36:39], v[136:151]
    buffer_load_dwordx4 v[60:63], v7, s[48:51], s85 offen offset:1024 sc1
    s_mov_b32 m0, 49152
    s_add_u32 s92, s82, 598528
    buffer_load_dwordx4 v7, s[48:51], s92 offen sc1 lds
    ds_read_b128 v[216:219], v253 offset:10752
    v_mfma_f32_32x32x16_bf16 v[152:167], v[36:39], v[228:231], v[152:167]
    ds_read_b128 v[220:223], v253 offset:11648
    s_lshl_b32 s60, s52, 6
    v_add_u32 v240, s60, v0
    v_min_u32 v240, 223, v240
    s_waitcnt vmcnt(8) lgkmcnt(7)
    v_mfma_f32_32x32x16_bf16 v[136:151], v[200:203], v[40:43], v[136:151]
    buffer_load_dwordx4 v[64:67], v7, s[48:51], s85 offen offset:2048 sc1
    ds_read_b128 v[224:227], v253 offset:12544
    v_mfma_f32_32x32x16_bf16 v[152:167], v[40:43], v[204:207], v[152:167]
    ds_read_b128 v[228:231], v253 offset:13440
    v_subrev_u32 v4, 112, v240
    v_min_u32 v4, v4, v240
    v_sub_u32 v5, v240, v4
    s_waitcnt vmcnt(8)
    v_mfma_f32_32x32x16_bf16 v[136:151], v[208:211], v[44:47], v[136:151]
    buffer_load_dwordx4 v[68:71], v7, s[48:51], s85 offen offset:3072 sc1
    s_add_u32 s85, s85, 4096
    buffer_load_dwordx4 v[72:75], v7, s[48:51], s85 offen offset:0 sc1
    ds_read_b128 v[200:203], v253 offset:14336
    s_waitcnt lgkmcnt(5)
    v_mfma_f32_32x32x16_bf16 v[152:167], v[44:47], v[212:215], v[152:167]
    ds_read_b128 v[204:207], v253 offset:15232
    v_lshlrev_b32 v240, 4, v240
    v_lshl_add_u32 v241, v5, 5, v240
    v_add_u32 v241, 3584, v241
    s_waitcnt vmcnt(8) lgkmcnt(4)
    v_mfma_f32_32x32x16_bf16 v[136:151], v[216:219], v[48:51], v[136:151]
    buffer_load_dwordx4 v[76:79], v7, s[48:51], s85 offen offset:1024 sc1
    s_add_u32 s85, s85, 20480
    ds_read_b128 v[208:211], v253 offset:16128
    v_mfma_f32_32x32x16_bf16 v[152:167], v[48:51], v[220:223], v[152:167]
    ds_read_b128 v[212:215], v253 offset:17024
    v_add_u32 v240, 5376, v240
    v_lshrrev_b32 v242, 3, v4
    v_lshlrev_b32 v242, 6, v242
    s_waitcnt vmcnt(8) lgkmcnt(4)
    v_mfma_f32_32x32x16_bf16 v[136:151], v[224:227], v[52:55], v[136:151]
    buffer_load_dwordx4 v[80:83], v7, s[48:51], s85 offen offset:0 sc1
    buffer_load_dwordx4 v[84:87], v7, s[48:51], s85 offen offset:1024 sc1
    ds_read_b128 v[216:219], v253 offset:17920
    v_mfma_f32_32x32x16_bf16 v[152:167], v[52:55], v[228:231], v[152:167]
    ds_read_b128 v[220:223], v253 offset:18816
    v_lshl_add_u32 v242, v5, 3, v242
    v_and_b32_e64 v5, 3, v4
    v_lshl_add_u32 v242, v5, 4, v242
    s_waitcnt vmcnt(8) lgkmcnt(4)
    v_mfma_f32_32x32x16_bf16 v[136:151], v[200:203], v[56:59], v[136:151]
    buffer_load_dwordx4 v[88:91], v7, s[48:51], s85 offen offset:2048 sc1
    ds_read_b128 v[224:227], v253 offset:19712
    v_mfma_f32_32x32x16_bf16 v[152:167], v[56:59], v[204:207], v[152:167]
    ds_read_b128 v[228:231], v253 offset:20608
    v_bfe_u32 v5, v4, 2, 1
    v_lshl_add_u32 v242, v5, 3, v242
    v_add_u32 v242, 115712, v242
    s_waitcnt vmcnt(8) lgkmcnt(5)
    v_mfma_f32_32x32x16_bf16 v[136:151], v[208:211], v[60:63], v[136:151]
    buffer_load_dwordx4 v[92:95], v7, s[48:51], s85 offen offset:3072 sc1
    s_add_u32 s85, s85, 4096
    buffer_load_dwordx4 v[96:99], v7, s[48:51], s85 offen offset:0 sc1
    ds_read_b128 v[200:203], v253 offset:21504
    s_waitcnt lgkmcnt(5)
    v_mfma_f32_32x32x16_bf16 v[152:167], v[60:63], v[212:215], v[152:167]
    ds_read_b128 v[204:207], v253 offset:22400
    s_lshl2_add_u32 s60, s56, s52
    s_lshl_b32 s60, s60, 6
    s_add_u32 s60, s60, s55
    s_waitcnt vmcnt(8) lgkmcnt(4)
    v_mfma_f32_32x32x16_bf16 v[136:151], v[216:219], v[64:67], v[136:151]
    buffer_load_dwordx4 v[100:103], v7, s[48:51], s85 offen offset:1024 sc1
    s_barrier
    ds_read_b128 v[208:211], v253 offset:23296
    v_mfma_f32_32x32x16_bf16 v[152:167], v[64:67], v[220:223], v[152:167]
    ds_read_b128 v[212:215], v253 offset:24192
    s_lshl_b32 s60, s60, 9
    s_add_u32 s75, s60, 23068672
    s_and_b32 s60, s54, 15
    s_waitcnt vmcnt(8) lgkmcnt(4)
    v_mfma_f32_32x32x16_bf16 v[136:151], v[224:227], v[68:71], v[136:151]
    buffer_load_dwordx4 v[104:107], v7, s[48:51], s85 offen offset:2048 sc1
    ds_read_b128 v[216:219], v253 offset:25088
    v_mfma_f32_32x32x16_bf16 v[152:167], v[68:71], v[228:231], v[152:167]
    ds_read_b128 v[220:223], v253 offset:25984
    s_lshl4_add_u32 s60, s55, s60
    s_lshl_b32 s61, s52, 7
    s_lshl_b32 s62, s60, 13
    s_waitcnt vmcnt(8) lgkmcnt(5)
    v_mfma_f32_32x32x16_bf16 v[136:151], v[200:203], v[72:75], v[136:151]
    buffer_load_dwordx4 v[108:111], v7, s[48:51], s85 offen offset:3072 sc1
    s_add_u32 s85, s85, 4096
    ds_read_b128 v[224:227], v253 offset:26880
    s_waitcnt lgkmcnt(5)
    v_mfma_f32_32x32x16_bf16 v[152:167], v[72:75], v[204:207], v[152:167]
    ds_read_b128 v[228:231], v253 offset:27776
    s_add_u32 s62, s62, s61
    s_add_u32 s76, s62, 23068672
    s_lshl_b32 s62, s60, 9
    s_waitcnt vmcnt(8) lgkmcnt(4)
    v_mfma_f32_32x32x16_bf16 v[136:151], v[208:211], v[76:79], v[136:151]
    buffer_load_dwordx4 v[112:115], v7, s[48:51], s85 offen offset:0 sc1
    ds_read_b128 v[200:203], v253 offset:28672
    v_mfma_f32_32x32x16_bf16 v[152:167], v[76:79], v[212:215], v[152:167]
    ds_read_b128 v[204:207], v253 offset:29568
    s_add_u32 s62, s62, s61
    s_add_u32 s77, s62, 262144
    s_mov_b32 s63, s56
    s_waitcnt vmcnt(8) lgkmcnt(4)
    v_mfma_f32_32x32x16_bf16 v[136:151], v[216:219], v[80:83], v[136:151]
    buffer_load_dwordx4 v[116:119], v7, s[48:51], s85 offen offset:1024 sc1
    ds_read_b128 v[208:211], v253 offset:30464
    v_mfma_f32_32x32x16_bf16 v[152:167], v[80:83], v[220:223], v[152:167]
    ds_read_b128 v[212:215], v253 offset:31360
    s_lshl2_add_u32 s60, s63, s52
    s_lshl_b32 s60, s60, 11
    s_add_u32 s78, s60, 262144
    s_waitcnt vmcnt(8) lgkmcnt(5)
    v_mfma_f32_32x32x16_bf16 v[136:151], v[224:227], v[84:87], v[136:151]
    buffer_load_dwordx4 v[120:123], v7, s[48:51], s85 offen offset:2048 sc1
    ds_read_b128 v[216:219], v253 offset:32256
    s_waitcnt lgkmcnt(5)
    v_mfma_f32_32x32x16_bf16 v[152:167], v[84:87], v[228:231], v[152:167]
    ds_read_b128 v[220:223], v253 offset:33152
    s_lshl2_add_u32 s61, s55, s52
    s_lshl_b32 s61, s61, 16
    s_lshl_b32 s60, s63, 10
    s_waitcnt vmcnt(8) lgkmcnt(5)
    v_mfma_f32_32x32x16_bf16 v[136:151], v[200:203], v[88:91], v[136:151]
    buffer_load_dwordx4 v[124:127], v7, s[48:51], s85 offen offset:3072 sc1
    s_add_u32 s85, s85, 4096
    ds_read_b128 v[224:227], v253 offset:34048
    s_waitcnt lgkmcnt(5)
    v_mfma_f32_32x32x16_bf16 v[152:167], v[88:91], v[204:207], v[152:167]
    ds_read_b128 v[228:231], v253 offset:34944
    s_add_u32 s60, s60, s61
    s_add_u32 s79, s60, 2097152
    s_lshl_b32 s60, s55, 8
    s_waitcnt vmcnt(8) lgkmcnt(4)
    v_mfma_f32_32x32x16_bf16 v[136:151], v[208:211], v[92:95], v[136:151]
    buffer_load_dwordx4 v[128:131], v7, s[48:51], s85 offen offset:0 sc1
    ds_read_b128 v[200:203], v253 offset:35840
    v_mfma_f32_32x32x16_bf16 v[152:167], v[92:95], v[212:215], v[152:167]
    ds_read_b128 v[204:207], v253 offset:36736
    s_lshl2_add_u32 s80, s63, s60
    s_add_u32 s80, s80, 16384
    s_waitcnt vmcnt(8) lgkmcnt(5)
    v_mfma_f32_32x32x16_bf16 v[136:151], v[216:219], v[96:99], v[136:151]
    buffer_load_dwordx4 v[132:135], v7, s[48:51], s85 offen offset:1024 sc1
    ds_read_b128 v[208:211], v253 offset:37632
    s_waitcnt lgkmcnt(5)
    v_mfma_f32_32x32x16_bf16 v[152:167], v[96:99], v[220:223], v[152:167]
    ds_read_b128 v[212:215], v253 offset:38528
    s_waitcnt vmcnt(8) lgkmcnt(5)
    v_mfma_f32_32x32x16_bf16 v[136:151], v[224:227], v[100:103], v[136:151]
    ds_read_b128 v[216:219], v253 offset:39424
    s_waitcnt lgkmcnt(5)
    v_mfma_f32_32x32x16_bf16 v[152:167], v[100:103], v[228:231], v[152:167]
    ds_read_b128 v[220:223], v253 offset:40320
    s_waitcnt vmcnt(7) lgkmcnt(5)
    v_mfma_f32_32x32x16_bf16 v[136:151], v[200:203], v[104:107], v[136:151]
    ds_read_b128 v[224:227], v253 offset:41216
    s_waitcnt lgkmcnt(5)
    v_mfma_f32_32x32x16_bf16 v[152:167], v[104:107], v[204:207], v[152:167]
    ds_read_b128 v[228:231], v253 offset:42112
    s_waitcnt vmcnt(6) lgkmcnt(5)
    v_mfma_f32_32x32x16_bf16 v[136:151], v[208:211], v[108:111], v[136:151]
    ds_read_b128 v[200:203], v253 offset:43008
    s_waitcnt lgkmcnt(5)
    v_mfma_f32_32x32x16_bf16 v[152:167], v[108:111], v[212:215], v[152:167]
    ds_read_b128 v[204:207], v253 offset:43904
    s_waitcnt vmcnt(5) lgkmcnt(5)
    v_mfma_f32_32x32x16_bf16 v[136:151], v[216:219], v[112:115], v[136:151]
    ds_read_b128 v[208:211], v253 offset:44800
    s_waitcnt lgkmcnt(5)
    v_mfma_f32_32x32x16_bf16 v[152:167], v[112:115], v[220:223], v[152:167]
    ds_read_b128 v[212:215], v253 offset:45696
    s_add_u32 m0, s93, 116736
    s_add_u32 s92, s83, 524288
    buffer_load_dwordx4 v7, s[48:51], s92 offen offset:0 sc1 lds
    buffer_load_dwordx4 v7, s[48:51], s92 offen offset:1024 sc1 lds
    buffer_load_dwordx4 v7, s[48:51], s92 offen offset:2048 sc1 lds
    buffer_load_dwordx4 v7, s[48:51], s92 offen offset:3072 sc1 lds
    s_waitcnt vmcnt(8) lgkmcnt(5)
    v_mfma_f32_32x32x16_bf16 v[136:151], v[224:227], v[116:119], v[136:151]
    ds_read_b128 v[216:219], v253 offset:46592
    s_waitcnt lgkmcnt(5)
    v_mfma_f32_32x32x16_bf16 v[152:167], v[116:119], v[228:231], v[152:167]
    ds_read_b128 v[220:223], v253 offset:47488
    s_waitcnt vmcnt(7) lgkmcnt(5)
    v_mfma_f32_32x32x16_bf16 v[136:151], v[200:203], v[120:123], v[136:151]
    ds_read_b128 v[224:227], v253 offset:48384
    s_waitcnt lgkmcnt(5)
    v_mfma_f32_32x32x16_bf16 v[152:167], v[120:123], v[204:207], v[152:167]
    ds_read_b128 v[228:231], v253 offset:49280
    s_waitcnt vmcnt(6) lgkmcnt(5)
    v_mfma_f32_32x32x16_bf16 v[136:151], v[208:211], v[124:127], v[136:151]
    s_waitcnt lgkmcnt(4)
    v_mfma_f32_32x32x16_bf16 v[152:167], v[124:127], v[212:215], v[152:167]
    s_waitcnt vmcnt(5) lgkmcnt(3)
    v_mfma_f32_32x32x16_bf16 v[136:151], v[216:219], v[128:131], v[136:151]
    s_waitcnt lgkmcnt(2)
    v_mfma_f32_32x32x16_bf16 v[152:167], v[128:131], v[220:223], v[152:167]
    s_add_u32 m0, s93, 120832
    s_add_u32 s92, s83, 528384
    buffer_load_dwordx4 v7, s[48:51], s92 offen offset:0 sc1 lds
    buffer_load_dwordx4 v7, s[48:51], s92 offen offset:1024 sc1 lds
    s_mov_b32 m0, 141312
    s_add_u32 s92, s82, 548864
    s_mov_b32 exec_hi, 0
    buffer_load_dwordx4 v7, s[48:51], s92 offen sc1 lds
    s_mov_b32 exec_hi, -1
    s_waitcnt vmcnt(7) lgkmcnt(1)
    v_mfma_f32_32x32x16_bf16 v[136:151], v[224:227], v[132:135], v[136:151]
    s_waitcnt lgkmcnt(0)
    v_mfma_f32_32x32x16_bf16 v[152:167], v[132:135], v[228:231], v[152:167]
    s_barrier
    s_nop 8
    s_nop 0
    v_cvt_pk_bf16_f32 v200, v136, v137
    v_cvt_pk_bf16_f32 v201, v138, v139
    v_cvt_pk_bf16_f32 v202, v140, v141
    v_cvt_pk_bf16_f32 v203, v142, v143
    v_cvt_pk_bf16_f32 v204, v144, v145
    v_cvt_pk_bf16_f32 v205, v146, v147
    v_mfma_f32_32x32x16_bf16 v[168:183], a[248:251], v[200:203], 0
    v_cvt_pk_bf16_f32 v206, v148, v149
    v_cvt_pk_bf16_f32 v207, v150, v151
    s_mov_b32 s64, 0x3fb8aa3b
    s_mov_b32 s65, 0x3fb8aa3b
    v_mfma_f32_32x32x16_bf16 v[168:183], a[252:255], v[204:207], v[168:183]
    v_cvt_pk_bf16_f32 v208, v152, v153
    v_cvt_pk_bf16_f32 v209, v154, v155
    v_cvt_pk_bf16_f32 v210, v156, v157
    v_cvt_pk_bf16_f32 v211, v158, v159
    v_cvt_pk_bf16_f32 v212, v160, v161
    v_cvt_pk_bf16_f32 v213, v162, v163
    v_cvt_pk_bf16_f32 v214, v164, v165
    v_cvt_pk_bf16_f32 v215, v166, v167
    s_mov_b32 exec_lo, 0xefffffff
    s_mov_b32 exec_hi, 0xefffffff
    ds_write_b128 v233, v[208:211] offset:0
    ds_write_b128 v233, v[212:215] offset:512
    s_mov_b64 exec, -1
    v_max3_f32 v248, v168, v169, v170
    v_min3_f32 v250, v168, v169, v170
    v_max3_f32 v248, v248, v171, v172
    v_min3_f32 v250, v250, v171, v172
    s_cmp_eq_u32 s58, 7
    s_cselect_b32 s90, s57, s58
    s_mul_i32 s92, s52, s86
    s_lshl4_add_u32 s90, s90, s92
    s_lshl_b32 s90, s90, 3
    s_lshl_b32 s86, s86, 5
    s_lshl_b32 s92, s52, 10
    s_add_u32 m0, s92, 0
    s_nop 0
    buffer_load_dwordx4 v14, s[8:11], s90 offen lds
    v_max3_f32 v248, v248, v173, v174
    v_min3_f32 v250, v250, v173, v174
    v_max3_f32 v248, v248, v175, v176
    v_min3_f32 v250, v250, v175, v176
    v_max3_f32 v248, v248, v177, v178
    v_min3_f32 v250, v250, v177, v178
    v_max_f32 v248, v248, v179
    v_min_f32 v250, v250, v179
    v_max3_f32 v249, v248, v180, v181
    v_min3_f32 v251, v250, v180, v181
    s_add_u32 m0, s92, 4096
    s_add_u32 s90, s90, s86
    s_nop 0
    buffer_load_dwordx4 v14, s[8:11], s90 offen lds
    v_max3_f32 v249, v249, v182, v183
    v_min3_f32 v251, v251, v182, v183
    v_cndmask_b32 v248, v249, v248, s[68:69]
    v_cndmask_b32_e64 v250, -v251, -v250, s[68:69]
    v_mov_b32 v6, 0xff800000
    s_nop 0
    v_permlane32_swap_b32 v248, v250
    v_max_f32_e64 v248, v248, v250
    v_mul_f32 v248, 0xbfb8aa3b, v248
    v_mov_b32_e64 v250, v248
    s_add_u32 m0, s92, 8192
    s_add_u32 s90, s90, s86
    buffer_load_dwordx4 v14, s[8:11], s90 offen lds
    v_permlane32_swap_b32 v248, v250
    v_cndmask_b32 v249, v248, v6, s[68:69]
    v_cndmask_b32 v251, v250, v6, s[68:69]
    v_pk_fma_f32 v[184:185], v[168:169], s[64:65], v[248:249] op_sel_hi:[1,1,0]
    v_pk_fma_f32 v[168:169], v[168:169], s[64:65], v[250:251] op_sel_hi:[1,1,0] neg_lo:[1,0,0] neg_hi:[1,0,0]
    v_pk_fma_f32 v[186:187], v[170:171], s[64:65], v[248:249] op_sel_hi:[1,1,0]
    v_pk_fma_f32 v[170:171], v[170:171], s[64:65], v[250:251] op_sel_hi:[1,1,0] neg_lo:[1,0,0] neg_hi:[1,0,0]
    v_pk_fma_f32 v[188:189], v[172:173], s[64:65], v[248:249] op_sel_hi:[1,1,0]
    v_pk_fma_f32 v[172:173], v[172:173], s[64:65], v[250:251] op_sel_hi:[1,1,0] neg_lo:[1,0,0] neg_hi:[1,0,0]
    v_pk_fma_f32 v[190:191], v[174:175], s[64:65], v[248:249] op_sel_hi:[1,1,0]
    s_add_u32 m0, s92, 12288
    s_add_u32 s90, s90, s86
    s_nop 0
    buffer_load_dwordx4 v14, s[8:11], s90 offen lds
    v_pk_fma_f32 v[174:175], v[174:175], s[64:65], v[250:251] op_sel_hi:[1,1,0] neg_lo:[1,0,0] neg_hi:[1,0,0]
    v_pk_fma_f32 v[192:193], v[176:177], s[64:65], v[248:249] op_sel_hi:[1,1,0]
    v_pk_fma_f32 v[176:177], v[176:177], s[64:65], v[250:251] op_sel_hi:[1,1,0] neg_lo:[1,0,0] neg_hi:[1,0,0]
    v_pk_fma_f32 v[194:195], v[178:179], s[64:65], v[248:249] op_sel_hi:[1,1,0]
    v_pk_fma_f32 v[178:179], v[178:179], s[64:65], v[250:251] op_sel_hi:[1,1,0] neg_lo:[1,0,0] neg_hi:[1,0,0]
    v_pk_fma_f32 v[196:197], v[180:181], s[64:65], v[248:249] op_sel:[0,0,1] op_sel_hi:[1,1,1]
    v_pk_fma_f32 v[180:181], v[180:181], s[64:65], v[250:251] op_sel:[0,0,1] op_sel_hi:[1,1,1] neg_lo:[1,0,0] neg_hi:[1,0,0]
    v_pk_fma_f32 v[198:199], v[182:183], s[64:65], v[248:249] op_sel:[0,0,1] op_sel_hi:[1,1,1]
    v_pk_fma_f32 v[182:183], v[182:183], s[64:65], v[250:251] op_sel:[0,0,1] op_sel_hi:[1,1,1] neg_lo:[1,0,0] neg_hi:[1,0,0]
    s_add_u32 m0, s92, 16384
    s_add_u32 s90, s90, s86
    buffer_load_dwordx4 v14, s[8:11], s90 offen lds
    v_exp_f32 v184, v184
    v_exp_f32 v185, v185
    v_exp_f32 v186, v186
    v_exp_f32 v187, v187
    v_exp_f32 v188, v188
    v_exp_f32 v189, v189
    v_exp_f32 v190, v190
    v_exp_f32 v191, v191
    v_exp_f32 v192, v192
    v_exp_f32_e64 v193, v193
    s_add_u32 m0, s92, 20480
    s_add_u32 s90, s90, s86
    buffer_load_dwordx4 v14, s[8:11], s90 offen lds
    v_exp_f32 v194, v194
    v_exp_f32 v195, v195
    v_exp_f32 v196, v196
    v_exp_f32 v197, v197
    v_exp_f32 v198, v198
    v_exp_f32 v199, v199
    v_exp_f32 v168, v168
    v_exp_f32 v169, v169
    v_exp_f32 v170, v170
    s_add_u32 m0, s92, 24576
    s_add_u32 s90, s90, s86
    buffer_load_dwordx4 v14, s[8:11], s90 offen lds
    v_exp_f32 v171, v171
    v_exp_f32 v172, v172
    v_exp_f32 v173, v173
    v_exp_f32 v174, v174
    v_exp_f32 v175, v175
    v_exp_f32 v176, v176
    v_exp_f32 v177, v177
    v_exp_f32 v178, v178
    v_exp_f32 v179, v179
    v_exp_f32_e64 v180, v180
    s_add_u32 m0, s92, 28672
    s_add_u32 s90, s90, s86
    buffer_load_dwordx4 v14, s[8:11], s90 offen lds
    v_exp_f32 v181, v181
    v_exp_f32 v182, v182
    v_exp_f32 v183, v183
    v_pk_add_f32 v[248:249], v[184:185], v[186:187]
    v_pk_add_f32 v[250:251], v[168:169], v[170:171]
    v_pk_add_f32 v[248:249], v[248:249], v[188:189]
    v_pk_add_f32 v[250:251], v[250:251], v[172:173]
    v_pk_add_f32 v[248:249], v[248:249], v[190:191]
    v_pk_add_f32 v[250:251], v[250:251], v[174:175]
    s_add_u32 m0, s92, 32768
    s_add_u32 s90, s90, s86
    s_nop 0
    buffer_load_dwordx4 v14, s[8:11], s90 offen lds
    v_pk_add_f32 v[248:249], v[248:249], v[192:193]
    v_pk_add_f32 v[250:251], v[250:251], v[176:177]
    v_pk_add_f32 v[248:249], v[248:249], v[194:195]
    v_pk_add_f32 v[250:251], v[250:251], v[178:179]
    v_pk_add_f32 v[248:249], v[248:249], v[196:197]
    v_pk_add_f32 v[250:251], v[250:251], v[180:181]
    v_pk_add_f32 v[248:249], v[248:249], v[198:199]
    v_pk_add_f32 v[250:251], v[250:251], v[182:183]
    v_add_f32 v248, v248, v249
    v_add_f32 v250, v250, v251
    s_add_u32 m0, s92, 36864
    s_add_u32 s90, s90, s86
    buffer_load_dwordx4 v14, s[8:11], s90 offen lds
    v_permlane32_swap_b32 v248, v250
    v_add_f32 v248, v248, v250
    v_rcp_f32 v248, v248
    s_nop 0
    v_mov_b32 v250, v248
    s_nop 1
    v_permlane32_swap_b32 v248, v250
    v_pk_mul_f32 v[184:185], v[184:185], v[248:249] op_sel_hi:[1,0]
    v_pk_mul_f32 v[186:187], v[186:187], v[248:249] op_sel_hi:[1,0]
    v_pk_mul_f32 v[188:189], v[188:189], v[248:249] op_sel_hi:[1,0]
    v_pk_mul_f32 v[190:191], v[190:191], v[248:249] op_sel_hi:[1,0]
    v_pk_mul_f32 v[192:193], v[192:193], v[248:249] op_sel_hi:[1,0]
    v_pk_mul_f32 v[194:195], v[194:195], v[248:249] op_sel_hi:[1,0]
    v_pk_mul_f32 v[196:197], v[196:197], v[248:249] op_sel_hi:[1,0]
    v_pk_mul_f32 v[198:199], v[198:199], v[248:249] op_sel_hi:[1,0]
    v_cvt_pk_bf16_f32 v216, v184, v185
    v_cvt_pk_bf16_f32 v217, v186, v187
    v_cvt_pk_bf16_f32 v218, v188, v189
    v_cvt_pk_bf16_f32 v219, v190, v191
    v_cvt_pk_bf16_f32 v220, v192, v193
    v_cvt_pk_bf16_f32 v221, v194, v195
    v_cvt_pk_bf16_f32 v222, v196, v197
    v_cvt_pk_bf16_f32 v223, v198, v199
    ds_write_b64 v232, v[216:217] offset:0
    ds_write_b64 v232, v[218:219] offset:16
    ds_write_b64 v232, v[220:221] offset:32
    ds_write_b64 v232, v[222:223] offset:48
    v_pk_mul_f32 v[168:169], v[168:169], v[250:251] op_sel_hi:[1,0]
    v_pk_mul_f32 v[170:171], v[170:171], v[250:251] op_sel_hi:[1,0]
    v_pk_mul_f32 v[172:173], v[172:173], v[250:251] op_sel_hi:[1,0]
    v_pk_mul_f32 v[174:175], v[174:175], v[250:251] op_sel_hi:[1,0]
    v_pk_mul_f32 v[176:177], v[176:177], v[250:251] op_sel_hi:[1,0]
    v_pk_mul_f32 v[178:179], v[178:179], v[250:251] op_sel_hi:[1,0]
    v_pk_mul_f32 v[180:181], v[180:181], v[250:251] op_sel_hi:[1,0]
    v_pk_mul_f32 v[182:183], v[182:183], v[250:251] op_sel_hi:[1,0]
    v_cvt_pk_bf16_f32 v224, v168, v169
    v_cvt_pk_bf16_f32 v225, v170, v171
    v_cvt_pk_bf16_f32 v226, v172, v173
    v_cvt_pk_bf16_f32 v227, v174, v175
    v_cvt_pk_bf16_f32 v228, v176, v177
    v_cvt_pk_bf16_f32 v229, v178, v179
    v_cvt_pk_bf16_f32 v230, v180, v181
    v_cvt_pk_bf16_f32 v231, v182, v183
    ds_write_b64 v232, v[224:225] offset:64
    ds_write_b64 v232, v[226:227] offset:80
    ds_write_b64 v232, v[228:229] offset:96
    ds_write_b64 v232, v[230:231] offset:112
    v_mov_b32_e64 v146, s59
    v_mov_b32 v147, s59
    v_mov_b32 v150, s59
    v_mov_b32 v151, s59
    s_waitcnt vmcnt(10)
    s_waitcnt lgkmcnt(0)
    s_barrier
    ds_read_b64_tr_b16 v[152:153], v234 offset:0
    ds_read_b64_tr_b16 v[154:155], v234 offset:1088
    ds_read_b128 v[168:171], v235 offset:33280
    ds_read_b128 v[172:175], v235 offset:34304
    ds_read_b64_tr_b16 v[156:157], v234 offset:4352
    ds_read_b64_tr_b16 v[158:159], v234 offset:5440
    ds_read_b128 v[176:179], v235 offset:35328
    ds_read_b128 v[180:183], v235 offset:36352
    ds_read_b64_tr_b16 v[160:161], v234 offset:8704
    ds_read_b64_tr_b16 v[162:163], v234 offset:9792
    ds_read_b128 v[184:187], v235 offset:37376
    ds_read_b128 v[188:191], v235 offset:38400
    ds_read_b64_tr_b16 v[164:165], v234 offset:13056
    ds_read_b64_tr_b16 v[166:167], v234 offset:14144
    ds_read_b128 v[192:195], v235 offset:39424
    ds_read_b128 v[196:199], v235 offset:40448
    ds_read_b128 v[200:203], v247 offset:0
    ds_read_b128 v[208:211], v247 offset:896
    ds_read_b128 v[216:219], v247 offset:1792
    s_waitcnt lgkmcnt(15)
    v_mfma_f32_16x16x32_bf16 v[136:139], v[152:155], v[168:171], 0
    s_waitcnt lgkmcnt(15)
    v_mfma_f32_16x16x32_bf16 v[140:143], v[152:155], v[172:175], 0
    s_waitcnt lgkmcnt(12)
    v_mfma_f32_16x16x32_bf16 v[136:139], v[156:159], v[176:179], v[136:139]
    s_waitcnt lgkmcnt(11)
    v_mfma_f32_16x16x32_bf16 v[140:143], v[156:159], v[180:183], v[140:143]
    s_waitcnt lgkmcnt(8)
    v_mfma_f32_16x16x32_bf16 v[136:139], v[160:163], v[184:187], v[136:139]
    s_waitcnt lgkmcnt(7)
    v_mfma_f32_16x16x32_bf16 v[140:143], v[160:163], v[188:191], v[140:143]
    s_waitcnt lgkmcnt(4)
    v_mfma_f32_16x16x32_bf16 v[136:139], v[164:167], v[192:195], v[136:139]
    s_waitcnt lgkmcnt(3)
    v_mfma_f32_16x16x32_bf16 v[140:143], v[164:167], v[196:199], v[140:143]
    s_nop 5
    s_nop 0
    v_cvt_pk_bf16_f32 v144, v136, v137
    v_cvt_pk_bf16_f32 v145, v138, v139
    buffer_store_dwordx4 v[144:147], v236, s[48:51], s75 offen offset:0 sc1
    v_cvt_pk_bf16_f32 v148, v140, v141
    v_cvt_pk_bf16_f32 v149, v142, v143
    buffer_store_dwordx4 v[148:151], v236, s[48:51], s75 offen offset:256 sc1
    s_add_u32 s63, s76, 4096
    s_waitcnt lgkmcnt(0)
    v_mfma_f32_32x32x16_bf16 v[152:167], v[200:203], v[24:27], 0
    ds_read_b128 v[224:227], v247 offset:2688
    v_mfma_f32_32x32x16_bf16 v[152:167], v[208:211], v[28:31], v[152:167]
    ds_read_b128 v[200:203], v247 offset:3584
    v_mfma_f32_32x32x16_bf16 v[152:167], v[216:219], v[32:35], v[152:167]
    ds_read_b128 v[208:211], v247 offset:4480
    s_waitcnt lgkmcnt(2)
    v_mfma_f32_32x32x16_bf16 v[152:167], v[224:227], v[36:39], v[152:167]
    ds_read_b128 v[216:219], v247 offset:5376
    s_waitcnt lgkmcnt(2)
    v_mfma_f32_32x32x16_bf16 v[152:167], v[200:203], v[40:43], v[152:167]
    ds_read_b128 v[224:227], v247 offset:6272
    s_barrier
    s_waitcnt lgkmcnt(2)
    v_mfma_f32_32x32x16_bf16 v[152:167], v[208:211], v[44:47], v[152:167]
    ds_read_b128 v[200:203], v247 offset:7168
    s_waitcnt lgkmcnt(2)
    v_mfma_f32_32x32x16_bf16 v[152:167], v[216:219], v[48:51], v[152:167]
    ds_read_b128 v[208:211], v247 offset:8064
    s_waitcnt lgkmcnt(2)
    v_mfma_f32_32x32x16_bf16 v[152:167], v[224:227], v[52:55], v[152:167]
    ds_read_b128 v[216:219], v247 offset:8960
    s_waitcnt lgkmcnt(2)
    v_mfma_f32_32x32x16_bf16 v[152:167], v[200:203], v[56:59], v[152:167]
    ds_read_b128 v[224:227], v247 offset:9856
    s_mov_b32 s73, 4096
    s_lshl2_add_u32 s72, s57, s52
    v_bfe_u32 v5, v0, 3, 1
    s_waitcnt lgkmcnt(2)
    v_mfma_f32_32x32x16_bf16 v[152:167], v[208:211], v[60:63], v[152:167]
    ds_read_b128 v[200:203], v247 offset:10752
    s_waitcnt lgkmcnt(2)
    v_mfma_f32_32x32x16_bf16 v[152:167], v[216:219], v[64:67], v[152:167]
    ds_read_b128 v[208:211], v247 offset:11648
    s_waitcnt lgkmcnt(2)
    v_mfma_f32_32x32x16_bf16 v[152:167], v[224:227], v[68:71], v[152:167]
    ds_read_b128 v[216:219], v247 offset:12544
    s_waitcnt lgkmcnt(2)
    v_mfma_f32_32x32x16_bf16 v[152:167], v[200:203], v[72:75], v[152:167]
    ds_read_b128 v[224:227], v247 offset:13440
    s_waitcnt lgkmcnt(2)
    v_mfma_f32_32x32x16_bf16 v[152:167], v[208:211], v[76:79], v[152:167]
    ds_read_b128 v[200:203], v247 offset:14336
    s_waitcnt lgkmcnt(2)
    v_mfma_f32_32x32x16_bf16 v[152:167], v[216:219], v[80:83], v[152:167]
    ds_read_b128 v[208:211], v247 offset:15232
    s_waitcnt lgkmcnt(2)
    v_mfma_f32_32x32x16_bf16 v[152:167], v[224:227], v[84:87], v[152:167]
    ds_read_b128 v[216:219], v247 offset:16128
    s_waitcnt lgkmcnt(2)
    v_mfma_f32_32x32x16_bf16 v[152:167], v[200:203], v[88:91], v[152:167]
    ds_read_b128 v[224:227], v247 offset:17024
    s_waitcnt lgkmcnt(2)
    v_mfma_f32_32x32x16_bf16 v[152:167], v[208:211], v[92:95], v[152:167]
    ds_read_b128 v[200:203], v247 offset:17920
    s_waitcnt lgkmcnt(2)
    v_mfma_f32_32x32x16_bf16 v[152:167], v[216:219], v[96:99], v[152:167]
    ds_read_b128 v[208:211], v247 offset:18816
    v_and_b32 v4, 7, v0
    v_lshlrev_b32_e64 v4, 7, v4
    v_lshl_add_u32 v4, v5, 15, v4
    s_waitcnt lgkmcnt(2)
    v_mfma_f32_32x32x16_bf16 v[152:167], v[224:227], v[100:103], v[152:167]
    ds_read_b128 v[216:219], v247 offset:19712
    s_waitcnt lgkmcnt(2)
    v_mfma_f32_32x32x16_bf16 v[152:167], v[200:203], v[104:107], v[152:167]
    ds_read_b128 v[224:227], v247 offset:20608
    s_waitcnt lgkmcnt(2)
    v_mfma_f32_32x32x16_bf16 v[152:167], v[208:211], v[108:111], v[152:167]
    ds_read_b128 v[200:203], v247 offset:21504
    s_waitcnt lgkmcnt(2)
    v_mfma_f32_32x32x16_bf16 v[152:167], v[216:219], v[112:115], v[152:167]
    ds_read_b128 v[208:211], v247 offset:22400
    s_waitcnt lgkmcnt(2)
    v_mfma_f32_32x32x16_bf16 v[152:167], v[224:227], v[116:119], v[152:167]
    ds_read_b128 v[216:219], v247 offset:23296
    buffer_load_dwordx4 v[24:27], v237, s[48:51], s76 offen sc1
    buffer_load_dwordx4 v[28:31], v237, s[48:51], s63 offen sc1
    s_waitcnt lgkmcnt(2)
    v_mfma_f32_32x32x16_bf16 v[152:167], v[200:203], v[120:123], v[152:167]
    ds_read_b128 v[224:227], v247 offset:24192
    s_waitcnt lgkmcnt(2)
    v_mfma_f32_32x32x16_bf16 v[152:167], v[208:211], v[124:127], v[152:167]
    s_mov_b64 exec, 0xffff
    buffer_load_dword v254, v4, s[48:51], s79 offen sc1
    s_mov_b64 exec, -1
    s_waitcnt lgkmcnt(1)
    v_mfma_f32_32x32x16_bf16 v[152:167], v[216:219], v[128:131], v[152:167]
    s_waitcnt lgkmcnt(0)
    v_mfma_f32_32x32x16_bf16 v[152:167], v[224:227], v[132:135], v[152:167]
    s_barrier
    s_nop 10
    v_cvt_pk_bf16_f32 v200, v152, v153
    v_cvt_pk_bf16_f32 v201, v154, v155
    v_cvt_pk_bf16_f32 v202, v156, v157
    v_cvt_pk_bf16_f32 v203, v158, v159
    v_cvt_pk_bf16_f32 v204, v160, v161
    v_cvt_pk_bf16_f32 v205, v162, v163
    v_mfma_f32_32x32x16_bf16 v[168:183], a[248:251], v[200:203], 0
    v_cvt_pk_bf16_f32 v206, v164, v165
    v_cvt_pk_bf16_f32 v207, v166, v167
    s_mov_b32 s64, 0x3fb8aa3b
    s_mov_b32 s65, 0x3fb8aa3b
    v_mfma_f32_32x32x16_bf16 v[168:183], a[252:255], v[204:207], v[168:183]
    s_cbranch_vccz SK_20
    s_waitcnt vmcnt(1)
    v_xor_b32_e64 v26, s59, v26
    v_bitop3_b32 v26, v26, v30, s59 bitop3:0xf6
    v_cmp_ne_u32 s[64:65], 0, v26
    s_nop 0
    s_cmp_eq_u64 s[64:65], 0
    s_cbranch_scc1 L_P1D
    s_mov_b32 s66, 0
L_P1L:
    s_add_u32 s66, s66, 1
    s_cmp_gt_u32 s66, 0x40000
    s_cbranch_scc1 L_P1D
L_P1F:
    buffer_load_dwordx4 v[24:27], v237, s[48:51], s76 offen sc1
    buffer_load_dwordx4 v[28:31], v237, s[48:51], s63 offen sc1
    s_waitcnt vmcnt(0)
    v_xor_b32 v26, s59, v26
    v_bitop3_b32 v26, v26, v30, s59 bitop3:0xf6
    v_cmp_ne_u32 s[64:65], 0, v26
    s_nop 0
    s_cmp_eq_u64 s[64:65], 0
    s_cbranch_scc0 L_P1L
L_P1D:
    v_lshlrev_b32 v40, 16, v24
    v_and_b32 v41, s70, v24
    v_lshlrev_b32 v42, 16, v25
    v_and_b32 v43, s70, v25
    v_lshlrev_b32 v24, 16, v28
    v_and_b32 v25, s70, v28
    v_lshlrev_b32 v26, 16, v29
    v_and_b32_e64 v27, s70, v29
    v_pk_add_f32 v[24:25], v[24:25], v[40:41]
    v_pk_add_f32 v[26:27], v[26:27], v[42:43]
    v_mov_b32 v30, s59
    v_mov_b32 v31, s59
    v_permlane32_swap_b32 v24, v26
    v_permlane32_swap_b32 v25, v27
    v_pk_add_f32 v[24:25], v[24:25], v[26:27]
    s_nop 1
    v_permlane16_swap_b32 v24, v25
    v_add_f32 v24, v24, v25
    s_nop 1
    v_add_f32_dpp v24, v24, v24 row_ror:8 row_mask:0xf bank_mask:0xf
    v_mov_b32 v25, v24
    s_nop 1
    v_permlane16_swap_b32_e64 v24, v25
    v_cvt_pk_bf16_f32 v28, v24, v25
    v_mov_b32 v29, v28
    s_nop 1
    v_permlane32_swap_b32_e64 v28, v29
    s_mov_b64 exec, 0xff
    buffer_store_dwordx4 v[28:31], v7, s[48:51], s77 offen sc1
    s_mov_b64 exec, -1
SK_20:
    s_cmp_eq_u32 s58, 7
    s_cbranch_scc0 SK_21
    s_lshl_b32 s60, s52, 5
    v_xor_b32_e64 v2, s60, v8
    v_add_u32 v2, 58368, v2
    v_lshlrev_b32_e64 v4, 3, v1
    v_add_u32 v4, 145408, v4
    ds_read_b64 v[96:97], v4 offset:0
    ds_read_b64_tr_b16 v[40:41], v2 offset:0
    ds_read_b64 v[98:99], v4 offset:32
    ds_read_b64_tr_b16 v[42:43], v2 offset:2048
    ds_read_b64 v[100:101], v4 offset:64
    ds_read_b64_tr_b16 v[44:45], v2 offset:4096
    ds_read_b64 v[102:103], v4 offset:96
    ds_read_b64_tr_b16 v[46:47], v2 offset:6144
    ds_read_b64 v[104:105], v4 offset:128
    ds_read_b64_tr_b16 v[48:49], v2 offset:8192
    ds_read_b64 v[106:107], v4 offset:160
    ds_read_b64_tr_b16 v[50:51], v2 offset:10240
    ds_read_b64 v[108:109], v4 offset:192
    ds_read_b64_tr_b16 v[52:53], v2 offset:12288
    ds_read_b64 v[110:111], v4 offset:224
    ds_read_b64_tr_b16 v[54:55], v2 offset:14336
    ds_read_b64 v[112:113], v4 offset:256
    ds_read_b64_tr_b16 v[56:57], v2 offset:16384
    ds_read_b64 v[114:115], v4 offset:288
    ds_read_b64_tr_b16 v[58:59], v2 offset:18432
    ds_read_b64 v[116:117], v4 offset:320
    ds_read_b64_tr_b16 v[60:61], v2 offset:20480
    ds_read_b64 v[118:119], v4 offset:352
    ds_read_b64_tr_b16 v[62:63], v2 offset:22528
    ds_read_b64 v[120:121], v4 offset:384
    ds_read_b64_tr_b16 v[64:65], v2 offset:24576
    ds_read_b64 v[122:123], v4 offset:416
    ds_read_b64_tr_b16 v[66:67], v2 offset:26624
    ds_read_b64 v[124:125], v4 offset:448
    ds_read_b64_tr_b16 v[68:69], v2 offset:28672
    ds_read_b64 v[126:127], v4 offset:480
    ds_read_b64_tr_b16 v[70:71], v2 offset:30720
    ds_read_b64 v[128:129], v4 offset:512
    ds_read_b64_tr_b16 v[72:73], v2 offset:32768
    ds_read_b64 v[130:131], v4 offset:544
    ds_read_b64_tr_b16 v[74:75], v2 offset:34816
    ds_read_b64 v[132:133], v4 offset:576
    ds_read_b64_tr_b16 v[76:77], v2 offset:36864
    ds_read_b64 v[134:135], v4 offset:608
    ds_read_b64_tr_b16 v[78:79], v2 offset:38912
    ds_read_b64 v[136:137], v4 offset:640
    ds_read_b64_tr_b16 v[80:81], v2 offset:40960
    ds_read_b64 v[138:139], v4 offset:672
    ds_read_b64_tr_b16 v[82:83], v2 offset:43008
    ds_read_b64 v[140:141], v4 offset:704
    ds_read_b64_tr_b16 v[84:85], v2 offset:45056
    ds_read_b64 v[142:143], v4 offset:736
    ds_read_b64_tr_b16 v[86:87], v2 offset:47104
    ds_read_b64 v[144:145], v4 offset:768
    ds_read_b64_tr_b16 v[88:89], v2 offset:49152
    ds_read_b64 v[146:147], v4 offset:800
    ds_read_b64_tr_b16 v[90:91], v2 offset:51200
    ds_read_b64 v[148:149], v4 offset:832
    ds_read_b64_tr_b16 v[92:93], v2 offset:53248
    ds_read_b64 v[150:151], v4 offset:864
    ds_read_b64_tr_b16 v[94:95], v2 offset:55296
    s_sub_u32 s61, s57, 14
    s_cmp_lt_u32 s61, 7
    s_cselect_b32 s62, 1.0, 0
    s_lshl2_add_u32 s61, s57, s52
    s_lshl_b32 s61, s61, 6
    s_add_u32 s61, s61, 7680
    v_lshlrev_b32_e64 v4, 4, v1
    s_waitcnt lgkmcnt(15)
    v_mfma_f32_16x16x32_bf16 v[184:187], v[40:43], v[96:99], 0
    v_mfma_f32_16x16x32_bf16 v[184:187], v[44:47], v[100:103], v[184:187]
    v_mfma_f32_16x16x32_bf16 v[184:187], v[48:51], v[104:107], v[184:187]
    v_mfma_f32_16x16x32_bf16 v[184:187], v[52:55], v[108:111], v[184:187]
    v_mfma_f32_16x16x32_bf16 v[184:187], v[56:59], v[112:115], v[184:187]
    v_mfma_f32_16x16x32_bf16 v[184:187], v[60:63], v[116:119], v[184:187]
    v_mfma_f32_16x16x32_bf16 v[184:187], v[64:67], v[120:123], v[184:187]
    v_mfma_f32_16x16x32_bf16 v[184:187], v[68:71], v[124:127], v[184:187]
    v_mfma_f32_16x16x32_bf16 v[184:187], v[72:75], v[128:131], v[184:187]
    v_mfma_f32_16x16x32_bf16 v[184:187], v[76:79], v[132:135], v[184:187]
    s_waitcnt lgkmcnt(5)
    v_mfma_f32_16x16x32_bf16 v[184:187], v[80:83], v[136:139], v[184:187]
    v_mfma_f32_16x16x32_bf16 v[184:187], v[84:87], v[140:143], v[184:187]
    s_waitcnt lgkmcnt(2)
    v_mfma_f32_16x16x32_bf16 v[184:187], v[88:91], v[144:147], v[184:187]
    s_waitcnt lgkmcnt(0)
    v_mfma_f32_16x16x32_bf16 v[184:187], v[92:95], v[148:151], v[184:187]
    s_barrier
    s_cmp_lt_u32 s57, 28
    s_cbranch_scc0 SK_22
    v_mov_b32 v190, s59
    v_mov_b32 v191, s59
    s_mov_b32 exec_lo, 0x00010001
    s_mov_b32 exec_hi, 0x00010001
    s_nop 0
    v_cvt_pk_bf16_f32 v188, v184, v185
    v_cvt_pk_bf16_f32 v189, v186, v187
    v_lshlrev_b32 v184, 16, v188
    v_and_b32 v185, s70, v188
    v_lshlrev_b32 v186, 16, v189
    v_and_b32 v187, s70, v189
    v_add_f32 v184, s62, v184
    v_add_f32 v185, s62, v185
    v_add_f32 v186, s62, v186
    v_add_f32_e64 v187, s62, v187
    v_cvt_pk_bf16_f32 v188, v184, v185
    v_cvt_pk_bf16_f32 v189, v186, v187
    buffer_store_dwordx4 v[188:191], v4, s[48:51], s61 offen sc1
    s_mov_b64 exec, -1
SK_22:
SK_21:
    s_mov_b32 s64, 0x3fb8aa3b
    s_mov_b32 s65, 0x3fb8aa3b
    s_nop 6
    v_max3_f32 v248, v168, v169, v170
    v_min3_f32 v250, v168, v169, v170
    v_max3_f32 v248, v248, v171, v172
    v_min3_f32 v250, v250, v171, v172
    s_add_u32 m0, s92, 40960
    s_add_u32 s90, s90, s86
    s_nop 0
    buffer_load_dwordx4 v14, s[8:11], s90 offen lds
    v_max3_f32 v248, v248, v173, v174
    v_min3_f32 v250, v250, v173, v174
    v_max3_f32 v248, v248, v175, v176
    v_min3_f32 v250, v250, v175, v176
    v_max3_f32 v248, v248, v177, v178
    v_min3_f32 v250, v250, v177, v178
    v_max_f32 v248, v248, v179
    v_min_f32 v250, v250, v179
    s_add_u32 m0, s92, 45056
    s_add_u32 s90, s90, s86
    s_nop 0
    buffer_load_dwordx4 v14, s[8:11], s90 offen lds
    v_max3_f32 v249, v248, v180, v181
    v_min3_f32 v251, v250, v180, v181
    v_max3_f32 v249, v249, v182, v183
    v_min3_f32 v251, v251, v182, v183
    v_cndmask_b32 v248, v249, v248, s[68:69]
    v_cndmask_b32_e64 v250, -v251, -v250, s[68:69]
    v_mov_b32 v6, 0xff800000
    s_nop 0
    v_permlane32_swap_b32 v248, v250
    v_max_f32_e64 v248, v248, v250
    s_add_u32 m0, s92, 49152
    s_add_u32 s90, s90, s86
    buffer_load_dwordx4 v14, s[8:11], s90 offen lds
    v_mul_f32 v248, 0xbfb8aa3b, v248
    v_mov_b32 v250, v248
    s_nop 1
    v_permlane32_swap_b32 v248, v250
    v_cndmask_b32 v249, v248, v6, s[68:69]
    v_cndmask_b32 v251, v250, v6, s[68:69]
    v_pk_fma_f32 v[184:185], v[168:169], s[64:65], v[248:249] op_sel_hi:[1,1,0]
    v_pk_fma_f32 v[168:169], v[168:169], s[64:65], v[250:251] op_sel_hi:[1,1,0] neg_lo:[1,0,0] neg_hi:[1,0,0]
    v_pk_fma_f32 v[186:187], v[170:171], s[64:65], v[248:249] op_sel_hi:[1,1,0]
    s_add_u32 m0, s92, 53248
    s_add_u32 s90, s90, s86
    s_nop 0
    buffer_load_dwordx4 v14, s[8:11], s90 offen lds
    v_pk_fma_f32 v[170:171], v[170:171], s[64:65], v[250:251] op_sel_hi:[1,1,0] neg_lo:[1,0,0] neg_hi:[1,0,0]
    v_pk_fma_f32 v[188:189], v[172:173], s[64:65], v[248:249] op_sel_hi:[1,1,0]
    v_pk_fma_f32 v[172:173], v[172:173], s[64:65], v[250:251] op_sel_hi:[1,1,0] neg_lo:[1,0,0] neg_hi:[1,0,0]
    v_pk_fma_f32 v[190:191], v[174:175], s[64:65], v[248:249] op_sel_hi:[1,1,0]
    v_pk_fma_f32 v[174:175], v[174:175], s[64:65], v[250:251] op_sel_hi:[1,1,0] neg_lo:[1,0,0] neg_hi:[1,0,0]
    v_pk_fma_f32 v[192:193], v[176:177], s[64:65], v[248:249] op_sel_hi:[1,1,0]
    v_pk_fma_f32 v[176:177], v[176:177], s[64:65], v[250:251] op_sel_hi:[1,1,0] neg_lo:[1,0,0] neg_hi:[1,0,0]
    v_pk_fma_f32 v[194:195], v[178:179], s[64:65], v[248:249] op_sel_hi:[1,1,0]
    s_mov_b32 m0, 57344
    s_nop 0
    s_nop 0
    buffer_load_dwordx4 v14, s[8:11], s10 offen lds
    v_pk_fma_f32 v[178:179], v[178:179], s[64:65], v[250:251] op_sel_hi:[1,1,0] neg_lo:[1,0,0] neg_hi:[1,0,0]
    v_pk_fma_f32 v[196:197], v[180:181], s[64:65], v[248:249] op_sel:[0,0,1] op_sel_hi:[1,1,1]
    v_pk_fma_f32 v[180:181], v[180:181], s[64:65], v[250:251] op_sel:[0,0,1] op_sel_hi:[1,1,1] neg_lo:[1,0,0] neg_hi:[1,0,0]
    v_pk_fma_f32 v[198:199], v[182:183], s[64:65], v[248:249] op_sel:[0,0,1] op_sel_hi:[1,1,1]
    v_pk_fma_f32 v[182:183], v[182:183], s[64:65], v[250:251] op_sel:[0,0,1] op_sel_hi:[1,1,1] neg_lo:[1,0,0] neg_hi:[1,0,0]
    v_exp_f32 v184, v184
    v_exp_f32 v185, v185
    v_exp_f32 v186, v186
    v_exp_f32 v187, v187
    v_exp_f32 v188, v188
    v_exp_f32 v189, v189
    v_exp_f32 v190, v190
    v_exp_f32 v191, v191
    v_exp_f32 v192, v192
    v_exp_f32 v193, v193
    v_exp_f32 v194, v194
    v_exp_f32 v195, v195
    v_exp_f32 v196, v196
    v_exp_f32 v197, v197
    v_exp_f32 v198, v198
    v_exp_f32 v199, v199
    v_exp_f32 v168, v168
    v_exp_f32 v169, v169
    v_exp_f32 v170, v170
    v_exp_f32 v171, v171
    v_exp_f32 v172, v172
    v_exp_f32 v173, v173
    v_exp_f32 v174, v174
    v_exp_f32 v175, v175
    buffer_load_dwordx4 v[40:43], v238, s[48:51], s78 offen offset:0 sc1
    buffer_load_dwordx4 v[44:47], v238, s[48:51], s78 offen offset:256 sc1
    v_exp_f32 v176, v176
    v_exp_f32 v177, v177
    v_exp_f32 v178, v178
    v_exp_f32 v179, v179
    v_exp_f32 v180, v180
    v_exp_f32 v181, v181
    v_exp_f32 v182, v182
    v_exp_f32 v183, v183
    v_pk_add_f32 v[248:249], v[184:185], v[186:187]
    v_pk_add_f32 v[250:251], v[168:169], v[170:171]
    v_pk_add_f32 v[248:249], v[248:249], v[188:189]
    v_pk_add_f32 v[250:251], v[250:251], v[172:173]
    v_pk_add_f32 v[248:249], v[248:249], v[190:191]
    v_pk_add_f32 v[250:251], v[250:251], v[174:175]
    v_pk_add_f32 v[248:249], v[248:249], v[192:193]
    v_pk_add_f32 v[250:251], v[250:251], v[176:177]
    s_waitcnt vmcnt(2)
    s_barrier
    v_pk_add_f32 v[248:249], v[248:249], v[194:195]
    v_pk_add_f32 v[250:251], v[250:251], v[178:179]
    v_pk_add_f32 v[248:249], v[248:249], v[196:197]
    v_pk_add_f32 v[250:251], v[250:251], v[180:181]
    v_pk_add_f32 v[248:249], v[248:249], v[198:199]
    v_pk_add_f32 v[250:251], v[250:251], v[182:183]
    v_add_f32_e64 v248, v248, v249
    v_add_f32 v250, v250, v251
    s_nop 1
    v_permlane32_swap_b32 v248, v250
    v_add_f32 v248, v248, v250
    v_rcp_f32 v248, v248
    s_add_u32 m0, s67, 0
    s_xor_b32 s66, s94, 1048576
    buffer_load_dwordx4 v16, s[24:27], s66 offen offset:0 lds
    buffer_load_dwordx4 v17, s[24:27], s66 offen offset:1024 lds
    buffer_load_dwordx4 v18, s[24:27], s66 offen offset:2048 lds
    buffer_load_dwordx4 v19, s[24:27], s66 offen offset:3072 lds
    v_mov_b32 v250, v248
    s_nop 1
    v_permlane32_swap_b32_e64 v248, v250
    v_pk_mul_f32 v[184:185], v[184:185], v[248:249] op_sel_hi:[1,0]
    v_pk_mul_f32 v[186:187], v[186:187], v[248:249] op_sel_hi:[1,0]
    v_pk_mul_f32 v[188:189], v[188:189], v[248:249] op_sel_hi:[1,0]
    v_pk_mul_f32 v[190:191], v[190:191], v[248:249] op_sel_hi:[1,0]
    v_pk_mul_f32 v[192:193], v[192:193], v[248:249] op_sel_hi:[1,0]
    v_pk_mul_f32 v[194:195], v[194:195], v[248:249] op_sel_hi:[1,0]
    v_pk_mul_f32 v[196:197], v[196:197], v[248:249] op_sel_hi:[1,0]
    v_pk_mul_f32 v[198:199], v[198:199], v[248:249] op_sel_hi:[1,0]
    v_cvt_pk_bf16_f32 v216, v184, v185
    v_cvt_pk_bf16_f32 v217, v186, v187
    v_cvt_pk_bf16_f32 v218, v188, v189
    v_cvt_pk_bf16_f32 v219, v190, v191
    v_cvt_pk_bf16_f32 v220, v192, v193
    v_cvt_pk_bf16_f32 v221, v194, v195
    v_cvt_pk_bf16_f32 v222, v196, v197
    v_cvt_pk_bf16_f32 v223, v198, v199
    v_pk_mul_f32 v[168:169], v[168:169], v[250:251] op_sel_hi:[1,0]
    v_pk_mul_f32 v[170:171], v[170:171], v[250:251] op_sel_hi:[1,0]
    v_pk_mul_f32 v[172:173], v[172:173], v[250:251] op_sel_hi:[1,0]
    v_pk_mul_f32 v[174:175], v[174:175], v[250:251] op_sel_hi:[1,0]
    s_add_u32 m0, s67, 4096
    s_xor_b32 s66, s94, 1048832
    buffer_load_dwordx4 v16, s[24:27], s66 offen offset:0 lds
    buffer_load_dwordx4 v17, s[24:27], s66 offen offset:1024 lds
    buffer_load_dwordx4 v18, s[24:27], s66 offen offset:2048 lds
    buffer_load_dwordx4 v19, s[24:27], s66 offen offset:3072 lds
    v_pk_mul_f32 v[176:177], v[176:177], v[250:251] op_sel_hi:[1,0]
    v_pk_mul_f32 v[178:179], v[178:179], v[250:251] op_sel_hi:[1,0]
    v_pk_mul_f32 v[180:181], v[180:181], v[250:251] op_sel_hi:[1,0]
    v_pk_mul_f32 v[182:183], v[182:183], v[250:251] op_sel_hi:[1,0]
    v_cvt_pk_bf16_f32 v224, v168, v169
    v_cvt_pk_bf16_f32 v225, v170, v171
    v_cvt_pk_bf16_f32 v226, v172, v173
    v_cvt_pk_bf16_f32 v227, v174, v175
    v_cvt_pk_bf16_f32 v228, v176, v177
    v_cvt_pk_bf16_f32 v229, v178, v179
    v_cvt_pk_bf16_f32 v230, v180, v181
    v_cvt_pk_bf16_f32 v231, v182, v183
    v_lshlrev_b32 v4, 10, v3
    v_add_u32 v232, v4, v8
    v_add_u32 v233, v4, v9
    v_add_u32 v234, v4, v10
    v_add_u32 v236, v4, v11
    s_lshl_b32 s61, s58, 7
    v_lshl_add_u32 v6, v1, 4, s61
    v_add_u32 v6, 115712, v6
    v_and_b32_e64 v2, 15, v0
    v_lshlrev_b32 v2, 2, v2
    s_lshl_b32 s60, s55, 8
    s_add_u32 s60, s60, 16384
    s_lshl_b32 s62, s72, 15
    s_nop 0
    s_add_u32 s62, s62, 2097152
    v_accvgpr_read_b32 v160, a240
    v_accvgpr_read_b32 v161, a241
    v_accvgpr_read_b32 v162, a242
    v_accvgpr_read_b32 v163, a243
    v_accvgpr_read_b32 v164, a244
    v_accvgpr_read_b32 v165, a245
    v_accvgpr_read_b32 v166, a246
    v_accvgpr_read_b32 v167, a247
    ds_read_b64_tr_b16 v[96:97], v232 offset:0
    ds_read_b64_tr_b16 v[98:99], v232 offset:1024
    ds_read_b64_tr_b16 v[100:101], v233 offset:0
    ds_read_b64_tr_b16 v[102:103], v233 offset:1024
    ds_read_b64_tr_b16 v[104:105], v234 offset:0
    ds_read_b64_tr_b16 v[106:107], v234 offset:1024
    ds_read_b64_tr_b16 v[108:109], v236 offset:0
    ds_read_b64_tr_b16 v[110:111], v236 offset:1024
    ds_read_b64_tr_b16 v[112:113], v234 offset:3584
    ds_read_b64_tr_b16 v[114:115], v234 offset:4608
    ds_read_b64_tr_b16 v[116:117], v236 offset:3584
    ds_read_b64_tr_b16 v[118:119], v236 offset:4608
    ds_read_b64_tr_b16 v[120:121], v232 offset:3584
    ds_read_b64_tr_b16 v[122:123], v232 offset:4608
    ds_read_b64_tr_b16 v[124:125], v233 offset:3584
    ds_read_b64_tr_b16 v[126:127], v233 offset:4608
    ds_read_b64_tr_b16 v[128:129], v232 offset:7168
    ds_read_b64_tr_b16 v[130:131], v232 offset:8192
    ds_read_b64_tr_b16 v[132:133], v233 offset:7168
    ds_read_b64_tr_b16 v[134:135], v233 offset:8192
    ds_read_b64_tr_b16 v[136:137], v234 offset:7168
    ds_read_b64_tr_b16 v[138:139], v234 offset:8192
    ds_read_b64_tr_b16 v[140:141], v236 offset:7168
    ds_read_b64_tr_b16 v[142:143], v236 offset:8192
    s_waitcnt vmcnt(8)
    v_xor_b32 v42, s59, v42
    v_bitop3_b32 v42, v42, v46, s59 bitop3:0xf6
    v_cmp_ne_u32 s[64:65], 0, v42
    s_nop 0
    s_cmp_eq_u64 s[64:65], 0
    s_cbranch_scc1 L_P2D
    s_mov_b32 s66, 0
L_P2L:
    s_add_u32 s66, s66, 1
    s_cmp_gt_u32 s66, 0x40000
    s_cbranch_scc1 L_P2D
L_P2F:
    buffer_load_dwordx4 v[40:43], v238, s[48:51], s78 offen offset:0 sc1
    buffer_load_dwordx4 v[44:47], v238, s[48:51], s78 offen offset:256 sc1
    s_waitcnt vmcnt(0)
    v_xor_b32 v42, s59, v42
    v_bitop3_b32 v42, v42, v46, s59 bitop3:0xf6
    v_cmp_ne_u32 s[64:65], 0, v42
    s_nop 0
    s_cmp_eq_u64 s[64:65], 0
    s_cbranch_scc0 L_P2L
L_P2D:
    ds_write_b64 v239, v[40:41] offset:0
    ds_write_b64 v239, v[44:45] offset:256
    s_waitcnt lgkmcnt(0)
    s_barrier
    ds_read_b128 v[184:187], v235 offset:0
    ds_read_b128 v[188:191], v235 offset:1024
    ds_read_b128 v[192:195], v235 offset:2048
    ds_read_b128 v[196:199], v235 offset:3072
    s_waitcnt lgkmcnt(3)
    v_mfma_f32_32x32x16_bf16 v[168:183], v[184:187], v[216:219], 0
    s_waitcnt lgkmcnt(2)
    v_mfma_f32_32x32x16_bf16 v[168:183], v[188:191], v[220:223], v[168:183]
    s_waitcnt lgkmcnt(1)
    v_mfma_f32_32x32x16_bf16 v[168:183], v[192:195], v[224:227], v[168:183]
    s_waitcnt lgkmcnt(0)
    v_mfma_f32_32x32x16_bf16 v[168:183], v[196:199], v[228:231], v[168:183]
    s_nop 11
    v_add_f32 v248, 0x358637bd, v180
    v_mov_b32_e64 v250, v248
    s_nop 1
    v_permlane32_swap_b32 v248, v250
    v_rcp_f32 v250, v250
    s_nop 0
    v_pk_mul_f32 v[168:169], v[168:169], v[250:251] op_sel_hi:[1,0]
    v_pk_mul_f32 v[170:171], v[170:171], v[250:251] op_sel_hi:[1,0]
    v_pk_mul_f32 v[172:173], v[172:173], v[250:251] op_sel_hi:[1,0]
    v_pk_mul_f32 v[174:175], v[174:175], v[250:251] op_sel_hi:[1,0]
    v_pk_mul_f32 v[176:177], v[176:177], v[250:251] op_sel_hi:[1,0]
    v_pk_mul_f32 v[178:179], v[178:179], v[250:251] op_sel_hi:[1,0]
    v_pk_mul_f32 v[180:181], v[180:181], v[250:251] op_sel_hi:[1,0]
    v_pk_mul_f32 v[182:183], v[182:183], v[250:251] op_sel_hi:[1,0]
    v_cvt_pk_bf16_f32 v184, v168, v169
    v_cvt_pk_bf16_f32 v185, v170, v171
    v_cvt_pk_bf16_f32 v186, v172, v173
    v_cvt_pk_bf16_f32 v187, v174, v175
    v_cvt_pk_bf16_f32 v188, v176, v177
    v_cvt_pk_bf16_f32 v189, v178, v179
    v_cvt_pk_bf16_f32 v190, v180, v181
    v_cvt_pk_bf16_f32 v191, v182, v183
    v_cndmask_b32 v190, v190, 0, s[68:69]
    v_cndmask_b32 v191, v191, 0, s[68:69]
    s_cmp_eq_u32 s87, 0
    s_cbranch_scc1 WT_23
    buffer_store_dwordx4 v[184:187], v246, s[48:51], s79 offen offset:0
    buffer_store_dwordx4 v[188:191], v246, s[48:51], s79 offen offset:512
WB_24:
    s_waitcnt vmcnt(2)
    s_nop 0
    ds_read_b128 a[0:3], v20 offset:49152
    ds_read_b128 a[4:7], v21 offset:49152
    ds_read_b128 a[8:11], v22 offset:49152
    ds_read_b128 a[12:15], v23 offset:49152
    ds_read_b128 a[16:19], v20 offset:53248
    ds_read_b128 a[20:23], v21 offset:53248
    ds_read_b128 a[24:27], v22 offset:53248
    ds_read_b128 a[28:31], v23 offset:53248
    s_cbranch_vccnz SK_25
    s_waitcnt vmcnt(0)
    s_waitcnt lgkmcnt(0)
    s_barrier
    s_cmp_eq_u32 s52, 0
    s_cbranch_scc0 SK_26
    v_mov_b32 v5, s59
    s_mov_b64 exec, 1
    s_cmp_eq_u32 s87, 0
    s_cbranch_scc1 WT_27
    buffer_store_dword v5, off, s[48:51], s80
WB_28:
    s_mov_b64 exec, -1
SK_26:
    buffer_load_dwordx4 v[32:35], v240, s[48:51], s73 offen sc1
    buffer_load_dwordx4 v[36:39], v241, s[48:51], s73 offen sc1
    s_waitcnt vmcnt(1)
    v_xor_b32 v34, s59, v34
    s_waitcnt vmcnt(0)
    v_bitop3_b32 v34, v34, v38, s59 bitop3:0xf6
    v_cmp_ne_u32 s[64:65], 0, v34
    s_nop 0
    s_cmp_eq_u64 s[64:65], 0
    s_cbranch_scc0 L_PMS
L_PMSD:
    ds_write_b64 v242, v[32:33]
    ds_write_b64 v242, v[36:37] offset:1792
    v_bfe_u32 v5, v0, 3, 1
    v_xor_b32 v4, 1, v5
    v_mul_u32_u24 v4, 896, v4
    v_lshl_add_u32 v4, v1, 4, v4
    v_add_u32 v12, 115712, v4
    v_lshlrev_b32_e64 v4, 5, v1
    v_lshl_add_u32 v13, v5, 4, v4
    s_lshl_b32 s60, s52, 5
    v_xor_b32 v2, s60, v8
    s_lshl_b32 s61, s72, 7
    s_add_u32 s61, s61, 49152
    s_cmp_lt_u32 s57, 28
    s_cselect_b32 s61, s61, 33554432
    v_mov_b32_e64 v167, s59
    s_waitcnt lgkmcnt(0)
    s_barrier
    ds_read_b128 v[40:43], v12 offset:0
    ds_read_b64_tr_b16 v[96:97], v2 offset:0
    ds_read_b64_tr_b16 v[98:99], v2 offset:2048
    ds_read_b128 v[44:47], v12 offset:64
    ds_read_b64_tr_b16 v[100:101], v2 offset:4096
    ds_read_b64_tr_b16 v[102:103], v2 offset:6144
    ds_read_b128 v[48:51], v12 offset:128
    ds_read_b64_tr_b16 v[104:105], v2 offset:8192
    ds_read_b64_tr_b16 v[106:107], v2 offset:10240
    ds_read_b128 v[52:55], v12 offset:192
    ds_read_b64_tr_b16 v[108:109], v2 offset:12288
    ds_read_b64_tr_b16 v[110:111], v2 offset:14336
    ds_read_b128 v[56:59], v12 offset:256
    ds_read_b64_tr_b16 v[112:113], v2 offset:16384
    ds_read_b64_tr_b16 v[114:115], v2 offset:18432
    ds_read_b128 v[60:63], v12 offset:320
    ds_read_b64_tr_b16 v[116:117], v2 offset:20480
    ds_read_b64_tr_b16 v[118:119], v2 offset:22528
    ds_read_b128 v[64:67], v12 offset:384
    ds_read_b64_tr_b16 v[120:121], v2 offset:24576
    ds_read_b64_tr_b16 v[122:123], v2 offset:26624
    ds_read_b128 v[68:71], v12 offset:448
    ds_read_b64_tr_b16 v[124:125], v2 offset:28672
    ds_read_b64_tr_b16 v[126:127], v2 offset:30720
    ds_read_b128 v[72:75], v12 offset:512
    ds_read_b64_tr_b16 v[128:129], v2 offset:32768
    ds_read_b64_tr_b16 v[130:131], v2 offset:34816
    ds_read_b128 v[76:79], v12 offset:576
    ds_read_b64_tr_b16 v[132:133], v2 offset:36864
    ds_read_b64_tr_b16 v[134:135], v2 offset:38912
    ds_read_b128 v[80:83], v12 offset:640
    ds_read_b64_tr_b16 v[136:137], v2 offset:40960
    ds_read_b64_tr_b16 v[138:139], v2 offset:43008
    ds_read_b128 v[84:87], v12 offset:704
    ds_read_b64_tr_b16 v[140:141], v2 offset:45056
    ds_read_b64_tr_b16 v[142:143], v2 offset:47104
    ds_read_b128 v[88:91], v12 offset:768
    ds_read_b64_tr_b16 v[144:145], v2 offset:49152
    ds_read_b64_tr_b16 v[146:147], v2 offset:51200
    ds_read_b128 v[92:95], v12 offset:832
    ds_read_b64_tr_b16 v[148:149], v2 offset:53248
    ds_read_b64_tr_b16 v[150:151], v2 offset:55296
    s_waitcnt lgkmcnt(15)
    s_nop 0
    v_mfma_f32_16x16x32_bf16 v[160:163], v[96:99], v[40:43], 0
    v_mfma_f32_16x16x32_bf16 v[160:163], v[100:103], v[44:47], v[160:163]
    v_mfma_f32_16x16x32_bf16 v[160:163], v[104:107], v[48:51], v[160:163]
    v_mfma_f32_16x16x32_bf16 v[160:163], v[108:111], v[52:55], v[160:163]
    v_mfma_f32_16x16x32_bf16 v[160:163], v[112:115], v[56:59], v[160:163]
    v_mfma_f32_16x16x32_bf16 v[160:163], v[116:119], v[60:63], v[160:163]
    s_waitcnt lgkmcnt(15)
    v_mfma_f32_16x16x32_bf16 v[160:163], v[120:123], v[64:67], v[160:163]
    v_mfma_f32_16x16x32_bf16 v[160:163], v[124:127], v[68:71], v[160:163]
    s_waitcnt lgkmcnt(13)
    v_mfma_f32_16x16x32_bf16 v[160:163], v[128:131], v[72:75], v[160:163]
    s_waitcnt lgkmcnt(11)
    v_mfma_f32_16x16x32_bf16 v[160:163], v[132:135], v[76:79], v[160:163]
    s_waitcnt lgkmcnt(9)
    v_mfma_f32_16x16x32_bf16 v[160:163], v[136:139], v[80:83], v[160:163]
    s_waitcnt lgkmcnt(6)
    v_mfma_f32_16x16x32_bf16 v[160:163], v[140:143], v[84:87], v[160:163]
    s_waitcnt lgkmcnt(3)
    v_mfma_f32_16x16x32_bf16 v[160:163], v[144:147], v[88:91], v[160:163]
    s_waitcnt lgkmcnt(0)
    v_mfma_f32_16x16x32_bf16 v[160:163], v[148:151], v[92:95], v[160:163]
    s_mov_b32 exec_lo, 0x01010101
    s_mov_b32 exec_hi, 0x01010101
    s_mov_b32 s60, 0x7060501
    s_nop 4
    v_perm_b32 v164, v160, v163, s60
    s_mov_b32 s60, 0x7060502
    v_perm_b32 v165, v161, v163, s60
    s_mov_b32 s60, 0x7060503
    v_perm_b32 v166, v162, v163, s60
    buffer_store_dwordx4 v[164:167], v13, s[48:51], s61 offen sc1
    s_mov_b64 exec, -1
    s_add_u32 m0, s67, 0
    s_xor_b32 s66, s94, 1049088
    buffer_load_dwordx4 v16, s[24:27], s66 offen offset:0 lds
    buffer_load_dwordx4 v17, s[24:27], s66 offen offset:1024 lds
    buffer_load_dwordx4 v18, s[24:27], s66 offen offset:2048 lds
    buffer_load_dwordx4 v19, s[24:27], s66 offen offset:3072 lds
    s_add_u32 m0, s67, 4096
    s_xor_b32 s66, s94, 1049344
    buffer_load_dwordx4 v16, s[24:27], s66 offen offset:0 lds
    buffer_load_dwordx4 v17, s[24:27], s66 offen offset:1024 lds
    buffer_load_dwordx4 v18, s[24:27], s66 offen offset:2048 lds
    buffer_load_dwordx4 v19, s[24:27], s66 offen offset:3072 lds
    s_lshl_b32 s60, s52, 6
    v_add_u32 v6, s60, v0
    v_lshrrev_b32 v4, 4, v6
    v_min_u32 v4, 13, v4
    v_mul_u32_u24 v4, 3584, v4
    v_and_b32 v6, 15, v6
    v_min_u32 v6, 13, v6
    v_lshl_add_u32 v6, v6, 7, v4
    s_mul_i32 s60, s57, 50176
    buffer_load_dword v254, v6, s[20:23], s60 offen offset:0
    s_waitcnt vmcnt(1)
    s_nop 0
    ds_read_b128 a[32:35], v20 offset:49152
    ds_read_b128 a[36:39], v21 offset:49152
    ds_read_b128 a[40:43], v22 offset:49152
    ds_read_b128 a[44:47], v23 offset:49152
    ds_read_b128 a[48:51], v20 offset:53248
    ds_read_b128 a[52:55], v21 offset:53248
    ds_read_b128 a[56:59], v22 offset:53248
    ds_read_b128 a[60:63], v23 offset:53248
    s_waitcnt lgkmcnt(0)
    s_add_u32 m0, s67, 0
    s_xor_b32 s66, s94, 1049600
    buffer_load_dwordx4 v16, s[24:27], s66 offen offset:0 lds
    buffer_load_dwordx4 v17, s[24:27], s66 offen offset:1024 lds
    buffer_load_dwordx4 v18, s[24:27], s66 offen offset:2048 lds
    buffer_load_dwordx4 v19, s[24:27], s66 offen offset:3072 lds
    s_add_u32 m0, s67, 4096
    s_xor_b32 s66, s94, 1049856
    buffer_load_dwordx4 v16, s[24:27], s66 offen offset:0 lds
    buffer_load_dwordx4 v17, s[24:27], s66 offen offset:1024 lds
    buffer_load_dwordx4 v18, s[24:27], s66 offen offset:2048 lds
    buffer_load_dwordx4 v19, s[24:27], s66 offen offset:3072 lds
    s_waitcnt vmcnt(0)
    s_nop 0
    ds_read_b128 a[64:67], v20 offset:49152
    ds_read_b128 a[68:71], v21 offset:49152
    ds_read_b128 a[72:75], v22 offset:49152
    ds_read_b128 a[76:79], v23 offset:49152
    ds_read_b128 a[80:83], v20 offset:53248
    ds_read_b128 a[84:87], v21 offset:53248
    ds_read_b128 a[88:91], v22 offset:53248
    ds_read_b128 a[92:95], v23 offset:53248
    s_waitcnt lgkmcnt(0)
    s_add_u32 m0, s67, 0
    s_xor_b32 s66, s94, 1050112
    buffer_load_dwordx4 v16, s[24:27], s66 offen offset:0 lds
    buffer_load_dwordx4 v17, s[24:27], s66 offen offset:1024 lds
    buffer_load_dwordx4 v18, s[24:27], s66 offen offset:2048 lds
    buffer_load_dwordx4 v19, s[24:27], s66 offen offset:3072 lds
    s_add_u32 m0, s67, 4096
    s_xor_b32 s66, s94, 1050368
    buffer_load_dwordx4 v16, s[24:27], s66 offen offset:0 lds
    buffer_load_dwordx4 v17, s[24:27], s66 offen offset:1024 lds
    buffer_load_dwordx4 v18, s[24:27], s66 offen offset:2048 lds
    buffer_load_dwordx4 v19, s[24:27], s66 offen offset:3072 lds
    s_waitcnt vmcnt(0)
    s_nop 0
    ds_read_b128 a[96:99], v20 offset:49152
    ds_read_b128 a[100:103], v21 offset:49152
    ds_read_b128 a[104:107], v22 offset:49152
    ds_read_b128 a[108:111], v23 offset:49152
    ds_read_b128 a[112:115], v20 offset:53248
    ds_read_b128 a[116:119], v21 offset:53248
    ds_read_b128 a[120:123], v22 offset:53248
    ds_read_b128 a[124:127], v23 offset:53248
    s_waitcnt lgkmcnt(0)
    s_add_u32 m0, s67, 0
    s_xor_b32 s66, s94, 0
    s_nop 0
    buffer_load_dwordx4 v16, s[24:27], s66 offen offset:0 lds
    buffer_load_dwordx4 v17, s[24:27], s66 offen offset:1024 lds
    buffer_load_dwordx4 v18, s[24:27], s66 offen offset:2048 lds
    buffer_load_dwordx4 v19, s[24:27], s66 offen offset:3072 lds
    s_add_u32 m0, s67, 4096
    s_xor_b32 s66, s94, 256
    buffer_load_dwordx4 v16, s[24:27], s66 offen offset:0 lds
    buffer_load_dwordx4 v17, s[24:27], s66 offen offset:1024 lds
    buffer_load_dwordx4 v18, s[24:27], s66 offen offset:2048 lds
    buffer_load_dwordx4 v19, s[24:27], s66 offen offset:3072 lds
    s_waitcnt vmcnt(0)
    s_nop 0
    ds_read_b128 a[128:131], v20 offset:49152
    ds_read_b128 a[132:135], v21 offset:49152
    ds_read_b128 a[136:139], v22 offset:49152
    ds_read_b128 a[140:143], v23 offset:49152
    ds_read_b128 a[144:147], v20 offset:53248
    ds_read_b128 a[148:151], v21 offset:53248
    ds_read_b128 a[152:155], v22 offset:53248
    ds_read_b128 a[156:159], v23 offset:53248
    s_waitcnt lgkmcnt(0)
    s_add_u32 m0, s67, 0
    s_xor_b32 s66, s94, 512
    buffer_load_dwordx4 v16, s[24:27], s66 offen offset:0 lds
    buffer_load_dwordx4 v17, s[24:27], s66 offen offset:1024 lds
    buffer_load_dwordx4 v18, s[24:27], s66 offen offset:2048 lds
    buffer_load_dwordx4 v19, s[24:27], s66 offen offset:3072 lds
    s_add_u32 m0, s67, 4096
    s_xor_b32 s66, s94, 768
    buffer_load_dwordx4 v16, s[24:27], s66 offen offset:0 lds
    buffer_load_dwordx4 v17, s[24:27], s66 offen offset:1024 lds
    buffer_load_dwordx4 v18, s[24:27], s66 offen offset:2048 lds
    buffer_load_dwordx4 v19, s[24:27], s66 offen offset:3072 lds
    s_lshl_b32 s60, s52, 6
    v_add_u32 v6, s60, v0
    v_lshrrev_b32 v4, 4, v6
    v_min_u32 v4, 13, v4
    v_mul_u32_u24 v4, 1792, v4
    v_and_b32 v6, 15, v6
    v_min_u32 v6, 13, v6
    v_lshl_add_u32 v6, v6, 7, v4
    s_mul_i32 s60, s57, 25088
    buffer_load_dword v254, v6, s[32:35], s60 offen offset:0
    s_waitcnt vmcnt(1)
    s_nop 0
    ds_read_b128 a[160:163], v20 offset:49152
    ds_read_b128 a[164:167], v21 offset:49152
    ds_read_b128 a[168:171], v22 offset:49152
    ds_read_b128 a[172:175], v23 offset:49152
    ds_read_b128 a[176:179], v20 offset:53248
    ds_read_b128 a[180:183], v21 offset:53248
    ds_read_b128 a[184:187], v22 offset:53248
    ds_read_b128 a[188:191], v23 offset:53248
    s_waitcnt lgkmcnt(0)
    s_add_u32 m0, s67, 0
    s_xor_b32 s66, s94, 1024
    buffer_load_dwordx4 v16, s[24:27], s66 offen offset:0 lds
    buffer_load_dwordx4 v17, s[24:27], s66 offen offset:1024 lds
    buffer_load_dwordx4 v18, s[24:27], s66 offen offset:2048 lds
    buffer_load_dwordx4 v19, s[24:27], s66 offen offset:3072 lds
    s_add_u32 m0, s67, 4096
    s_xor_b32 s66, s94, 1280
    buffer_load_dwordx4 v16, s[24:27], s66 offen offset:0 lds
    buffer_load_dwordx4 v17, s[24:27], s66 offen offset:1024 lds
    buffer_load_dwordx4 v18, s[24:27], s66 offen offset:2048 lds
    buffer_load_dwordx4 v19, s[24:27], s66 offen offset:3072 lds
    s_waitcnt vmcnt(0)
    s_nop 0
    ds_read_b128 a[192:195], v20 offset:49152
    ds_read_b128 a[196:199], v21 offset:49152
    ds_read_b128 a[200:203], v22 offset:49152
    ds_read_b128 a[204:207], v23 offset:49152
    ds_read_b128 a[208:211], v20 offset:53248
    ds_read_b128 a[212:215], v21 offset:53248
    ds_read_b128 a[216:219], v22 offset:53248
    ds_read_b128 a[220:223], v23 offset:53248
    s_waitcnt lgkmcnt(0)
    s_add_u32 m0, s67, 0
    s_xor_b32 s66, s94, 1536
    buffer_load_dwordx4 v16, s[24:27], s66 offen offset:0 lds
    buffer_load_dwordx4 v17, s[24:27], s66 offen offset:1024 lds
    buffer_load_dwordx4 v18, s[24:27], s66 offen offset:2048 lds
    buffer_load_dwordx4 v19, s[24:27], s66 offen offset:3072 lds
    s_add_u32 m0, s67, 4096
    s_xor_b32 s66, s94, 1792
    buffer_load_dwordx4 v16, s[24:27], s66 offen offset:0 lds
    buffer_load_dwordx4 v17, s[24:27], s66 offen offset:1024 lds
    buffer_load_dwordx4 v18, s[24:27], s66 offen offset:2048 lds
    buffer_load_dwordx4 v19, s[24:27], s66 offen offset:3072 lds
    s_waitcnt vmcnt(0)
    s_nop 0
    ds_read_b128 a[224:227], v20 offset:49152
    ds_read_b128 a[228:231], v21 offset:49152
    ds_read_b128 a[232:235], v22 offset:49152
    ds_read_b128 a[236:239], v23 offset:49152
    ds_read_b128 a[240:243], v20 offset:53248
    ds_read_b128 a[244:247], v21 offset:53248
    ds_read_b128 a[248:251], v22 offset:53248
    ds_read_b128 a[252:255], v23 offset:53248
    s_waitcnt lgkmcnt(0)
    s_branch L_P3
SK_25:
    s_cbranch_vccz SK_29
    s_nop 0
    buffer_load_dwordx4 v[32:35], v240, s[48:51], s73 offen sc1
    buffer_load_dwordx4 v[36:39], v241, s[48:51], s73 offen sc1
    ds_read_b64_tr_b16 v[144:145], v234 offset:10752
    ds_read_b64_tr_b16 v[146:147], v234 offset:11776
    ds_read_b64_tr_b16 v[148:149], v236 offset:10752
    ds_read_b64_tr_b16 v[150:151], v236 offset:11776
    ds_read_b64_tr_b16 v[152:153], v232 offset:10752
    ds_read_b64_tr_b16 v[154:155], v232 offset:11776
    ds_read_b64_tr_b16 v[156:157], v233 offset:10752
    ds_read_b64_tr_b16 v[158:159], v233 offset:11776
    ds_read_b64_tr_b16 a[240:241], v232 offset:14336
    ds_read_b64_tr_b16 a[242:243], v232 offset:15360
    ds_read_b64_tr_b16 a[244:245], v233 offset:14336
    ds_read_b64_tr_b16 a[246:247], v233 offset:15360
    ds_read_b64_tr_b16 a[248:249], v234 offset:14336
    ds_read_b64_tr_b16 a[250:251], v234 offset:15360
    ds_read_b64_tr_b16 a[252:253], v236 offset:14336
    ds_read_b64_tr_b16 a[254:255], v236 offset:15360
    ds_read_b64_tr_b16 a[224:225], v234 offset:17920
    ds_read_b64_tr_b16 a[226:227], v234 offset:18944
    ds_read_b64_tr_b16 a[228:229], v236 offset:17920
    ds_read_b64_tr_b16 a[230:231], v236 offset:18944
    ds_read_b64_tr_b16 a[232:233], v232 offset:17920
    ds_read_b64_tr_b16 a[234:235], v232 offset:18944
    ds_read_b64_tr_b16 a[236:237], v233 offset:17920
    ds_read_b64_tr_b16 a[238:239], v233 offset:18944
    ds_read_b64_tr_b16 a[208:209], v232 offset:21504
    ds_read_b64_tr_b16 a[210:211], v232 offset:22528
    ds_read_b64_tr_b16 a[212:213], v233 offset:21504
    ds_read_b64_tr_b16 a[214:215], v233 offset:22528
    ds_read_b64_tr_b16 a[216:217], v234 offset:21504
    ds_read_b64_tr_b16 a[218:219], v234 offset:22528
    ds_read_b64_tr_b16 a[220:221], v236 offset:21504
    ds_read_b64_tr_b16 a[222:223], v236 offset:22528
    s_waitcnt vmcnt(2)
    s_barrier
    s_cmp_eq_u32 s52, 0
    s_cbranch_scc0 SK_30
    v_mov_b32 v5, s59
    s_mov_b64 exec, 1
    s_cmp_eq_u32 s87, 0
    s_cbranch_scc1 WT_31
    buffer_store_dword v5, off, s[48:51], s80
WB_32:
    s_mov_b64 exec, -1
SK_30:
    s_waitcnt vmcnt(1)
    v_xor_b32 v34, s59, v34
    s_waitcnt vmcnt(0)
    v_bitop3_b32 v34, v34, v38, s59 bitop3:0xf6
    v_cmp_ne_u32 s[64:65], 0, v34
    s_nop 0
    s_cmp_eq_u64 s[64:65], 0
    s_cbranch_scc0 L_PM
L_PMD:
    s_nop 0
    ds_write_b64 v242, v[32:33]
    ds_write_b64 v242, v[36:37] offset:1792
    ds_read_b64_tr_b16 a[192:193], v234 offset:25088
    ds_read_b64_tr_b16 a[194:195], v234 offset:26112
    ds_read_b64_tr_b16 a[196:197], v236 offset:25088
    ds_read_b64_tr_b16 a[198:199], v236 offset:26112
    ds_read_b64_tr_b16 a[200:201], v232 offset:25088
    ds_read_b64_tr_b16 a[202:203], v232 offset:26112
    ds_read_b64_tr_b16 a[204:205], v233 offset:25088
    ds_read_b64_tr_b16 a[206:207], v233 offset:26112
    ds_read_b64_tr_b16 a[176:177], v232 offset:28672
    ds_read_b64_tr_b16 a[178:179], v232 offset:29696
    ds_read_b64_tr_b16 a[180:181], v233 offset:28672
    ds_read_b64_tr_b16 a[182:183], v233 offset:29696
    ds_read_b64_tr_b16 a[184:185], v234 offset:28672
    ds_read_b64_tr_b16 a[186:187], v234 offset:29696
    ds_read_b64_tr_b16 a[188:189], v236 offset:28672
    ds_read_b64_tr_b16 a[190:191], v236 offset:29696
    ds_read_b64_tr_b16 a[160:161], v234 offset:32256
    ds_read_b64_tr_b16 a[162:163], v234 offset:33280
    ds_read_b64_tr_b16 a[164:165], v236 offset:32256
    ds_read_b64_tr_b16 a[166:167], v236 offset:33280
    ds_read_b64_tr_b16 a[168:169], v232 offset:32256
    ds_read_b64_tr_b16 a[170:171], v232 offset:33280
    ds_read_b64_tr_b16 a[172:173], v233 offset:32256
    ds_read_b64_tr_b16 a[174:175], v233 offset:33280
    s_mov_b32 s66, 0
L_POL:
    s_add_u32 s66, s66, 1
    s_cmp_gt_u32 s66, 0x40000
    s_cbranch_scc1 L_POD
L_POF:
    buffer_load_dword v5, v2, s[48:51], s60 offen sc1
    s_waitcnt vmcnt(0)
    v_cmp_ne_u32 vcc, s59, v5
    s_cbranch_vccnz L_POL
L_POD:
    buffer_load_dwordx4 v[32:35], v7, s[48:51], s62 offen offset:0 sc1
    buffer_load_dwordx4 v[36:39], v7, s[48:51], s62 offen offset:1024 sc1
    buffer_load_dwordx4 v[40:43], v7, s[48:51], s62 offen offset:2048 sc1
    buffer_load_dwordx4 v[44:47], v7, s[48:51], s62 offen offset:3072 sc1
    s_add_u32 s62, s62, 4096
    buffer_load_dwordx4 v[48:51], v7, s[48:51], s62 offen offset:0 sc1
    buffer_load_dwordx4 v[52:55], v7, s[48:51], s62 offen offset:1024 sc1
    buffer_load_dwordx4 v[56:59], v7, s[48:51], s62 offen offset:2048 sc1
    buffer_load_dwordx4 v[60:63], v7, s[48:51], s62 offen offset:3072 sc1
    s_add_u32 s62, s62, 4096
    buffer_load_dwordx4 v[64:67], v7, s[48:51], s62 offen offset:0 sc1
    s_waitcnt lgkmcnt(0)
    s_barrier
    ds_read_b128 v[200:203], v6 offset:1792
    ds_read_b128 v[208:211], v6 offset:896
    ds_read_b128 v[204:207], v6 offset:1856
    ds_read_b128 v[212:215], v6 offset:960
    v_lshlrev_b32 v176, 16, v160
    v_and_b32 v177, s70, v160
    v_lshlrev_b32 v178, 16, v161
    v_and_b32 v179, s70, v161
    v_lshlrev_b32 v180, 16, v162
    v_and_b32 v181, s70, v162
    v_lshlrev_b32 v182, 16, v163
    v_and_b32 v183, s70, v163
    v_lshlrev_b32 v184, 16, v164
    v_and_b32 v185, s70, v164
    v_lshlrev_b32 v186, 16, v165
    v_and_b32 v187, s70, v165
    v_lshlrev_b32 v188, 16, v166
    v_and_b32 v189, s70, v166
    v_lshlrev_b32 v190, 16, v167
    v_and_b32 v191, s70, v167
    ds_read_b64_tr_b16 a[144:145], v232 offset:35840
    ds_read_b64_tr_b16 a[146:147], v232 offset:36864
    ds_read_b64_tr_b16 a[148:149], v233 offset:35840
    ds_read_b64_tr_b16 a[150:151], v233 offset:36864
    ds_read_b64_tr_b16 a[152:153], v234 offset:35840
    ds_read_b64_tr_b16 a[154:155], v234 offset:36864
    ds_read_b64_tr_b16 a[156:157], v236 offset:35840
    ds_read_b64_tr_b16 a[158:159], v236 offset:36864
    ds_read_b64_tr_b16 a[128:129], v234 offset:39424
    ds_read_b64_tr_b16 a[130:131], v234 offset:40448
    ds_read_b64_tr_b16 a[132:133], v236 offset:39424
    ds_read_b64_tr_b16 a[134:135], v236 offset:40448
    ds_read_b64_tr_b16 a[136:137], v232 offset:39424
    ds_read_b64_tr_b16 a[138:139], v232 offset:40448
    ds_read_b64_tr_b16 a[140:141], v233 offset:39424
    ds_read_b64_tr_b16 a[142:143], v233 offset:40448
    s_waitcnt vmcnt(8)
    v_mfma_f32_16x16x32_bf16 v[160:163], v[96:99], v[32:35], 0
    buffer_load_dwordx4 v[68:71], v7, s[48:51], s62 offen offset:1024 sc1
    v_mfma_f32_16x16x32_bf16 v[164:167], v[100:103], v[32:35], 0
    ds_read_b64_tr_b16 a[112:113], v232 offset:43008
    ds_read_b64_tr_b16 a[114:115], v232 offset:44032
    v_mfma_f32_16x16x32_bf16 v[168:171], v[104:107], v[32:35], 0
    ds_read_b64_tr_b16 a[116:117], v233 offset:43008
    ds_read_b64_tr_b16 a[118:119], v233 offset:44032
    v_mfma_f32_16x16x32_bf16 v[172:175], v[108:111], v[32:35], 0
    ds_read_b64_tr_b16 a[120:121], v234 offset:43008
    ds_read_b64_tr_b16 a[122:123], v234 offset:44032
    s_waitcnt vmcnt(8)
    v_mfma_f32_16x16x32_bf16 v[160:163], v[112:115], v[36:39], v[160:163]
    buffer_load_dwordx4 v[72:75], v7, s[48:51], s62 offen offset:2048 sc1
    v_mfma_f32_16x16x32_bf16 v[164:167], v[116:119], v[36:39], v[164:167]
    ds_read_b64_tr_b16 a[124:125], v236 offset:43008
    ds_read_b64_tr_b16 a[126:127], v236 offset:44032
    v_mfma_f32_16x16x32_bf16 v[168:171], v[120:123], v[36:39], v[168:171]
    ds_read_b64_tr_b16 a[96:97], v234 offset:46592
    ds_read_b64_tr_b16 a[98:99], v234 offset:47616
    v_mfma_f32_16x16x32_bf16 v[172:175], v[124:127], v[36:39], v[172:175]
    ds_read_b64_tr_b16 a[100:101], v236 offset:46592
    ds_read_b64_tr_b16 a[102:103], v236 offset:47616
    s_waitcnt vmcnt(8)
    v_mfma_f32_16x16x32_bf16 v[160:163], v[128:131], v[40:43], v[160:163]
    buffer_load_dwordx4 v[76:79], v7, s[48:51], s62 offen offset:3072 sc1
    s_add_u32 s62, s62, 4096
    v_mfma_f32_16x16x32_bf16 v[164:167], v[132:135], v[40:43], v[164:167]
    ds_read_b64_tr_b16 a[104:105], v232 offset:46592
    ds_read_b64_tr_b16 a[106:107], v232 offset:47616
    v_mfma_f32_16x16x32_bf16 v[168:171], v[136:139], v[40:43], v[168:171]
    ds_read_b64_tr_b16 a[108:109], v233 offset:46592
    ds_read_b64_tr_b16 a[110:111], v233 offset:47616
    v_mfma_f32_16x16x32_bf16 v[172:175], v[140:143], v[40:43], v[172:175]
    ds_read_b64_tr_b16 a[80:81], v232 offset:50176
    ds_read_b64_tr_b16 a[82:83], v232 offset:51200
    s_waitcnt vmcnt(8)
    v_mfma_f32_16x16x32_bf16 v[160:163], v[144:147], v[44:47], v[160:163]
    buffer_load_dwordx4 v[80:83], v7, s[48:51], s62 offen offset:0 sc1
    v_mfma_f32_16x16x32_bf16 v[164:167], v[148:151], v[44:47], v[164:167]
    ds_read_b64_tr_b16 a[84:85], v233 offset:50176
    ds_read_b64_tr_b16 a[86:87], v233 offset:51200
    v_mfma_f32_16x16x32_bf16 v[168:171], v[152:155], v[44:47], v[168:171]
    ds_read_b64_tr_b16 a[88:89], v234 offset:50176
    ds_read_b64_tr_b16 a[90:91], v234 offset:51200
    v_mfma_f32_16x16x32_bf16 v[172:175], v[156:159], v[44:47], v[172:175]
    ds_read_b64_tr_b16 a[92:93], v236 offset:50176
    ds_read_b64_tr_b16 a[94:95], v236 offset:51200
    s_waitcnt vmcnt(8)
    v_mfma_f32_16x16x32_bf16 v[160:163], a[240:243], v[48:51], v[160:163]
    buffer_load_dwordx4 v[84:87], v7, s[48:51], s62 offen offset:1024 sc1
    v_mfma_f32_16x16x32_bf16 v[164:167], a[244:247], v[48:51], v[164:167]
    ds_read_b64_tr_b16 a[64:65], v234 offset:53760
    ds_read_b64_tr_b16 a[66:67], v234 offset:54784
    v_mfma_f32_16x16x32_bf16 v[168:171], a[248:251], v[48:51], v[168:171]
    ds_read_b64_tr_b16 a[68:69], v236 offset:53760
    ds_read_b64_tr_b16 a[70:71], v236 offset:54784
    v_mfma_f32_16x16x32_bf16 v[172:175], a[252:255], v[48:51], v[172:175]
    ds_read_b64_tr_b16 a[72:73], v232 offset:53760
    ds_read_b64_tr_b16 a[74:75], v232 offset:54784
    s_waitcnt vmcnt(8)
    v_mfma_f32_16x16x32_bf16 v[160:163], a[224:227], v[52:55], v[160:163]
    buffer_load_dwordx4 v[88:91], v7, s[48:51], s62 offen offset:2048 sc1
    v_mfma_f32_16x16x32_bf16 v[164:167], a[228:231], v[52:55], v[164:167]
    ds_read_b64_tr_b16 a[76:77], v233 offset:53760
    ds_read_b64_tr_b16 a[78:79], v233 offset:54784
    v_mfma_f32_16x16x32_bf16 v[168:171], a[232:235], v[52:55], v[168:171]
    s_waitcnt lgkmcnt(11)
    v_lshlrev_b32 v216, 16, v200
    v_and_b32_e64 v217, s70, v200
    v_mfma_f32_16x16x32_bf16 v[172:175], a[236:239], v[52:55], v[172:175]
    v_lshlrev_b32_e64 v218, 16, v201
    v_and_b32 v219, s70, v201
    s_waitcnt vmcnt(8)
    v_mfma_f32_16x16x32_bf16 v[160:163], a[208:211], v[56:59], v[160:163]
    buffer_load_dwordx4 v[92:95], v7, s[48:51], s62 offen offset:3072 sc1
    v_mfma_f32_16x16x32_bf16 v[164:167], a[212:215], v[56:59], v[164:167]
    v_lshlrev_b32 v220, 16, v202
    v_and_b32 v221, s70, v202
    v_mfma_f32_16x16x32_bf16 v[168:171], a[216:219], v[56:59], v[168:171]
    v_lshlrev_b32 v222, 16, v203
    v_and_b32 v223, s70, v203
    v_mfma_f32_16x16x32_bf16 v[172:175], a[220:223], v[56:59], v[172:175]
    v_lshlrev_b32_e64 v224, 16, v204
    v_and_b32 v225, s70, v204
    s_waitcnt vmcnt(8)
    v_mfma_f32_16x16x32_bf16 v[160:163], a[192:195], v[60:63], v[160:163]
    v_lshlrev_b32 v226, 16, v205
    v_and_b32 v227, s70, v205
    v_mfma_f32_16x16x32_bf16 v[164:167], a[196:199], v[60:63], v[164:167]
    v_lshlrev_b32 v228, 16, v206
    v_and_b32 v229, s70, v206
    v_mfma_f32_16x16x32_bf16 v[168:171], a[200:203], v[60:63], v[168:171]
    v_lshlrev_b32 v230, 16, v207
    v_and_b32 v231, s70, v207
    v_mfma_f32_16x16x32_bf16 v[172:175], a[204:207], v[60:63], v[172:175]
    v_lshlrev_b32_e64 v192, 16, v208
    v_and_b32 v193, s70, v208
    s_waitcnt vmcnt(7)
    v_mfma_f32_16x16x32_bf16 v[160:163], a[176:179], v[64:67], v[160:163]
    v_lshlrev_b32 v194, 16, v209
    v_and_b32 v195, s70, v209
    v_mfma_f32_16x16x32_bf16 v[164:167], a[180:183], v[64:67], v[164:167]
    v_lshlrev_b32 v196, 16, v210
    v_and_b32 v197, s70, v210
    v_mfma_f32_16x16x32_bf16 v[168:171], a[184:187], v[64:67], v[168:171]
    v_lshlrev_b32 v198, 16, v211
    v_and_b32 v199, s70, v211
    v_mfma_f32_16x16x32_bf16 v[172:175], a[188:191], v[64:67], v[172:175]
    v_lshlrev_b32_e64 v200, 16, v212
    v_and_b32 v201, s70, v212
    s_waitcnt vmcnt(6)
    v_mfma_f32_16x16x32_bf16 v[160:163], a[160:163], v[68:71], v[160:163]
    v_lshlrev_b32 v202, 16, v213
    v_and_b32 v203, s70, v213
    v_mfma_f32_16x16x32_bf16 v[164:167], a[164:167], v[68:71], v[164:167]
    v_lshlrev_b32 v204, 16, v214
    v_and_b32 v205, s70, v214
    v_mfma_f32_16x16x32_bf16 v[168:171], a[168:171], v[68:71], v[168:171]
    v_lshlrev_b32 v206, 16, v215
    v_and_b32 v207, s70, v215
    v_mfma_f32_16x16x32_bf16 v[172:175], a[172:175], v[68:71], v[172:175]
    s_lshl_b32 s60, s72, 15
    s_lshl_b32 s61, s58, 11
    s_add_u32 m0, s67, 0
    s_xor_b32 s66, s94, 1049088
    buffer_load_dwordx4 v16, s[24:27], s66 offen offset:0 lds
    buffer_load_dwordx4 v17, s[24:27], s66 offen offset:1024 lds
    buffer_load_dwordx4 v18, s[24:27], s66 offen offset:2048 lds
    buffer_load_dwordx4 v19, s[24:27], s66 offen offset:3072 lds
    s_waitcnt vmcnt(9)
    v_mfma_f32_16x16x32_bf16 v[160:163], a[144:147], v[72:75], v[160:163]
    s_add_u32 s60, s60, s61
    s_add_u32 s60, s60, 2113536
    v_mfma_f32_16x16x32_bf16 v[164:167], a[148:151], v[72:75], v[164:167]
    s_lshl_b32 s63, s72, 8
    s_add_u32 s63, s63, s58
    v_mfma_f32_16x16x32_bf16 v[168:171], a[152:155], v[72:75], v[168:171]
    s_lshl_b32 s63, s63, 7
    s_add_u32 s63, s63, 2127872
    v_mfma_f32_16x16x32_bf16 v[172:175], a[156:159], v[72:75], v[172:175]
    s_mul_i32 s90, s52, 401408
    s_lshl_b32 s61, s71, 7
    s_waitcnt vmcnt(8)
    v_mfma_f32_16x16x32_bf16 v[160:163], a[128:131], v[76:79], v[160:163]
    s_add_u32 s90, s90, s61
    s_lshl_b32 s64, s57, 5
    v_mfma_f32_16x16x32_bf16 v[164:167], a[132:135], v[76:79], v[164:167]
    s_add_u32 s64, s64, s58
    s_lshl_b32 s64, s64, 2
    v_mfma_f32_16x16x32_bf16 v[168:171], a[136:139], v[76:79], v[168:171]
    s_add_u32 s64, s64, 20480
    v_lshlrev_b32_e64 v3, 2, v0
    v_mfma_f32_16x16x32_bf16 v[172:175], a[140:143], v[76:79], v[172:175]
    s_waitcnt vmcnt(7)
    v_mfma_f32_16x16x32_bf16 v[160:163], a[112:115], v[80:83], v[160:163]
    v_mfma_f32_16x16x32_bf16 v[164:167], a[116:119], v[80:83], v[164:167]
    v_mfma_f32_16x16x32_bf16 v[168:171], a[120:123], v[80:83], v[168:171]
    v_mfma_f32_16x16x32_bf16 v[172:175], a[124:127], v[80:83], v[172:175]
    s_waitcnt vmcnt(6)
    v_mfma_f32_16x16x32_bf16 v[160:163], a[96:99], v[84:87], v[160:163]
    v_mfma_f32_16x16x32_bf16 v[164:167], a[100:103], v[84:87], v[164:167]
    v_mfma_f32_16x16x32_bf16 v[168:171], a[104:107], v[84:87], v[168:171]
    v_mfma_f32_16x16x32_bf16 v[172:175], a[108:111], v[84:87], v[172:175]
    s_add_u32 m0, s67, 4096
    s_xor_b32 s66, s94, 1049344
    buffer_load_dwordx4 v16, s[24:27], s66 offen offset:0 lds
    buffer_load_dwordx4 v17, s[24:27], s66 offen offset:1024 lds
    buffer_load_dwordx4 v18, s[24:27], s66 offen offset:2048 lds
    buffer_load_dwordx4 v19, s[24:27], s66 offen offset:3072 lds
    s_waitcnt vmcnt(9)
    v_mfma_f32_16x16x32_bf16 v[160:163], a[80:83], v[88:91], v[160:163]
    v_mfma_f32_16x16x32_bf16 v[164:167], a[84:87], v[88:91], v[164:167]
    s_waitcnt lgkmcnt(0)
    v_mfma_f32_16x16x32_bf16 v[168:171], a[88:91], v[88:91], v[168:171]
    v_mfma_f32_16x16x32_bf16 v[172:175], a[92:95], v[88:91], v[172:175]
    s_waitcnt vmcnt(8)
    v_mfma_f32_16x16x32_bf16 v[160:163], a[64:67], v[92:95], v[160:163]
    v_mfma_f32_16x16x32_bf16 v[164:167], a[68:71], v[92:95], v[164:167]
    v_mfma_f32_16x16x32_bf16 v[168:171], a[72:75], v[92:95], v[168:171]
    v_mfma_f32_16x16x32_bf16 v[172:175], a[76:79], v[92:95], v[172:175]
    s_nop 4
    v_pk_fma_f32 v[176:177], v[160:161], v[216:217], v[176:177]
    v_pk_fma_f32 v[178:179], v[162:163], v[218:219], v[178:179]
    v_pk_fma_f32 v[180:181], v[164:165], v[220:221], v[180:181]
    v_pk_fma_f32 v[182:183], v[166:167], v[222:223], v[182:183]
    v_pk_fma_f32 v[184:185], v[168:169], v[224:225], v[184:185]
    v_pk_fma_f32 v[186:187], v[170:171], v[226:227], v[186:187]
    v_pk_fma_f32 v[188:189], v[172:173], v[228:229], v[188:189]
    v_pk_fma_f32 v[190:191], v[174:175], v[230:231], v[190:191]
    v_pk_mul_f32 v[192:193], v[176:177], v[192:193]
    v_pk_mul_f32 v[194:195], v[178:179], v[194:195]
    v_pk_mul_f32 v[196:197], v[180:181], v[196:197]
    v_pk_mul_f32 v[198:199], v[182:183], v[198:199]
    v_pk_mul_f32 v[200:201], v[184:185], v[200:201]
    v_pk_mul_f32 v[202:203], v[186:187], v[202:203]
    v_pk_mul_f32 v[204:205], v[188:189], v[204:205]
    v_pk_mul_f32 v[206:207], v[190:191], v[206:207]
    v_cvt_pk_bf16_f32 v64, v192, v193
    v_cvt_pk_bf16_f32 v65, v194, v195
    v_cvt_pk_bf16_f32 v66, v196, v197
    v_cvt_pk_bf16_f32 v67, v198, v199
    v_cvt_pk_bf16_f32 v68, v200, v201
    v_cvt_pk_bf16_f32 v69, v202, v203
    v_cvt_pk_bf16_f32 v70, v204, v205
    v_cvt_pk_bf16_f32 v71, v206, v207
    s_cmp_eq_u32 s87, 0
    s_cbranch_scc1 WT_33
    buffer_store_dwordx4 v[64:67], v7, s[48:51], s60 offen offset:0
    buffer_store_dwordx4 v[68:71], v7, s[48:51], s60 offen offset:1024
WB_34:
    v_pk_add_f32 v[72:73], v[176:177], v[178:179]
    v_pk_mul_f32 v[74:75], v[176:177], v[176:177]
    v_pk_fma_f32 v[74:75], v[178:179], v[178:179], v[74:75]
    v_pk_add_f32 v[72:73], v[72:73], v[180:181]
    v_pk_fma_f32 v[74:75], v[180:181], v[180:181], v[74:75]
    v_pk_add_f32 v[72:73], v[72:73], v[182:183]
    v_pk_fma_f32 v[74:75], v[182:183], v[182:183], v[74:75]
    v_pk_add_f32 v[72:73], v[72:73], v[184:185]
    v_pk_fma_f32 v[74:75], v[184:185], v[184:185], v[74:75]
    v_pk_add_f32 v[72:73], v[72:73], v[186:187]
    v_pk_fma_f32 v[74:75], v[186:187], v[186:187], v[74:75]
    v_pk_add_f32 v[72:73], v[72:73], v[188:189]
    v_pk_fma_f32 v[74:75], v[188:189], v[188:189], v[74:75]
    v_pk_add_f32 v[72:73], v[72:73], v[190:191]
    v_pk_fma_f32 v[74:75], v[190:191], v[190:191], v[74:75]
    v_add_f32 v72, v72, v73
    v_add_f32 v74, v74, v75
    v_cvt_pk_bf16_f32 v240, v176, v177
    v_cvt_pk_bf16_f32 v241, v178, v179
    v_permlane16_swap_b32 v72, v74
    v_add_f32 v72, v72, v74
    v_mov_b32_e64 v74, v72
    v_cvt_pk_bf16_f32 v242, v180, v181
    v_cvt_pk_bf16_f32 v243, v182, v183
    v_permlane32_swap_b32_e64 v72, v74
    v_add_f32 v72, v72, v74
    s_mov_b32 exec_hi, 0
    s_cmp_eq_u32 s87, 0
    s_cbranch_scc1 WT_35
    buffer_store_dword v72, v3, s[48:51], s63 offen
WB_36:
    s_mov_b32 exec_hi, -1
    v_cvt_pk_bf16_f32 v244, v184, v185
    v_cvt_pk_bf16_f32 v245, v186, v187
    v_cvt_pk_bf16_f32 v246, v188, v189
    v_cvt_pk_bf16_f32 v247, v190, v191
    s_waitcnt vmcnt(3)
    ds_read_b128 a[32:35], v20 offset:49152
    ds_read_b128 a[36:39], v21 offset:49152
    ds_read_b128 a[40:43], v22 offset:49152
    ds_read_b128 a[44:47], v23 offset:49152
    ds_read_b128 a[48:51], v20 offset:53248
    ds_read_b128 a[52:55], v21 offset:53248
    ds_read_b128 a[56:59], v22 offset:53248
    ds_read_b128 a[60:63], v23 offset:53248
    s_waitcnt vmcnt(0)
    s_waitcnt lgkmcnt(0)
    s_barrier
    s_cmp_eq_u32 s52, 0
    s_cbranch_scc0 SK_37
    v_mov_b32 v2, s59
    s_mov_b64 exec, 1
    s_cmp_eq_u32 s87, 0
    s_cbranch_scc1 WT_38
    buffer_store_dword v2, off, s[48:51], s64
WB_39:
    s_mov_b64 exec, -1
SK_37:
    v_min_u32 v3, 6, v0
    v_lshlrev_b32 v3, 2, v3
    s_lshr_b32 s61, s52, 1
    s_lshl1_add_u32 s60, s55, s61
    s_lshl_b32 s60, s60, 7
    s_add_u32 s60, s60, 20480
    s_lshl2_add_u32 s72, s55, s52
    s_lshl_b32 s62, s72, 16
    s_add_u32 s62, s62, 2113536
    s_add_u32 s63, s62, 32768
    s_add_u32 s64, s62, 14336
    v_lshrrev_b32 v2, 5, v0
    v_lshlrev_b32 v2, 15, v2
    v_and_b32 v5, 31, v0
    v_lshl_add_u32 v2, v5, 2, v2
    v_add_u32 v248, 58368, v8
    v_add_u32 v249, 58368, v9
    v_add_u32 v250, 58368, v10
    v_add_u32 v251, 58368, v11
    v_lshlrev_b32_e64 v6, 5, v1
    v_add_u32 v6, 119296, v6
    ds_read_b64_tr_b16 v[200:201], v248 offset:0
    ds_read_b64_tr_b16 v[202:203], v248 offset:2048
    ds_read_b64_tr_b16 v[204:205], v249 offset:0
    ds_read_b64_tr_b16 v[206:207], v249 offset:2048
    ds_read_b64_tr_b16 v[208:209], v250 offset:0
    ds_read_b64_tr_b16 v[210:211], v250 offset:2048
    ds_read_b64_tr_b16 v[212:213], v251 offset:0
    ds_read_b64_tr_b16 v[214:215], v251 offset:2048
    s_mov_b32 s66, 0
L_PYL:
    s_add_u32 s66, s66, 1
    s_cmp_gt_u32 s66, 0x40000
    s_cbranch_scc1 L_PYD
L_PYF:
    buffer_load_dword v5, v3, s[48:51], s60 offen sc1
    s_waitcnt vmcnt(0)
    v_cmp_ne_u32 vcc, s59, v5
    s_cbranch_vccnz L_PYL
L_PYD:
    buffer_load_dwordx4 v[24:27], v7, s[48:51], s62 offen offset:0 sc1
    buffer_load_dwordx4 v[28:31], v7, s[48:51], s63 offen offset:0 sc1
    buffer_load_dwordx4 v[32:35], v7, s[48:51], s62 offen offset:1024 sc1
    buffer_load_dwordx4 v[36:39], v7, s[48:51], s63 offen offset:1024 sc1
    buffer_load_dwordx4 v[40:43], v7, s[48:51], s62 offen offset:2048 sc1
    buffer_load_dwordx4 v[44:47], v7, s[48:51], s63 offen offset:2048 sc1
    buffer_load_dwordx4 v[48:51], v7, s[48:51], s62 offen offset:3072 sc1
    s_add_u32 s62, s62, 4096
    buffer_load_dwordx4 v[52:55], v7, s[48:51], s63 offen offset:3072 sc1
    s_add_u32 s63, s63, 4096
    buffer_load_dwordx4 v[56:59], v7, s[48:51], s62 offen offset:0 sc1
    buffer_load_dwordx4 v[60:63], v7, s[48:51], s63 offen offset:0 sc1
    v_and_b32 v4, 31, v0
    v_lshlrev_b32 v4, 4, v4
    v_add_u32 v12, 7168, v4
    v_cndmask_b32 v12, v12, v4, s[68:69]
    v_add_u32 v13, 119296, v7
    s_lshl_b32 s60, s71, 9
    s_add_u32 s60, s60, 49152
    s_lshl_b32 s73, s72, 13
    s_add_u32 s73, s73, 6815744
    s_lshl_b32 s74, s71, 9
    s_add_u32 s74, s74, s73
    s_waitcnt vmcnt(9) lgkmcnt(0)
    v_mfma_f32_16x16x32_bf16 v[136:139], v[200:203], v[24:27], 0
    ds_read_b64_tr_b16 v[216:217], v248 offset:4096
    s_waitcnt vmcnt(8)
    v_mfma_f32_16x16x32_bf16 v[140:143], v[200:203], v[28:31], 0
    ds_read_b64_tr_b16 v[218:219], v248 offset:6144
    buffer_load_dwordx4 v[64:67], v7, s[48:51], s62 offen offset:1024 sc1
    v_mfma_f32_16x16x32_bf16 v[144:147], v[204:207], v[24:27], 0
    ds_read_b64_tr_b16 v[220:221], v249 offset:4096
    v_mfma_f32_16x16x32_bf16 v[148:151], v[204:207], v[28:31], 0
    ds_read_b64_tr_b16 v[222:223], v249 offset:6144
    buffer_load_dwordx4 v[68:71], v7, s[48:51], s63 offen offset:1024 sc1
    v_mfma_f32_16x16x32_bf16 v[152:155], v[208:211], v[24:27], 0
    ds_read_b64_tr_b16 v[224:225], v250 offset:4096
    v_mfma_f32_16x16x32_bf16 v[156:159], v[208:211], v[28:31], 0
    ds_read_b64_tr_b16 v[226:227], v250 offset:6144
    v_mfma_f32_16x16x32_bf16 v[160:163], v[212:215], v[24:27], 0
    ds_read_b64_tr_b16 v[228:229], v251 offset:4096
    v_mfma_f32_16x16x32_bf16 v[164:167], v[212:215], v[28:31], 0
    ds_read_b64_tr_b16 v[230:231], v251 offset:6144
    s_waitcnt vmcnt(9) lgkmcnt(6)
    v_mfma_f32_16x16x32_bf16 v[136:139], v[216:219], v[32:35], v[136:139]
    ds_read_b64_tr_b16 v[200:201], v248 offset:8192
    s_waitcnt vmcnt(8)
    v_mfma_f32_16x16x32_bf16 v[140:143], v[216:219], v[36:39], v[140:143]
    ds_read_b64_tr_b16 v[202:203], v248 offset:10240
    buffer_load_dwordx4 v[72:75], v7, s[48:51], s62 offen offset:2048 sc1
    s_waitcnt lgkmcnt(6)
    v_mfma_f32_16x16x32_bf16 v[144:147], v[220:223], v[32:35], v[144:147]
    ds_read_b64_tr_b16 v[204:205], v249 offset:8192
    v_mfma_f32_16x16x32_bf16 v[148:151], v[220:223], v[36:39], v[148:151]
    ds_read_b64_tr_b16 v[206:207], v249 offset:10240
    buffer_load_dwordx4 v[76:79], v7, s[48:51], s63 offen offset:2048 sc1
    s_waitcnt lgkmcnt(6)
    v_mfma_f32_16x16x32_bf16 v[152:155], v[224:227], v[32:35], v[152:155]
    ds_read_b64_tr_b16 v[208:209], v250 offset:8192
    v_mfma_f32_16x16x32_bf16 v[156:159], v[224:227], v[36:39], v[156:159]
    ds_read_b64_tr_b16 v[210:211], v250 offset:10240
    s_waitcnt lgkmcnt(6)
    v_mfma_f32_16x16x32_bf16 v[160:163], v[228:231], v[32:35], v[160:163]
    ds_read_b64_tr_b16 v[212:213], v251 offset:8192
    v_mfma_f32_16x16x32_bf16 v[164:167], v[228:231], v[36:39], v[164:167]
    ds_read_b64_tr_b16 v[214:215], v251 offset:10240
    s_waitcnt vmcnt(9) lgkmcnt(6)
    v_mfma_f32_16x16x32_bf16 v[136:139], v[200:203], v[40:43], v[136:139]
    ds_read_b64_tr_b16 v[216:217], v248 offset:12288
    s_waitcnt vmcnt(8)
    v_mfma_f32_16x16x32_bf16 v[140:143], v[200:203], v[44:47], v[140:143]
    ds_read_b64_tr_b16 v[218:219], v248 offset:14336
    buffer_load_dwordx4 v[80:83], v7, s[48:51], s62 offen offset:3072 sc1
    s_add_u32 s62, s62, 4096
    s_waitcnt lgkmcnt(6)
    v_mfma_f32_16x16x32_bf16 v[144:147], v[204:207], v[40:43], v[144:147]
    ds_read_b64_tr_b16 v[220:221], v249 offset:12288
    v_mfma_f32_16x16x32_bf16 v[148:151], v[204:207], v[44:47], v[148:151]
    ds_read_b64_tr_b16 v[222:223], v249 offset:14336
    buffer_load_dwordx4 v[84:87], v7, s[48:51], s63 offen offset:3072 sc1
    s_add_u32 s63, s63, 4096
    s_waitcnt lgkmcnt(6)
    v_mfma_f32_16x16x32_bf16 v[152:155], v[208:211], v[40:43], v[152:155]
    ds_read_b64_tr_b16 v[224:225], v250 offset:12288
    v_mfma_f32_16x16x32_bf16 v[156:159], v[208:211], v[44:47], v[156:159]
    ds_read_b64_tr_b16 v[226:227], v250 offset:14336
    buffer_load_dwordx4 v[168:171], v12, s[48:51], s60 offen sc1
    s_waitcnt lgkmcnt(6)
    v_mfma_f32_16x16x32_bf16 v[160:163], v[212:215], v[40:43], v[160:163]
    ds_read_b64_tr_b16 v[228:229], v251 offset:12288
    v_mfma_f32_16x16x32_bf16 v[164:167], v[212:215], v[44:47], v[164:167]
    ds_read_b64_tr_b16 v[230:231], v251 offset:14336
    s_waitcnt vmcnt(10) lgkmcnt(6)
    v_mfma_f32_16x16x32_bf16 v[136:139], v[216:219], v[48:51], v[136:139]
    ds_read_b64_tr_b16 v[200:201], v248 offset:16384
    s_waitcnt vmcnt(9)
    v_mfma_f32_16x16x32_bf16 v[140:143], v[216:219], v[52:55], v[140:143]
    ds_read_b64_tr_b16 v[202:203], v248 offset:18432
    buffer_load_dwordx4 v[88:91], v7, s[48:51], s62 offen offset:0 sc1
    s_waitcnt lgkmcnt(6)
    v_mfma_f32_16x16x32_bf16 v[144:147], v[220:223], v[48:51], v[144:147]
    ds_read_b64_tr_b16 v[204:205], v249 offset:16384
    v_mfma_f32_16x16x32_bf16 v[148:151], v[220:223], v[52:55], v[148:151]
    ds_read_b64_tr_b16 v[206:207], v249 offset:18432
    buffer_load_dwordx4 v[92:95], v7, s[48:51], s63 offen offset:0 sc1
    s_waitcnt lgkmcnt(6)
    v_mfma_f32_16x16x32_bf16 v[152:155], v[224:227], v[48:51], v[152:155]
    ds_read_b64_tr_b16 v[208:209], v250 offset:16384
    v_mfma_f32_16x16x32_bf16 v[156:159], v[224:227], v[52:55], v[156:159]
    ds_read_b64_tr_b16 v[210:211], v250 offset:18432
    s_waitcnt lgkmcnt(6)
    v_mfma_f32_16x16x32_bf16 v[160:163], v[228:231], v[48:51], v[160:163]
    ds_read_b64_tr_b16 v[212:213], v251 offset:16384
    v_mfma_f32_16x16x32_bf16 v[164:167], v[228:231], v[52:55], v[164:167]
    ds_read_b64_tr_b16 v[214:215], v251 offset:18432
    s_waitcnt vmcnt(10) lgkmcnt(6)
    v_mfma_f32_16x16x32_bf16 v[136:139], v[200:203], v[56:59], v[136:139]
    ds_read_b64_tr_b16 v[216:217], v248 offset:20480
    s_waitcnt vmcnt(9)
    v_mfma_f32_16x16x32_bf16 v[140:143], v[200:203], v[60:63], v[140:143]
    ds_read_b64_tr_b16 v[218:219], v248 offset:22528
    buffer_load_dwordx4 v[96:99], v7, s[48:51], s62 offen offset:1024 sc1
    s_waitcnt lgkmcnt(6)
    v_mfma_f32_16x16x32_bf16 v[144:147], v[204:207], v[56:59], v[144:147]
    ds_read_b64_tr_b16 v[220:221], v249 offset:20480
    v_mfma_f32_16x16x32_bf16 v[148:151], v[204:207], v[60:63], v[148:151]
    ds_read_b64_tr_b16 v[222:223], v249 offset:22528
    buffer_load_dwordx4 v[100:103], v7, s[48:51], s63 offen offset:1024 sc1
    s_waitcnt lgkmcnt(6)
    v_mfma_f32_16x16x32_bf16 v[152:155], v[208:211], v[56:59], v[152:155]
    ds_read_b64_tr_b16 v[224:225], v250 offset:20480
    v_mfma_f32_16x16x32_bf16 v[156:159], v[208:211], v[60:63], v[156:159]
    ds_read_b64_tr_b16 v[226:227], v250 offset:22528
    s_waitcnt lgkmcnt(6)
    v_mfma_f32_16x16x32_bf16 v[160:163], v[212:215], v[56:59], v[160:163]
    ds_read_b64_tr_b16 v[228:229], v251 offset:20480
    v_mfma_f32_16x16x32_bf16 v[164:167], v[212:215], v[60:63], v[164:167]
    ds_read_b64_tr_b16 v[230:231], v251 offset:22528
    s_waitcnt vmcnt(10) lgkmcnt(6)
    v_mfma_f32_16x16x32_bf16 v[136:139], v[216:219], v[64:67], v[136:139]
    ds_read_b64_tr_b16 v[200:201], v248 offset:24576
    s_waitcnt vmcnt(9)
    v_mfma_f32_16x16x32_bf16 v[140:143], v[216:219], v[68:71], v[140:143]
    ds_read_b64_tr_b16 v[202:203], v248 offset:26624
    buffer_load_dwordx4 v[104:107], v7, s[48:51], s62 offen offset:2048 sc1
    s_waitcnt lgkmcnt(6)
    v_mfma_f32_16x16x32_bf16 v[144:147], v[220:223], v[64:67], v[144:147]
    ds_read_b64_tr_b16 v[204:205], v249 offset:24576
    v_mfma_f32_16x16x32_bf16 v[148:151], v[220:223], v[68:71], v[148:151]
    ds_read_b64_tr_b16 v[206:207], v249 offset:26624
    buffer_load_dwordx4 v[108:111], v7, s[48:51], s63 offen offset:2048 sc1
    s_waitcnt lgkmcnt(6)
    v_mfma_f32_16x16x32_bf16 v[152:155], v[224:227], v[64:67], v[152:155]
    ds_read_b64_tr_b16 v[208:209], v250 offset:24576
    v_mfma_f32_16x16x32_bf16 v[156:159], v[224:227], v[68:71], v[156:159]
    ds_read_b64_tr_b16 v[210:211], v250 offset:26624
    s_waitcnt lgkmcnt(6)
    v_mfma_f32_16x16x32_bf16 v[160:163], v[228:231], v[64:67], v[160:163]
    ds_read_b64_tr_b16 v[212:213], v251 offset:24576
    v_mfma_f32_16x16x32_bf16 v[164:167], v[228:231], v[68:71], v[164:167]
    ds_read_b64_tr_b16 v[214:215], v251 offset:26624
    s_waitcnt vmcnt(10) lgkmcnt(6)
    v_mfma_f32_16x16x32_bf16 v[136:139], v[200:203], v[72:75], v[136:139]
    ds_read_b64_tr_b16 v[216:217], v248 offset:28672
    s_waitcnt vmcnt(9)
    v_mfma_f32_16x16x32_bf16 v[140:143], v[200:203], v[76:79], v[140:143]
    ds_read_b64_tr_b16 v[218:219], v248 offset:30720
    buffer_load_dwordx4 v[112:115], v7, s[48:51], s62 offen offset:3072 sc1
    s_add_u32 s62, s62, 4096
    s_waitcnt lgkmcnt(6)
    v_mfma_f32_16x16x32_bf16 v[144:147], v[204:207], v[72:75], v[144:147]
    ds_read_b64_tr_b16 v[220:221], v249 offset:28672
    v_mfma_f32_16x16x32_bf16 v[148:151], v[204:207], v[76:79], v[148:151]
    ds_read_b64_tr_b16 v[222:223], v249 offset:30720
    buffer_load_dwordx4 v[116:119], v7, s[48:51], s63 offen offset:3072 sc1
    s_add_u32 s63, s63, 4096
    s_waitcnt lgkmcnt(6)
    v_mfma_f32_16x16x32_bf16 v[152:155], v[208:211], v[72:75], v[152:155]
    ds_read_b64_tr_b16 v[224:225], v250 offset:28672
    v_mfma_f32_16x16x32_bf16 v[156:159], v[208:211], v[76:79], v[156:159]
    ds_read_b64_tr_b16 v[226:227], v250 offset:30720
    s_waitcnt lgkmcnt(6)
    v_mfma_f32_16x16x32_bf16 v[160:163], v[212:215], v[72:75], v[160:163]
    ds_read_b64_tr_b16 v[228:229], v251 offset:28672
    v_mfma_f32_16x16x32_bf16 v[164:167], v[212:215], v[76:79], v[164:167]
    ds_read_b64_tr_b16 v[230:231], v251 offset:30720
    s_waitcnt vmcnt(10) lgkmcnt(6)
    v_mfma_f32_16x16x32_bf16 v[136:139], v[216:219], v[80:83], v[136:139]
    ds_read_b64_tr_b16 v[200:201], v248 offset:32768
    s_waitcnt vmcnt(9)
    v_mfma_f32_16x16x32_bf16 v[140:143], v[216:219], v[84:87], v[140:143]
    ds_read_b64_tr_b16 v[202:203], v248 offset:34816
    buffer_load_dwordx4 v[120:123], v7, s[48:51], s62 offen offset:0 sc1
    s_waitcnt lgkmcnt(6)
    v_mfma_f32_16x16x32_bf16 v[144:147], v[220:223], v[80:83], v[144:147]
    ds_read_b64_tr_b16 v[204:205], v249 offset:32768
    v_mfma_f32_16x16x32_bf16 v[148:151], v[220:223], v[84:87], v[148:151]
    ds_read_b64_tr_b16 v[206:207], v249 offset:34816
    buffer_load_dwordx4 v[124:127], v7, s[48:51], s63 offen offset:0 sc1
    s_waitcnt lgkmcnt(6)
    v_mfma_f32_16x16x32_bf16 v[152:155], v[224:227], v[80:83], v[152:155]
    ds_read_b64_tr_b16 v[208:209], v250 offset:32768
    v_mfma_f32_16x16x32_bf16 v[156:159], v[224:227], v[84:87], v[156:159]
    ds_read_b64_tr_b16 v[210:211], v250 offset:34816
    s_waitcnt lgkmcnt(6)
    v_mfma_f32_16x16x32_bf16 v[160:163], v[228:231], v[80:83], v[160:163]
    ds_read_b64_tr_b16 v[212:213], v251 offset:32768
    v_mfma_f32_16x16x32_bf16 v[164:167], v[228:231], v[84:87], v[164:167]
    ds_read_b64_tr_b16 v[214:215], v251 offset:34816
    s_waitcnt vmcnt(9) lgkmcnt(6)
    v_mfma_f32_16x16x32_bf16 v[136:139], v[200:203], v[88:91], v[136:139]
    ds_read_b64_tr_b16 v[216:217], v248 offset:36864
    s_waitcnt vmcnt(8)
    v_mfma_f32_16x16x32_bf16 v[140:143], v[200:203], v[92:95], v[140:143]
    ds_read_b64_tr_b16 v[218:219], v248 offset:38912
    buffer_load_dwordx4 v[128:131], v7, s[48:51], s62 offen offset:1024 sc1
    s_waitcnt lgkmcnt(6)
    v_mfma_f32_16x16x32_bf16 v[144:147], v[204:207], v[88:91], v[144:147]
    ds_read_b64_tr_b16 v[220:221], v249 offset:36864
    v_mfma_f32_16x16x32_bf16 v[148:151], v[204:207], v[92:95], v[148:151]
    ds_read_b64_tr_b16 v[222:223], v249 offset:38912
    buffer_load_dwordx4 v[132:135], v7, s[48:51], s63 offen offset:1024 sc1
    s_waitcnt lgkmcnt(6)
    v_mfma_f32_16x16x32_bf16 v[152:155], v[208:211], v[88:91], v[152:155]
    ds_read_b64_tr_b16 v[224:225], v250 offset:36864
    v_mfma_f32_16x16x32_bf16 v[156:159], v[208:211], v[92:95], v[156:159]
    ds_read_b64_tr_b16 v[226:227], v250 offset:38912
    v_cmp_ne_u32 vcc, s59, v171
    s_cbranch_vccnz L_PU
L_PUD:
    s_waitcnt lgkmcnt(6)
    v_mfma_f32_16x16x32_bf16 v[160:163], v[212:215], v[88:91], v[160:163]
    ds_read_b64_tr_b16 v[228:229], v251 offset:36864
    v_mfma_f32_16x16x32_bf16 v[164:167], v[212:215], v[92:95], v[164:167]
    ds_read_b64_tr_b16 v[230:231], v251 offset:38912
    s_mov_b32 s61, 0x0c04000c
    v_perm_b32 v171, v169, v168, s61
    s_waitcnt vmcnt(9) lgkmcnt(6)
    v_mfma_f32_16x16x32_bf16 v[136:139], v[216:219], v[96:99], v[136:139]
    ds_read_b64_tr_b16 v[200:201], v248 offset:40960
    s_waitcnt vmcnt(8)
    v_mfma_f32_16x16x32_bf16 v[140:143], v[216:219], v[100:103], v[140:143]
    ds_read_b64_tr_b16 v[202:203], v248 offset:43008
    s_mov_b32 s61, 0x0402010c
    v_perm_b32 v171, v170, v171, s61
    s_waitcnt lgkmcnt(6)
    v_mfma_f32_16x16x32_bf16 v[144:147], v[220:223], v[96:99], v[144:147]
    ds_read_b64_tr_b16 v[204:205], v249 offset:40960
    v_mfma_f32_16x16x32_bf16 v[148:151], v[220:223], v[100:103], v[148:151]
    ds_read_b64_tr_b16 v[206:207], v249 offset:43008
    ds_write_b128 v13, v[168:171]
    s_waitcnt lgkmcnt(7)
    v_mfma_f32_16x16x32_bf16 v[152:155], v[224:227], v[96:99], v[152:155]
    ds_read_b64_tr_b16 v[208:209], v250 offset:40960
    v_mfma_f32_16x16x32_bf16 v[156:159], v[224:227], v[100:103], v[156:159]
    ds_read_b64_tr_b16 v[210:211], v250 offset:43008
    buffer_load_dword v232, v2, s[48:51], s64 offen offset:0 sc1
    s_waitcnt lgkmcnt(7)
    v_mfma_f32_16x16x32_bf16 v[160:163], v[228:231], v[96:99], v[160:163]
    ds_read_b64_tr_b16 v[212:213], v251 offset:40960
    v_mfma_f32_16x16x32_bf16 v[164:167], v[228:231], v[100:103], v[164:167]
    ds_read_b64_tr_b16 v[214:215], v251 offset:43008
    buffer_load_dword v233, v2, s[48:51], s64 offen offset:128 sc1
    buffer_load_dword v234, v2, s[48:51], s64 offen offset:256 sc1
    buffer_load_dword v235, v2, s[48:51], s64 offen offset:384 sc1
    s_waitcnt vmcnt(11) lgkmcnt(7)
    v_mfma_f32_16x16x32_bf16 v[136:139], v[200:203], v[104:107], v[136:139]
    ds_read_b64_tr_b16 v[216:217], v248 offset:45056
    s_waitcnt vmcnt(10)
    v_mfma_f32_16x16x32_bf16 v[140:143], v[200:203], v[108:111], v[140:143]
    ds_read_b64_tr_b16 v[218:219], v248 offset:47104
    s_mov_b32 exec_hi, 0
    buffer_load_dword v254, v7, s[48:51], s74 offen sc1
    s_mov_b32 exec_hi, -1
    s_waitcnt lgkmcnt(6)
    v_mfma_f32_16x16x32_bf16 v[144:147], v[204:207], v[104:107], v[144:147]
    ds_read_b64_tr_b16 v[220:221], v249 offset:45056
    v_mfma_f32_16x16x32_bf16 v[148:151], v[204:207], v[108:111], v[148:151]
    ds_read_b64_tr_b16 v[222:223], v249 offset:47104
    buffer_load_dword v236, v2, s[48:51], s64 offen offset:512 sc1
    s_waitcnt lgkmcnt(6)
    v_mfma_f32_16x16x32_bf16 v[152:155], v[208:211], v[104:107], v[152:155]
    ds_read_b64_tr_b16 v[224:225], v250 offset:45056
    v_mfma_f32_16x16x32_bf16 v[156:159], v[208:211], v[108:111], v[156:159]
    ds_read_b64_tr_b16 v[226:227], v250 offset:47104
    buffer_load_dword v237, v2, s[48:51], s64 offen offset:640 sc1
    s_waitcnt lgkmcnt(6)
    v_mfma_f32_16x16x32_bf16 v[160:163], v[212:215], v[104:107], v[160:163]
    ds_read_b64_tr_b16 v[228:229], v251 offset:45056
    v_mfma_f32_16x16x32_bf16 v[164:167], v[212:215], v[108:111], v[164:167]
    ds_read_b64_tr_b16 v[230:231], v251 offset:47104
    buffer_load_dword v238, v2, s[48:51], s64 offen offset:768 sc1
    s_waitcnt vmcnt(13) lgkmcnt(6)
    v_mfma_f32_16x16x32_bf16 v[136:139], v[216:219], v[112:115], v[136:139]
    ds_read_b64_tr_b16 v[200:201], v248 offset:49152
    s_waitcnt vmcnt(12)
    v_mfma_f32_16x16x32_bf16 v[140:143], v[216:219], v[116:119], v[140:143]
    ds_read_b64_tr_b16 v[202:203], v248 offset:51200
    s_add_u32 m0, s67, 0
    s_xor_b32 s66, s94, 1049600
    buffer_load_dwordx4 v16, s[24:27], s66 offen offset:0 lds
    buffer_load_dwordx4 v17, s[24:27], s66 offen offset:1024 lds
    buffer_load_dwordx4 v18, s[24:27], s66 offen offset:2048 lds
    buffer_load_dwordx4 v19, s[24:27], s66 offen offset:3072 lds
    s_waitcnt lgkmcnt(6)
    v_mfma_f32_16x16x32_bf16 v[144:147], v[220:223], v[112:115], v[144:147]
    ds_read_b64_tr_b16 v[204:205], v249 offset:49152
    v_mfma_f32_16x16x32_bf16 v[148:151], v[220:223], v[116:119], v[148:151]
    ds_read_b64_tr_b16 v[206:207], v249 offset:51200
    s_add_u32 m0, s91, 0
    s_nop 0
    buffer_load_dwordx4 v15, s[20:23], s90 offen lds
    s_waitcnt lgkmcnt(6)
    v_mfma_f32_16x16x32_bf16 v[152:155], v[224:227], v[112:115], v[152:155]
    ds_read_b64_tr_b16 v[208:209], v250 offset:49152
    v_mfma_f32_16x16x32_bf16 v[156:159], v[224:227], v[116:119], v[156:159]
    ds_read_b64_tr_b16 v[210:211], v250 offset:51200
    s_add_u32 m0, s91, 1024
    s_add_u32 s90, s90, 28672
    buffer_load_dwordx4 v15, s[20:23], s90 offen lds
    s_waitcnt lgkmcnt(5)
    v_mfma_f32_16x16x32_bf16 v[160:163], v[228:231], v[112:115], v[160:163]
    ds_read_b64_tr_b16 v[212:213], v251 offset:49152
    v_mfma_f32_16x16x32_bf16 v[164:167], v[228:231], v[116:119], v[164:167]
    ds_read_b64_tr_b16 v[214:215], v251 offset:51200
    s_waitcnt vmcnt(17) lgkmcnt(6)
    v_mfma_f32_16x16x32_bf16 v[136:139], v[200:203], v[120:123], v[136:139]
    ds_read_b64_tr_b16 v[216:217], v248 offset:53248
    s_waitcnt vmcnt(16)
    v_mfma_f32_16x16x32_bf16 v[140:143], v[200:203], v[124:127], v[140:143]
    ds_read_b64_tr_b16 v[218:219], v248 offset:55296
    s_add_u32 m0, s91, 2048
    s_add_u32 s90, s90, 28672
    buffer_load_dwordx4 v15, s[20:23], s90 offen lds
    s_waitcnt lgkmcnt(6)
    v_mfma_f32_16x16x32_bf16 v[144:147], v[204:207], v[120:123], v[144:147]
    ds_read_b64_tr_b16 v[220:221], v249 offset:53248
    v_mfma_f32_16x16x32_bf16 v[148:151], v[204:207], v[124:127], v[148:151]
    ds_read_b64_tr_b16 v[222:223], v249 offset:55296
    s_add_u32 m0, s91, 3072
    s_add_u32 s90, s90, 28672
    buffer_load_dwordx4 v15, s[20:23], s90 offen lds
    s_waitcnt lgkmcnt(6)
    v_mfma_f32_16x16x32_bf16 v[152:155], v[208:211], v[120:123], v[152:155]
    ds_read_b64_tr_b16 v[224:225], v250 offset:53248
    v_mfma_f32_16x16x32_bf16 v[156:159], v[208:211], v[124:127], v[156:159]
    ds_read_b64_tr_b16 v[226:227], v250 offset:55296
    s_waitcnt lgkmcnt(6)
    v_mfma_f32_16x16x32_bf16 v[160:163], v[212:215], v[120:123], v[160:163]
    ds_read_b64_tr_b16 v[228:229], v251 offset:53248
    v_mfma_f32_16x16x32_bf16 v[164:167], v[212:215], v[124:127], v[164:167]
    ds_read_b64_tr_b16 v[230:231], v251 offset:55296
    s_waitcnt vmcnt(17) lgkmcnt(6)
    v_mfma_f32_16x16x32_bf16 v[136:139], v[216:219], v[128:131], v[136:139]
    s_waitcnt vmcnt(16)
    v_mfma_f32_16x16x32_bf16 v[140:143], v[216:219], v[132:135], v[140:143]
    s_add_u32 m0, s67, 4096
    s_xor_b32 s66, s94, 1049856
    buffer_load_dwordx4 v16, s[24:27], s66 offen offset:0 lds
    buffer_load_dwordx4 v17, s[24:27], s66 offen offset:1024 lds
    buffer_load_dwordx4 v18, s[24:27], s66 offen offset:2048 lds
    buffer_load_dwordx4 v19, s[24:27], s66 offen offset:3072 lds
    s_waitcnt lgkmcnt(4)
    v_mfma_f32_16x16x32_bf16 v[144:147], v[220:223], v[128:131], v[144:147]
    v_mfma_f32_16x16x32_bf16 v[148:151], v[220:223], v[132:135], v[148:151]
    s_add_u32 m0, s91, 4096
    s_add_u32 s90, s90, 28672
    buffer_load_dwordx4 v15, s[20:23], s90 offen lds
    s_waitcnt lgkmcnt(2)
    v_mfma_f32_16x16x32_bf16 v[152:155], v[224:227], v[128:131], v[152:155]
    v_mfma_f32_16x16x32_bf16 v[156:159], v[224:227], v[132:135], v[156:159]
    s_add_u32 m0, s91, 5120
    s_add_u32 s90, s90, 28672
    buffer_load_dwordx4 v15, s[20:23], s90 offen lds
    s_waitcnt lgkmcnt(0)
    v_mfma_f32_16x16x32_bf16 v[160:163], v[228:231], v[128:131], v[160:163]
    v_mfma_f32_16x16x32_bf16 v[164:167], v[228:231], v[132:135], v[164:167]
    s_barrier
    s_waitcnt vmcnt(20)
    v_add_f32 v232, v232, v233
    s_waitcnt vmcnt(19)
    v_add_f32 v232, v232, v234
    s_waitcnt vmcnt(18)
    v_add_f32 v232, v232, v235
    s_waitcnt vmcnt(16)
    v_add_f32 v232, v232, v236
    s_waitcnt vmcnt(15)
    v_add_f32 v232, v232, v237
    s_waitcnt vmcnt(14)
    v_add_f32_e64 v232, v232, v238
    v_mul_f32 v232, 0x3b124925, v232
    v_mov_b32_e64 v234, v232
    s_mov_b32 s96, 0xbdd2d3e8
    s_mov_b32 s97, 0xbdd2d3e8
    ds_read_b128 v[200:203], v6 offset:0
    ds_read_b128 v[204:207], v6 offset:16
    ds_read_b128 v[208:211], v6 offset:128
    ds_read_b128 v[212:215], v6 offset:144
    ds_read_b128 v[216:219], v6 offset:256
    ds_read_b128 v[220:223], v6 offset:272
    ds_read_b128 v[224:227], v6 offset:384
    ds_read_b128 v[228:231], v6 offset:400
    v_permlane16_swap_b32_e64 v232, v234
    v_fma_f32 v234, -v232, v232, v234
    v_max_f32_e64 v234, 0, v234
    v_add_f32 v234, 0x3727c5ac, v234
    v_rsq_f32 v234, v234
    v_mov_b32 v233, v232
    v_mov_b32_e64 v235, v234
    v_mov_b32 v236, 0xc0135761
    v_permlane32_swap_b32_e64 v232, v233
    v_permlane32_swap_b32 v234, v235
    s_waitcnt lgkmcnt(7)
    v_pk_fma_f32 v[136:137], v[200:201], v[232:233], v[136:137] op_sel:[0,0,0] op_sel_hi:[1,0,1] neg_lo:[0,1,0] neg_hi:[0,1,0]
    v_pk_fma_f32 v[138:139], v[202:203], v[232:233], v[138:139] op_sel:[0,0,0] op_sel_hi:[1,0,1] neg_lo:[0,1,0] neg_hi:[0,1,0]
    v_pk_fma_f32 v[140:141], v[200:201], v[232:233], v[140:141] op_sel:[0,1,0] op_sel_hi:[1,1,1] neg_lo:[0,1,0] neg_hi:[0,1,0]
    s_add_u32 m0, s91, 6144
    s_add_u32 s90, s90, 28672
    buffer_load_dwordx4 v15, s[20:23], s90 offen lds
    v_pk_fma_f32 v[142:143], v[202:203], v[232:233], v[142:143] op_sel:[0,1,0] op_sel_hi:[1,1,1] neg_lo:[0,1,0] neg_hi:[0,1,0]
    s_waitcnt lgkmcnt(5)
    s_nop 0
    v_pk_fma_f32 v[136:137], v[136:137], v[234:235], v[204:205] op_sel:[0,0,0] op_sel_hi:[1,0,1]
    v_pk_fma_f32 v[138:139], v[138:139], v[234:235], v[206:207] op_sel:[0,0,0] op_sel_hi:[1,0,1]
    v_pk_fma_f32 v[140:141], v[140:141], v[234:235], v[204:205] op_sel:[0,1,0] op_sel_hi:[1,1,1]
    v_pk_fma_f32 v[142:143], v[142:143], v[234:235], v[206:207] op_sel:[0,1,0] op_sel_hi:[1,1,1]
    v_pk_mul_f32 v[200:201], v[136:137], v[136:137]
    v_pk_mul_f32 v[202:203], v[138:139], v[138:139]
    v_pk_mul_f32 v[204:205], v[140:141], v[140:141]
    s_add_u32 m0, s91, 7168
    s_add_u32 s90, s90, 28672
    buffer_load_dwordx4 v15, s[20:23], s90 offen lds
    v_pk_mul_f32 v[206:207], v[142:143], v[142:143]
    v_pk_fma_f32 v[200:201], v[200:201], s[96:97], v[236:237] op_sel_hi:[1,1,0]
    v_pk_fma_f32 v[202:203], v[202:203], s[96:97], v[236:237] op_sel_hi:[1,1,0]
    v_pk_fma_f32 v[204:205], v[204:205], s[96:97], v[236:237] op_sel_hi:[1,1,0]
    v_pk_fma_f32 v[206:207], v[206:207], s[96:97], v[236:237] op_sel_hi:[1,1,0]
    v_pk_mul_f32 v[200:201], v[200:201], v[136:137]
    v_pk_mul_f32 v[202:203], v[202:203], v[138:139]
    s_add_u32 m0, s91, 8192
    s_add_u32 s90, s90, 28672
    buffer_load_dwordx4 v15, s[20:23], s90 offen lds
    v_pk_mul_f32 v[204:205], v[204:205], v[140:141]
    v_pk_mul_f32 v[206:207], v[206:207], v[142:143]
    v_exp_f32 v200, v200
    v_exp_f32 v201, v201
    v_exp_f32 v202, v202
    v_exp_f32 v203, v203
    v_exp_f32_e64 v204, v204
    s_add_u32 m0, s91, 9216
    s_add_u32 s90, s90, 28672
    buffer_load_dwordx4 v15, s[20:23], s90 offen lds
    v_exp_f32 v205, v205
    v_exp_f32 v206, v206
    v_exp_f32_e64 v207, v207
    v_pk_add_f32 v[200:201], v[200:201], 1.0 op_sel_hi:[1,0]
    v_pk_add_f32 v[202:203], v[202:203], 1.0 op_sel_hi:[1,0]
    v_pk_add_f32 v[204:205], v[204:205], 1.0 op_sel_hi:[1,0]
    v_pk_add_f32 v[206:207], v[206:207], 1.0 op_sel_hi:[1,0]
    v_rcp_f32 v200, v200
    v_rcp_f32 v201, v201
    v_rcp_f32 v202, v202
    v_rcp_f32 v203, v203
    v_rcp_f32 v204, v204
    v_rcp_f32 v205, v205
    v_rcp_f32 v206, v206
    v_rcp_f32 v207, v207
    v_pk_mul_f32 v[136:137], v[136:137], v[200:201]
    v_pk_mul_f32 v[138:139], v[138:139], v[202:203]
    v_pk_mul_f32 v[140:141], v[140:141], v[204:205]
    v_pk_mul_f32 v[142:143], v[142:143], v[206:207]
    s_waitcnt vmcnt(6)
    s_nop 0
    ds_read_b128 a[64:67], v20 offset:49152
    ds_read_b128 a[68:71], v21 offset:49152
    ds_read_b128 a[72:75], v22 offset:49152
    ds_read_b128 a[76:79], v23 offset:49152
    ds_read_b128 a[80:83], v20 offset:53248
    ds_read_b128 a[84:87], v21 offset:53248
    ds_read_b128 a[88:91], v22 offset:53248
    ds_read_b128 a[92:95], v23 offset:53248
    v_pk_fma_f32 v[144:145], v[208:209], v[232:233], v[144:145] op_sel:[0,0,0] op_sel_hi:[1,0,1] neg_lo:[0,1,0] neg_hi:[0,1,0]
    v_pk_fma_f32 v[146:147], v[210:211], v[232:233], v[146:147] op_sel:[0,0,0] op_sel_hi:[1,0,1] neg_lo:[0,1,0] neg_hi:[0,1,0]
    v_pk_fma_f32 v[148:149], v[208:209], v[232:233], v[148:149] op_sel:[0,1,0] op_sel_hi:[1,1,1] neg_lo:[0,1,0] neg_hi:[0,1,0]
    v_pk_fma_f32 v[150:151], v[210:211], v[232:233], v[150:151] op_sel:[0,1,0] op_sel_hi:[1,1,1] neg_lo:[0,1,0] neg_hi:[0,1,0]
    s_waitcnt lgkmcnt(8)
    s_nop 0
    v_pk_fma_f32 v[144:145], v[144:145], v[234:235], v[212:213] op_sel:[0,0,0] op_sel_hi:[1,0,1]
    s_add_u32 m0, s91, 10240
    s_add_u32 s90, s90, 28672
    buffer_load_dwordx4 v15, s[20:23], s90 offen lds
    v_pk_fma_f32 v[146:147], v[146:147], v[234:235], v[214:215] op_sel:[0,0,0] op_sel_hi:[1,0,1]
    v_pk_fma_f32 v[148:149], v[148:149], v[234:235], v[212:213] op_sel:[0,1,0] op_sel_hi:[1,1,1]
    v_pk_fma_f32 v[150:151], v[150:151], v[234:235], v[214:215] op_sel:[0,1,0] op_sel_hi:[1,1,1]
    v_pk_mul_f32 v[208:209], v[144:145], v[144:145]
    v_pk_mul_f32 v[210:211], v[146:147], v[146:147]
    v_pk_mul_f32 v[212:213], v[148:149], v[148:149]
    v_pk_mul_f32 v[214:215], v[150:151], v[150:151]
    v_pk_fma_f32 v[208:209], v[208:209], s[96:97], v[236:237] op_sel_hi:[1,1,0]
    v_pk_fma_f32 v[210:211], v[210:211], s[96:97], v[236:237] op_sel_hi:[1,1,0]
    v_pk_fma_f32 v[212:213], v[212:213], s[96:97], v[236:237] op_sel_hi:[1,1,0]
    v_pk_fma_f32 v[214:215], v[214:215], s[96:97], v[236:237] op_sel_hi:[1,1,0]
    s_add_u32 m0, s91, 11264
    s_add_u32 s90, s90, 28672
    buffer_load_dwordx4 v15, s[20:23], s90 offen lds
    v_pk_mul_f32 v[208:209], v[208:209], v[144:145]
    v_pk_mul_f32 v[210:211], v[210:211], v[146:147]
    v_pk_mul_f32 v[212:213], v[212:213], v[148:149]
    v_pk_mul_f32 v[214:215], v[214:215], v[150:151]
    v_exp_f32 v208, v208
    v_exp_f32 v209, v209
    v_exp_f32 v210, v210
    v_exp_f32 v211, v211
    v_exp_f32 v212, v212
    v_exp_f32 v213, v213
    v_exp_f32_e64 v214, v214
    s_add_u32 m0, s91, 12288
    s_add_u32 s90, s90, 28672
    buffer_load_dwordx4 v15, s[20:23], s90 offen lds
    v_exp_f32_e64 v215, v215
    v_pk_add_f32 v[208:209], v[208:209], 1.0 op_sel_hi:[1,0]
    v_pk_add_f32 v[210:211], v[210:211], 1.0 op_sel_hi:[1,0]
    v_pk_add_f32 v[212:213], v[212:213], 1.0 op_sel_hi:[1,0]
    v_pk_add_f32 v[214:215], v[214:215], 1.0 op_sel_hi:[1,0]
    v_rcp_f32 v208, v208
    v_rcp_f32 v209, v209
    v_rcp_f32 v210, v210
    v_rcp_f32 v211, v211
    v_rcp_f32 v212, v212
    v_rcp_f32 v213, v213
    s_add_u32 m0, s91, 13312
    s_add_u32 s90, s90, 28672
    buffer_load_dwordx4 v15, s[20:23], s90 offen lds
    v_rcp_f32 v214, v214
    v_rcp_f32 v215, v215
    v_pk_mul_f32 v[144:145], v[144:145], v[208:209]
    v_pk_mul_f32 v[146:147], v[146:147], v[210:211]
    v_pk_mul_f32 v[148:149], v[148:149], v[212:213]
    v_pk_mul_f32 v[150:151], v[150:151], v[214:215]
    s_waitcnt lgkmcnt(0)
    s_nop 0
    v_pk_fma_f32 v[152:153], v[216:217], v[232:233], v[152:153] op_sel:[0,0,0] op_sel_hi:[1,0,1] neg_lo:[0,1,0] neg_hi:[0,1,0]
    v_pk_fma_f32 v[154:155], v[218:219], v[232:233], v[154:155] op_sel:[0,0,0] op_sel_hi:[1,0,1] neg_lo:[0,1,0] neg_hi:[0,1,0]
    v_pk_fma_f32 v[156:157], v[216:217], v[232:233], v[156:157] op_sel:[0,1,0] op_sel_hi:[1,1,1] neg_lo:[0,1,0] neg_hi:[0,1,0]
    v_pk_fma_f32 v[158:159], v[218:219], v[232:233], v[158:159] op_sel:[0,1,0] op_sel_hi:[1,1,1] neg_lo:[0,1,0] neg_hi:[0,1,0]
    v_pk_fma_f32 v[152:153], v[152:153], v[234:235], v[220:221] op_sel:[0,0,0] op_sel_hi:[1,0,1]
    v_pk_fma_f32 v[154:155], v[154:155], v[234:235], v[222:223] op_sel:[0,0,0] op_sel_hi:[1,0,1]
    v_pk_fma_f32 v[156:157], v[156:157], v[234:235], v[220:221] op_sel:[0,1,0] op_sel_hi:[1,1,1]
    v_pk_fma_f32 v[158:159], v[158:159], v[234:235], v[222:223] op_sel:[0,1,0] op_sel_hi:[1,1,1]
    v_pk_mul_f32 v[216:217], v[152:153], v[152:153]
    v_pk_mul_f32 v[218:219], v[154:155], v[154:155]
    v_pk_mul_f32 v[220:221], v[156:157], v[156:157]
    s_add_u32 m0, s67, 0
    s_nop 0
    s_xor_b32 s66, s94, 1050112
    buffer_load_dwordx4 v16, s[24:27], s66 offen offset:0 lds
    buffer_load_dwordx4 v17, s[24:27], s66 offen offset:1024 lds
    buffer_load_dwordx4 v18, s[24:27], s66 offen offset:2048 lds
    buffer_load_dwordx4 v19, s[24:27], s66 offen offset:3072 lds
    v_pk_mul_f32 v[222:223], v[158:159], v[158:159]
    v_pk_fma_f32 v[216:217], v[216:217], s[96:97], v[236:237] op_sel_hi:[1,1,0]
    v_pk_fma_f32 v[218:219], v[218:219], s[96:97], v[236:237] op_sel_hi:[1,1,0]
    v_pk_fma_f32 v[220:221], v[220:221], s[96:97], v[236:237] op_sel_hi:[1,1,0]
    v_pk_fma_f32 v[222:223], v[222:223], s[96:97], v[236:237] op_sel_hi:[1,1,0]
    v_pk_mul_f32 v[216:217], v[216:217], v[152:153]
    v_pk_mul_f32 v[218:219], v[218:219], v[154:155]
    v_pk_mul_f32 v[220:221], v[220:221], v[156:157]
    v_pk_mul_f32 v[222:223], v[222:223], v[158:159]
    v_exp_f32 v216, v216
    v_exp_f32 v217, v217
    v_exp_f32 v218, v218
    v_exp_f32 v219, v219
    v_exp_f32 v220, v220
    v_exp_f32 v221, v221
    v_exp_f32 v222, v222
    v_exp_f32 v223, v223
    v_pk_add_f32 v[216:217], v[216:217], 1.0 op_sel_hi:[1,0]
    v_pk_add_f32 v[218:219], v[218:219], 1.0 op_sel_hi:[1,0]
    v_pk_add_f32 v[220:221], v[220:221], 1.0 op_sel_hi:[1,0]
    v_pk_add_f32 v[222:223], v[222:223], 1.0 op_sel_hi:[1,0]
    v_rcp_f32_e64 v216, v216
    s_add_u32 m0, s67, 4096
    s_xor_b32 s66, s94, 1050368
    buffer_load_dwordx4 v16, s[24:27], s66 offen offset:0 lds
    buffer_load_dwordx4 v17, s[24:27], s66 offen offset:1024 lds
    buffer_load_dwordx4 v18, s[24:27], s66 offen offset:2048 lds
    buffer_load_dwordx4 v19, s[24:27], s66 offen offset:3072 lds
    v_rcp_f32 v217, v217
    v_rcp_f32 v218, v218
    v_rcp_f32 v219, v219
    v_rcp_f32 v220, v220
    v_rcp_f32 v221, v221
    v_rcp_f32 v222, v222
    v_rcp_f32_e64 v223, v223
    v_pk_mul_f32 v[152:153], v[152:153], v[216:217]
    v_pk_mul_f32 v[154:155], v[154:155], v[218:219]
    v_pk_mul_f32 v[156:157], v[156:157], v[220:221]
    v_pk_mul_f32 v[158:159], v[158:159], v[222:223]
    v_pk_fma_f32 v[160:161], v[224:225], v[232:233], v[160:161] op_sel:[0,0,0] op_sel_hi:[1,0,1] neg_lo:[0,1,0] neg_hi:[0,1,0]
    v_pk_fma_f32 v[162:163], v[226:227], v[232:233], v[162:163] op_sel:[0,0,0] op_sel_hi:[1,0,1] neg_lo:[0,1,0] neg_hi:[0,1,0]
    v_pk_fma_f32 v[164:165], v[224:225], v[232:233], v[164:165] op_sel:[0,1,0] op_sel_hi:[1,1,1] neg_lo:[0,1,0] neg_hi:[0,1,0]
    v_pk_fma_f32 v[166:167], v[226:227], v[232:233], v[166:167] op_sel:[0,1,0] op_sel_hi:[1,1,1] neg_lo:[0,1,0] neg_hi:[0,1,0]
    v_pk_fma_f32 v[160:161], v[160:161], v[234:235], v[228:229] op_sel:[0,0,0] op_sel_hi:[1,0,1]
    v_pk_fma_f32 v[162:163], v[162:163], v[234:235], v[230:231] op_sel:[0,0,0] op_sel_hi:[1,0,1]
    v_pk_fma_f32 v[164:165], v[164:165], v[234:235], v[228:229] op_sel:[0,1,0] op_sel_hi:[1,1,1]
    v_pk_fma_f32 v[166:167], v[166:167], v[234:235], v[230:231] op_sel:[0,1,0] op_sel_hi:[1,1,1]
    v_pk_mul_f32 v[224:225], v[160:161], v[160:161]
    v_pk_mul_f32 v[226:227], v[162:163], v[162:163]
    v_pk_mul_f32 v[228:229], v[164:165], v[164:165]
    v_pk_mul_f32 v[230:231], v[166:167], v[166:167]
    v_pk_fma_f32 v[224:225], v[224:225], s[96:97], v[236:237] op_sel_hi:[1,1,0]
    v_pk_fma_f32 v[226:227], v[226:227], s[96:97], v[236:237] op_sel_hi:[1,1,0]
    v_pk_fma_f32 v[228:229], v[228:229], s[96:97], v[236:237] op_sel_hi:[1,1,0]
    v_pk_fma_f32 v[230:231], v[230:231], s[96:97], v[236:237] op_sel_hi:[1,1,0]
    v_pk_mul_f32 v[224:225], v[224:225], v[160:161]
    v_pk_mul_f32 v[226:227], v[226:227], v[162:163]
    v_pk_mul_f32 v[228:229], v[228:229], v[164:165]
    v_pk_mul_f32 v[230:231], v[230:231], v[166:167]
    v_exp_f32 v224, v224
    v_exp_f32 v225, v225
    v_exp_f32 v226, v226
    v_exp_f32 v227, v227
    v_exp_f32 v228, v228
    v_exp_f32 v229, v229
    v_exp_f32 v230, v230
    v_exp_f32 v231, v231
    v_pk_add_f32 v[224:225], v[224:225], 1.0 op_sel_hi:[1,0]
    v_pk_add_f32 v[226:227], v[226:227], 1.0 op_sel_hi:[1,0]
    v_pk_add_f32 v[228:229], v[228:229], 1.0 op_sel_hi:[1,0]
    v_pk_add_f32 v[230:231], v[230:231], 1.0 op_sel_hi:[1,0]
    v_rcp_f32 v224, v224
    v_rcp_f32 v225, v225
    v_rcp_f32 v226, v226
    v_rcp_f32 v227, v227
    v_rcp_f32 v228, v228
    v_rcp_f32 v229, v229
    v_rcp_f32 v230, v230
    v_rcp_f32 v231, v231
    v_pk_mul_f32 v[160:161], v[160:161], v[224:225]
    v_pk_mul_f32 v[162:163], v[162:163], v[226:227]
    v_pk_mul_f32 v[164:165], v[164:165], v[228:229]
    v_pk_mul_f32 v[166:167], v[166:167], v[230:231]
    v_pk_mul_f32 v[220:221], v[136:137], v[136:137]
    v_pk_add_f32 v[216:217], v[136:137], v[138:139]
    v_pk_fma_f32 v[220:221], v[138:139], v[138:139], v[220:221]
    v_pk_mul_f32 v[222:223], v[140:141], v[140:141]
    v_pk_add_f32 v[218:219], v[140:141], v[142:143]
    v_pk_fma_f32 v[222:223], v[142:143], v[142:143], v[222:223]
    v_pk_add_f32 v[216:217], v[216:217], v[144:145]
    v_pk_fma_f32 v[220:221], v[144:145], v[144:145], v[220:221]
    v_pk_add_f32 v[216:217], v[216:217], v[146:147]
    v_pk_fma_f32 v[220:221], v[146:147], v[146:147], v[220:221]
    v_pk_add_f32 v[218:219], v[218:219], v[148:149]
    v_pk_fma_f32 v[222:223], v[148:149], v[148:149], v[222:223]
    v_pk_add_f32 v[218:219], v[218:219], v[150:151]
    v_pk_fma_f32 v[222:223], v[150:151], v[150:151], v[222:223]
    v_pk_add_f32 v[216:217], v[216:217], v[152:153]
    v_pk_fma_f32 v[220:221], v[152:153], v[152:153], v[220:221]
    v_pk_add_f32 v[216:217], v[216:217], v[154:155]
    v_pk_fma_f32 v[220:221], v[154:155], v[154:155], v[220:221]
    v_pk_add_f32 v[218:219], v[218:219], v[156:157]
    v_pk_fma_f32 v[222:223], v[156:157], v[156:157], v[222:223]
    v_pk_add_f32 v[218:219], v[218:219], v[158:159]
    v_pk_fma_f32 v[222:223], v[158:159], v[158:159], v[222:223]
    v_pk_add_f32 v[216:217], v[216:217], v[160:161]
    v_pk_fma_f32 v[220:221], v[160:161], v[160:161], v[220:221]
    v_pk_add_f32 v[216:217], v[216:217], v[162:163]
    v_pk_fma_f32 v[220:221], v[162:163], v[162:163], v[220:221]
    v_pk_add_f32 v[218:219], v[218:219], v[164:165]
    v_pk_fma_f32 v[222:223], v[164:165], v[164:165], v[222:223]
    v_pk_add_f32 v[218:219], v[218:219], v[166:167]
    v_pk_fma_f32 v[222:223], v[166:167], v[166:167], v[222:223]
    v_add_f32_e64 v216, v216, v217
    v_add_f32 v218, v218, v219
    v_add_f32 v220, v220, v221
    v_add_f32 v222, v222, v223
    v_permlane16_swap_b32 v216, v218
    s_nop 0
    v_permlane16_swap_b32 v220, v222
    v_add_f32 v216, v216, v218
    v_add_f32 v220, v220, v222
    v_mov_b32 v218, s59
    v_mov_b32 v219, s59
    v_permlane32_swap_b32 v216, v220
    v_add_f32 v216, v216, v220
    v_mov_b32 v217, v216
    s_nop 1
    v_permlane32_swap_b32 v216, v217
    s_mov_b32 exec_hi, 0
    s_cmp_eq_u32 s87, 0
    s_cbranch_scc1 WT_40
    buffer_store_dwordx4 v[216:219], v7, s[48:51], s74 offen
WB_41:
    s_mov_b32 exec_hi, -1
    s_waitcnt vmcnt(9)
    s_barrier
    s_nop 0
    ds_read_b64_tr_b16 v[200:201], v8 offset:0
    ds_read_b64_tr_b16 v[202:203], v8 offset:2048
    ds_read_b64_tr_b16 v[204:205], v9 offset:0
    ds_read_b64_tr_b16 v[206:207], v9 offset:2048
    ds_read_b64_tr_b16 v[208:209], v10 offset:0
    ds_read_b64_tr_b16 v[210:211], v10 offset:2048
    ds_read_b64_tr_b16 v[212:213], v11 offset:0
    ds_read_b64_tr_b16 v[214:215], v11 offset:2048
    s_add_u32 s77, s73, 4096
    s_waitcnt lgkmcnt(6)
    v_mfma_f32_16x16x32_bf16 v[168:171], v[200:203], v[24:27], 0
    ds_read_b64_tr_b16 v[216:217], v8 offset:4096
    v_mfma_f32_16x16x32_bf16 v[172:175], v[200:203], v[28:31], 0
    ds_read_b64_tr_b16 v[218:219], v8 offset:6144
    s_add_u32 m0, s67, -49152
    s_xor_b32 s66, s94, 0
    buffer_load_dwordx4 v16, s[24:27], s66 offen offset:0 lds
    buffer_load_dwordx4 v17, s[24:27], s66 offen offset:1024 lds
    buffer_load_dwordx4 v18, s[24:27], s66 offen offset:2048 lds
    buffer_load_dwordx4 v19, s[24:27], s66 offen offset:3072 lds
    s_waitcnt lgkmcnt(6)
    v_mfma_f32_16x16x32_bf16 v[176:179], v[204:207], v[24:27], 0
    ds_read_b64_tr_b16 v[220:221], v9 offset:4096
    v_mfma_f32_16x16x32_bf16 v[180:183], v[204:207], v[28:31], 0
    ds_read_b64_tr_b16 v[222:223], v9 offset:6144
    v_and_b32_e64 v3, 15, v0
    s_waitcnt lgkmcnt(6)
    v_mfma_f32_16x16x32_bf16 v[184:187], v[208:211], v[24:27], 0
    ds_read_b64_tr_b16 v[224:225], v10 offset:4096
    v_mfma_f32_16x16x32_bf16 v[188:191], v[208:211], v[28:31], 0
    ds_read_b64_tr_b16 v[226:227], v10 offset:6144
    v_mul_u32_u24 v3, 136, v3
    s_waitcnt lgkmcnt(6)
    v_mfma_f32_16x16x32_bf16 v[192:195], v[212:215], v[24:27], 0
    ds_read_b64_tr_b16 v[228:229], v11 offset:4096
    v_mfma_f32_16x16x32_bf16 v[196:199], v[212:215], v[28:31], 0
    ds_read_b64_tr_b16 v[230:231], v11 offset:6144
    v_lshl_add_u32 v3, v1, 3, v3
    s_waitcnt lgkmcnt(6)
    v_mfma_f32_16x16x32_bf16 v[168:171], v[216:219], v[32:35], v[168:171]
    ds_read_b64_tr_b16 v[200:201], v8 offset:8192
    v_mfma_f32_16x16x32_bf16 v[172:175], v[216:219], v[36:39], v[172:175]
    ds_read_b64_tr_b16 v[202:203], v8 offset:10240
    s_add_u32 m0, s67, -45056
    s_xor_b32 s66, s94, 256
    buffer_load_dwordx4 v16, s[24:27], s66 offen offset:0 lds
    buffer_load_dwordx4 v17, s[24:27], s66 offen offset:1024 lds
    buffer_load_dwordx4 v18, s[24:27], s66 offen offset:2048 lds
    buffer_load_dwordx4 v19, s[24:27], s66 offen offset:3072 lds
    s_waitcnt lgkmcnt(6)
    v_mfma_f32_16x16x32_bf16 v[176:179], v[220:223], v[32:35], v[176:179]
    ds_read_b64_tr_b16 v[204:205], v9 offset:8192
    v_mfma_f32_16x16x32_bf16 v[180:183], v[220:223], v[36:39], v[180:183]
    ds_read_b64_tr_b16 v[206:207], v9 offset:10240
    s_mul_i32 s61, s52, 4352
    s_waitcnt lgkmcnt(6)
    v_mfma_f32_16x16x32_bf16 v[184:187], v[224:227], v[32:35], v[184:187]
    ds_read_b64_tr_b16 v[208:209], v10 offset:8192
    v_mfma_f32_16x16x32_bf16 v[188:191], v[224:227], v[36:39], v[188:191]
    ds_read_b64_tr_b16 v[210:211], v10 offset:10240
    s_add_u32 s61, s61, 58368
    s_waitcnt lgkmcnt(6)
    v_mfma_f32_16x16x32_bf16 v[192:195], v[228:231], v[32:35], v[192:195]
    ds_read_b64_tr_b16 v[212:213], v11 offset:8192
    v_mfma_f32_16x16x32_bf16 v[196:199], v[228:231], v[36:39], v[196:199]
    ds_read_b64_tr_b16 v[214:215], v11 offset:10240
    v_add_u32_e64 v3, s61, v3
    s_waitcnt lgkmcnt(6)
    v_mfma_f32_16x16x32_bf16 v[168:171], v[200:203], v[40:43], v[168:171]
    ds_read_b64_tr_b16 v[216:217], v8 offset:12288
    v_mfma_f32_16x16x32_bf16 v[172:175], v[200:203], v[44:47], v[172:175]
    ds_read_b64_tr_b16 v[218:219], v8 offset:14336
    v_bfe_u32 v4, v0, 2, 2
    s_waitcnt lgkmcnt(6)
    v_mfma_f32_16x16x32_bf16 v[176:179], v[204:207], v[40:43], v[176:179]
    ds_read_b64_tr_b16 v[220:221], v9 offset:12288
    v_mfma_f32_16x16x32_bf16 v[180:183], v[204:207], v[44:47], v[180:183]
    ds_read_b64_tr_b16 v[222:223], v9 offset:14336
    v_lshl_add_u32 v4, v1, 3, v4
    s_waitcnt lgkmcnt(6)
    v_mfma_f32_16x16x32_bf16 v[184:187], v[208:211], v[40:43], v[184:187]
    ds_read_b64_tr_b16 v[224:225], v10 offset:12288
    v_mfma_f32_16x16x32_bf16 v[188:191], v[208:211], v[44:47], v[188:191]
    ds_read_b64_tr_b16 v[226:227], v10 offset:14336
    v_mul_u32_u24 v4, 136, v4
    s_waitcnt lgkmcnt(6)
    v_mfma_f32_16x16x32_bf16 v[192:195], v[212:215], v[40:43], v[192:195]
    ds_read_b64_tr_b16 v[228:229], v11 offset:12288
    v_mfma_f32_16x16x32_bf16 v[196:199], v[212:215], v[44:47], v[196:199]
    ds_read_b64_tr_b16 v[230:231], v11 offset:14336
    v_and_b32_e64 v5, 3, v0
    s_waitcnt lgkmcnt(6)
    v_mfma_f32_16x16x32_bf16 v[168:171], v[216:219], v[48:51], v[168:171]
    ds_read_b64_tr_b16 v[200:201], v8 offset:16384
    v_mfma_f32_16x16x32_bf16 v[172:175], v[216:219], v[52:55], v[172:175]
    ds_read_b64_tr_b16 v[202:203], v8 offset:18432
    s_waitcnt vmcnt(9)
    ds_read_b128 a[96:99], v20 offset:49152
    ds_read_b128 a[100:103], v21 offset:49152
    ds_read_b128 a[104:107], v22 offset:49152
    ds_read_b128 a[108:111], v23 offset:49152
    ds_read_b128 a[112:115], v20 offset:53248
    ds_read_b128 a[116:119], v21 offset:53248
    ds_read_b128 a[120:123], v22 offset:53248
    ds_read_b128 a[124:127], v23 offset:53248
    s_waitcnt lgkmcnt(13)
    v_mfma_f32_16x16x32_bf16 v[176:179], v[220:223], v[48:51], v[176:179]
    ds_read_b64_tr_b16 v[204:205], v9 offset:16384
    v_mfma_f32_16x16x32_bf16 v[180:183], v[220:223], v[52:55], v[180:183]
    ds_read_b64_tr_b16 v[206:207], v9 offset:18432
    buffer_load_dwordx4 v[24:27], v7, s[48:51], s73 offen offset:0 sc1
    s_waitcnt lgkmcnt(13)
    v_mfma_f32_16x16x32_bf16 v[184:187], v[224:227], v[48:51], v[184:187]
    ds_read_b64_tr_b16 v[208:209], v10 offset:16384
    v_mfma_f32_16x16x32_bf16 v[188:191], v[224:227], v[52:55], v[188:191]
    ds_read_b64_tr_b16 v[210:211], v10 offset:18432
    buffer_load_dwordx4 v[28:31], v7, s[48:51], s73 offen offset:1024 sc1
    s_waitcnt lgkmcnt(13)
    v_mfma_f32_16x16x32_bf16 v[192:195], v[228:231], v[48:51], v[192:195]
    ds_read_b64_tr_b16 v[212:213], v11 offset:16384
    v_mfma_f32_16x16x32_bf16 v[196:199], v[228:231], v[52:55], v[196:199]
    ds_read_b64_tr_b16 v[214:215], v11 offset:18432
    buffer_load_dwordx4 v[32:35], v7, s[48:51], s73 offen offset:2048 sc1
    buffer_load_dwordx4 v[36:39], v7, s[48:51], s73 offen offset:3072 sc1
    s_waitcnt lgkmcnt(10)
    v_mfma_f32_16x16x32_bf16 v[168:171], v[200:203], v[56:59], v[168:171]
    ds_read_b64_tr_b16 v[216:217], v8 offset:20480
    v_mfma_f32_16x16x32_bf16 v[172:175], v[200:203], v[60:63], v[172:175]
    ds_read_b64_tr_b16 v[218:219], v8 offset:22528
    buffer_load_dwordx4 v[40:43], v7, s[48:51], s77 offen offset:0 sc1
    s_waitcnt lgkmcnt(6)
    v_mfma_f32_16x16x32_bf16 v[176:179], v[204:207], v[56:59], v[176:179]
    ds_read_b64_tr_b16 v[220:221], v9 offset:20480
    v_mfma_f32_16x16x32_bf16 v[180:183], v[204:207], v[60:63], v[180:183]
    ds_read_b64_tr_b16 v[222:223], v9 offset:22528
    buffer_load_dwordx4 v[44:47], v7, s[48:51], s77 offen offset:1024 sc1
    s_waitcnt lgkmcnt(6)
    v_mfma_f32_16x16x32_bf16 v[184:187], v[208:211], v[56:59], v[184:187]
    ds_read_b64_tr_b16 v[224:225], v10 offset:20480
    v_mfma_f32_16x16x32_bf16 v[188:191], v[208:211], v[60:63], v[188:191]
    ds_read_b64_tr_b16 v[226:227], v10 offset:22528
    buffer_load_dwordx4 v[48:51], v7, s[48:51], s77 offen offset:2048 sc1
    s_waitcnt lgkmcnt(6)
    v_mfma_f32_16x16x32_bf16 v[192:195], v[212:215], v[56:59], v[192:195]
    ds_read_b64_tr_b16 v[228:229], v11 offset:20480
    v_mfma_f32_16x16x32_bf16 v[196:199], v[212:215], v[60:63], v[196:199]
    ds_read_b64_tr_b16 v[230:231], v11 offset:22528
    v_lshl_add_u32 v4, v5, 3, v4
    s_waitcnt lgkmcnt(6)
    v_mfma_f32_16x16x32_bf16 v[168:171], v[216:219], v[64:67], v[168:171]
    ds_read_b64_tr_b16 v[200:201], v8 offset:24576
    v_mfma_f32_16x16x32_bf16 v[172:175], v[216:219], v[68:71], v[172:175]
    ds_read_b64_tr_b16 v[202:203], v8 offset:26624
    s_add_u32 m0, s67, 0
    s_xor_b32 s66, s94, 512
    buffer_load_dwordx4 v16, s[24:27], s66 offen offset:0 lds
    buffer_load_dwordx4 v17, s[24:27], s66 offen offset:1024 lds
    buffer_load_dwordx4 v18, s[24:27], s66 offen offset:2048 lds
    buffer_load_dwordx4 v19, s[24:27], s66 offen offset:3072 lds
    s_waitcnt lgkmcnt(6)
    v_mfma_f32_16x16x32_bf16 v[176:179], v[220:223], v[64:67], v[176:179]
    ds_read_b64_tr_b16 v[204:205], v9 offset:24576
    v_mfma_f32_16x16x32_bf16 v[180:183], v[220:223], v[68:71], v[180:183]
    ds_read_b64_tr_b16 v[206:207], v9 offset:26624
    v_add_u32_e64 v4, s61, v4
    s_waitcnt lgkmcnt(6)
    v_mfma_f32_16x16x32_bf16 v[184:187], v[224:227], v[64:67], v[184:187]
    ds_read_b64_tr_b16 v[208:209], v10 offset:24576
    v_mfma_f32_16x16x32_bf16 v[188:191], v[224:227], v[68:71], v[188:191]
    ds_read_b64_tr_b16 v[210:211], v10 offset:26624
    s_lshl_b32 s60, s71, 18
    s_waitcnt lgkmcnt(6)
    v_mfma_f32_16x16x32_bf16 v[192:195], v[228:231], v[64:67], v[192:195]
    ds_read_b64_tr_b16 v[212:213], v11 offset:24576
    v_mfma_f32_16x16x32_bf16 v[196:199], v[228:231], v[68:71], v[196:199]
    ds_read_b64_tr_b16 v[214:215], v11 offset:26624
    s_lshl_b32 s61, s72, 10
    s_waitcnt lgkmcnt(6)
    v_mfma_f32_16x16x32_bf16 v[168:171], v[200:203], v[72:75], v[168:171]
    v_mfma_f32_16x16x32_bf16 v[172:175], v[200:203], v[76:79], v[172:175]
    s_add_u32 m0, s67, 4096
    s_xor_b32 s66, s94, 768
    buffer_load_dwordx4 v16, s[24:27], s66 offen offset:0 lds
    buffer_load_dwordx4 v17, s[24:27], s66 offen offset:1024 lds
    buffer_load_dwordx4 v18, s[24:27], s66 offen offset:2048 lds
    buffer_load_dwordx4 v19, s[24:27], s66 offen offset:3072 lds
    s_waitcnt lgkmcnt(4)
    v_mfma_f32_16x16x32_bf16 v[176:179], v[204:207], v[72:75], v[176:179]
    v_mfma_f32_16x16x32_bf16 v[180:183], v[204:207], v[76:79], v[180:183]
    s_add_u32 s60, s60, s61
    s_waitcnt lgkmcnt(2)
    v_mfma_f32_16x16x32_bf16 v[184:187], v[208:211], v[72:75], v[184:187]
    v_mfma_f32_16x16x32_bf16 v[188:191], v[208:211], v[76:79], v[188:191]
    s_add_u32 s60, s60, 8388608
    s_waitcnt lgkmcnt(0)
    v_mfma_f32_16x16x32_bf16 v[192:195], v[212:215], v[72:75], v[192:195]
    v_mfma_f32_16x16x32_bf16 v[196:199], v[212:215], v[76:79], v[196:199]
    s_waitcnt vmcnt(14)
    v_xor_b32 v26, s59, v26
    s_waitcnt vmcnt(13)
    v_bitop3_b32 v26, v26, v30, s59 bitop3:0xf6
    s_waitcnt vmcnt(12)
    v_bitop3_b32 v26, v26, v34, s59 bitop3:0xf6
    s_waitcnt vmcnt(11)
    v_bitop3_b32 v26, v26, v38, s59 bitop3:0xf6
    s_waitcnt vmcnt(10)
    v_bitop3_b32 v26, v26, v42, s59 bitop3:0xf6
    s_waitcnt vmcnt(9)
    v_bitop3_b32 v26, v26, v46, s59 bitop3:0xf6
    s_waitcnt vmcnt(8)
    v_bitop3_b32 v26, v26, v50, s59 bitop3:0xf6
    v_cmp_ne_u32 vcc, 0, v26
    s_cbranch_vccnz L_PE
L_PED:
    v_pk_add_f32 v[24:25], v[24:25], v[28:29]
    v_pk_add_f32 v[24:25], v[24:25], v[32:33]
    v_pk_add_f32 v[24:25], v[24:25], v[36:37]
    v_pk_add_f32 v[24:25], v[24:25], v[40:41]
    v_pk_add_f32 v[24:25], v[24:25], v[44:45]
    v_pk_add_f32 v[24:25], v[24:25], v[48:49]
    s_nop 1
    v_permlane32_swap_b32 v24, v25
    v_add_f32_e64 v24, v24, v25
    v_mul_f32 v24, 0x3a924925, v24
    v_mov_b32 v26, v24
    s_nop 1
    v_permlane32_swap_b32_e64 v24, v26
    v_fma_f32 v26, -v24, v24, v26
    v_max_f32_e64 v26, 0, v26
    v_add_f32 v26, 0x3727c5ac, v26
    v_rsq_f32 v26, v26
    s_nop 0
    v_mul_f32_e64 v24, -v24, v26
    v_mov_b32 v27, v26
    v_mov_b32 v25, v24
    s_nop 0
    v_permlane16_swap_b32 v26, v27
    v_permlane16_swap_b32_e64 v24, v25
    v_pk_fma_f32 v[136:137], v[136:137], v[26:27], v[24:25] op_sel:[0,0,0] op_sel_hi:[1,0,0]
    v_pk_fma_f32 v[138:139], v[138:139], v[26:27], v[24:25] op_sel:[0,0,0] op_sel_hi:[1,0,0]
    v_cvt_pk_bf16_f32 v32, v136, v137
    v_cvt_pk_bf16_f32 v33, v138, v139
    v_pk_fma_f32 v[140:141], v[140:141], v[26:27], v[24:25] op_sel:[0,1,1] op_sel_hi:[1,1,1]
    v_pk_fma_f32 v[142:143], v[142:143], v[26:27], v[24:25] op_sel:[0,1,1] op_sel_hi:[1,1,1]
    v_cvt_pk_bf16_f32 v34, v140, v141
    v_cvt_pk_bf16_f32 v35, v142, v143
    v_pk_fma_f32 v[144:145], v[144:145], v[26:27], v[24:25] op_sel:[0,0,0] op_sel_hi:[1,0,0]
    v_pk_fma_f32 v[146:147], v[146:147], v[26:27], v[24:25] op_sel:[0,0,0] op_sel_hi:[1,0,0]
    v_cvt_pk_bf16_f32 v36, v144, v145
    v_cvt_pk_bf16_f32 v37, v146, v147
    v_pk_fma_f32 v[148:149], v[148:149], v[26:27], v[24:25] op_sel:[0,1,1] op_sel_hi:[1,1,1]
    v_pk_fma_f32 v[150:151], v[150:151], v[26:27], v[24:25] op_sel:[0,1,1] op_sel_hi:[1,1,1]
    v_cvt_pk_bf16_f32 v38, v148, v149
    v_cvt_pk_bf16_f32 v39, v150, v151
    ds_write_b64 v3, v[32:33] offset:0
    ds_write_b64 v3, v[34:35] offset:2176
    ds_write_b64 v3, v[36:37] offset:32
    ds_write_b64 v3, v[38:39] offset:2208
    ds_read_b64_tr_b16 v[48:49], v4 offset:0
    ds_read_b64_tr_b16 v[50:51], v4 offset:544
    ds_read_b64_tr_b16 v[52:53], v4 offset:32
    ds_read_b64_tr_b16 v[54:55], v4 offset:576
    v_pk_fma_f32 v[152:153], v[152:153], v[26:27], v[24:25] op_sel:[0,0,0] op_sel_hi:[1,0,0]
    v_pk_fma_f32 v[154:155], v[154:155], v[26:27], v[24:25] op_sel:[0,0,0] op_sel_hi:[1,0,0]
    v_cvt_pk_bf16_f32 v40, v152, v153
    v_cvt_pk_bf16_f32 v41, v154, v155
    v_pk_fma_f32 v[156:157], v[156:157], v[26:27], v[24:25] op_sel:[0,1,1] op_sel_hi:[1,1,1]
    v_pk_fma_f32 v[158:159], v[158:159], v[26:27], v[24:25] op_sel:[0,1,1] op_sel_hi:[1,1,1]
    v_cvt_pk_bf16_f32 v42, v156, v157
    v_cvt_pk_bf16_f32 v43, v158, v159
    v_pk_fma_f32 v[160:161], v[160:161], v[26:27], v[24:25] op_sel:[0,0,0] op_sel_hi:[1,0,0]
    v_pk_fma_f32 v[162:163], v[162:163], v[26:27], v[24:25] op_sel:[0,0,0] op_sel_hi:[1,0,0]
    v_cvt_pk_bf16_f32 v44, v160, v161
    v_cvt_pk_bf16_f32 v45, v162, v163
    v_pk_fma_f32 v[164:165], v[164:165], v[26:27], v[24:25] op_sel:[0,1,1] op_sel_hi:[1,1,1]
    v_pk_fma_f32 v[166:167], v[166:167], v[26:27], v[24:25] op_sel:[0,1,1] op_sel_hi:[1,1,1]
    v_cvt_pk_bf16_f32 v46, v164, v165
    v_cvt_pk_bf16_f32 v47, v166, v167
    ds_write_b64 v3, v[40:41] offset:64
    ds_write_b64 v3, v[42:43] offset:2240
    ds_write_b64 v3, v[44:45] offset:96
    ds_write_b64 v3, v[46:47] offset:2272
    ds_read_b64_tr_b16 v[56:57], v4 offset:64
    ds_read_b64_tr_b16 v[58:59], v4 offset:608
    ds_read_b64_tr_b16 v[60:61], v4 offset:96
    ds_read_b64_tr_b16 v[62:63], v4 offset:640
    ds_read_b64_tr_b16 v[216:217], v8 offset:28672
    ds_read_b64_tr_b16 v[218:219], v8 offset:30720
    ds_read_b64_tr_b16 v[220:221], v9 offset:28672
    ds_read_b64_tr_b16 v[222:223], v9 offset:30720
    ds_read_b64_tr_b16 v[224:225], v10 offset:28672
    ds_read_b64_tr_b16 v[226:227], v10 offset:30720
    ds_read_b64_tr_b16 v[228:229], v11 offset:28672
    ds_read_b64_tr_b16 v[230:231], v11 offset:30720
    s_waitcnt lgkmcnt(15)
    buffer_store_dwordx4 v[48:51], v7, s[48:51], s60 offen sc1
    s_add_u32 s60, s60, 65536
    buffer_store_dwordx4 v[52:55], v7, s[48:51], s60 offen sc1
    s_add_u32 s60, s60, 65536
    s_waitcnt lgkmcnt(10)
    buffer_store_dwordx4 v[56:59], v7, s[48:51], s60 offen sc1
    s_add_u32 s60, s60, 65536
    s_waitcnt lgkmcnt(8)
    buffer_store_dwordx4 v[60:63], v7, s[48:51], s60 offen sc1
    s_lshl4_add_u32 s63, s55, s71
    s_lshl_b32 s63, s63, 7
    s_add_u32 s63, s63, 163840
    s_waitcnt lgkmcnt(6)
    v_mfma_f32_16x16x32_bf16 v[168:171], v[216:219], v[80:83], v[168:171]
    ds_read_b64_tr_b16 v[200:201], v8 offset:32768
    v_mfma_f32_16x16x32_bf16 v[172:175], v[216:219], v[84:87], v[172:175]
    ds_read_b64_tr_b16 v[202:203], v8 offset:34816
    ds_read_b128 a[128:131], v20 offset:0
    ds_read_b128 a[132:135], v21 offset:0
    ds_read_b128 a[136:139], v22 offset:0
    ds_read_b128 a[140:143], v23 offset:0
    ds_read_b128 a[144:147], v20 offset:4096
    ds_read_b128 a[148:151], v21 offset:4096
    ds_read_b128 a[152:155], v22 offset:4096
    ds_read_b128 a[156:159], v23 offset:4096
    s_waitcnt lgkmcnt(10)
    v_mfma_f32_16x16x32_bf16 v[176:179], v[220:223], v[80:83], v[176:179]
    ds_read_b64_tr_b16 v[204:205], v9 offset:32768
    v_mfma_f32_16x16x32_bf16 v[180:183], v[220:223], v[84:87], v[180:183]
    ds_read_b64_tr_b16 v[206:207], v9 offset:34816
    v_mfma_f32_16x16x32_bf16 v[184:187], v[224:227], v[80:83], v[184:187]
    ds_read_b64_tr_b16 v[208:209], v10 offset:32768
    v_mfma_f32_16x16x32_bf16 v[188:191], v[224:227], v[84:87], v[188:191]
    ds_read_b64_tr_b16 v[210:211], v10 offset:34816
    v_mfma_f32_16x16x32_bf16 v[192:195], v[228:231], v[80:83], v[192:195]
    ds_read_b64_tr_b16 v[212:213], v11 offset:32768
    v_mfma_f32_16x16x32_bf16 v[196:199], v[228:231], v[84:87], v[196:199]
    ds_read_b64_tr_b16 v[214:215], v11 offset:34816
    s_waitcnt lgkmcnt(14)
    v_mfma_f32_16x16x32_bf16 v[168:171], v[200:203], v[88:91], v[168:171]
    ds_read_b64_tr_b16 v[216:217], v8 offset:36864
    v_mfma_f32_16x16x32_bf16 v[172:175], v[200:203], v[92:95], v[172:175]
    ds_read_b64_tr_b16 v[218:219], v8 offset:38912
    s_waitcnt lgkmcnt(6)
    v_mfma_f32_16x16x32_bf16 v[176:179], v[204:207], v[88:91], v[176:179]
    ds_read_b64_tr_b16 v[220:221], v9 offset:36864
    v_mfma_f32_16x16x32_bf16 v[180:183], v[204:207], v[92:95], v[180:183]
    ds_read_b64_tr_b16 v[222:223], v9 offset:38912
    s_waitcnt lgkmcnt(6)
    v_mfma_f32_16x16x32_bf16 v[184:187], v[208:211], v[88:91], v[184:187]
    ds_read_b64_tr_b16 v[224:225], v10 offset:36864
    v_mfma_f32_16x16x32_bf16 v[188:191], v[208:211], v[92:95], v[188:191]
    ds_read_b64_tr_b16 v[226:227], v10 offset:38912
    s_waitcnt lgkmcnt(6)
    v_mfma_f32_16x16x32_bf16 v[192:195], v[212:215], v[88:91], v[192:195]
    ds_read_b64_tr_b16 v[228:229], v11 offset:36864
    v_mfma_f32_16x16x32_bf16 v[196:199], v[212:215], v[92:95], v[196:199]
    ds_read_b64_tr_b16 v[230:231], v11 offset:38912
    s_waitcnt lgkmcnt(6)
    v_mfma_f32_16x16x32_bf16 v[168:171], v[216:219], v[96:99], v[168:171]
    ds_read_b64_tr_b16 v[200:201], v8 offset:40960
    v_mfma_f32_16x16x32_bf16 v[172:175], v[216:219], v[100:103], v[172:175]
    ds_read_b64_tr_b16 v[202:203], v8 offset:43008
    s_waitcnt lgkmcnt(6)
    v_mfma_f32_16x16x32_bf16 v[176:179], v[220:223], v[96:99], v[176:179]
    ds_read_b64_tr_b16 v[204:205], v9 offset:40960
    v_mfma_f32_16x16x32_bf16 v[180:183], v[220:223], v[100:103], v[180:183]
    ds_read_b64_tr_b16 v[206:207], v9 offset:43008
    s_waitcnt lgkmcnt(6)
    v_mfma_f32_16x16x32_bf16 v[184:187], v[224:227], v[96:99], v[184:187]
    ds_read_b64_tr_b16 v[208:209], v10 offset:40960
    v_mfma_f32_16x16x32_bf16 v[188:191], v[224:227], v[100:103], v[188:191]
    ds_read_b64_tr_b16 v[210:211], v10 offset:43008
    s_waitcnt lgkmcnt(6)
    v_mfma_f32_16x16x32_bf16 v[192:195], v[228:231], v[96:99], v[192:195]
    ds_read_b64_tr_b16 v[212:213], v11 offset:40960
    v_mfma_f32_16x16x32_bf16 v[196:199], v[228:231], v[100:103], v[196:199]
    ds_read_b64_tr_b16 v[214:215], v11 offset:43008
    s_waitcnt lgkmcnt(6)
    v_mfma_f32_16x16x32_bf16 v[168:171], v[200:203], v[104:107], v[168:171]
    ds_read_b64_tr_b16 v[216:217], v8 offset:45056
    v_mfma_f32_16x16x32_bf16 v[172:175], v[200:203], v[108:111], v[172:175]
    ds_read_b64_tr_b16 v[218:219], v8 offset:47104
    s_waitcnt lgkmcnt(6)
    v_mfma_f32_16x16x32_bf16 v[176:179], v[204:207], v[104:107], v[176:179]
    ds_read_b64_tr_b16 v[220:221], v9 offset:45056
    v_mfma_f32_16x16x32_bf16 v[180:183], v[204:207], v[108:111], v[180:183]
    ds_read_b64_tr_b16 v[222:223], v9 offset:47104
    s_waitcnt lgkmcnt(6)
    v_mfma_f32_16x16x32_bf16 v[184:187], v[208:211], v[104:107], v[184:187]
    ds_read_b64_tr_b16 v[224:225], v10 offset:45056
    v_mfma_f32_16x16x32_bf16 v[188:191], v[208:211], v[108:111], v[188:191]
    ds_read_b64_tr_b16 v[226:227], v10 offset:47104
    s_waitcnt lgkmcnt(6)
    v_mfma_f32_16x16x32_bf16 v[192:195], v[212:215], v[104:107], v[192:195]
    ds_read_b64_tr_b16 v[228:229], v11 offset:45056
    v_mfma_f32_16x16x32_bf16 v[196:199], v[212:215], v[108:111], v[196:199]
    ds_read_b64_tr_b16 v[230:231], v11 offset:47104
    s_waitcnt lgkmcnt(6)
    v_mfma_f32_16x16x32_bf16 v[168:171], v[216:219], v[112:115], v[168:171]
    v_mfma_f32_16x16x32_bf16 v[172:175], v[216:219], v[116:119], v[172:175]
    s_waitcnt lgkmcnt(4)
    v_mfma_f32_16x16x32_bf16 v[176:179], v[220:223], v[112:115], v[176:179]
    v_mfma_f32_16x16x32_bf16 v[180:183], v[220:223], v[116:119], v[180:183]
    s_waitcnt lgkmcnt(2)
    v_mfma_f32_16x16x32_bf16 v[184:187], v[224:227], v[112:115], v[184:187]
    v_mfma_f32_16x16x32_bf16 v[188:191], v[224:227], v[116:119], v[188:191]
    s_waitcnt lgkmcnt(0)
    v_mfma_f32_16x16x32_bf16 v[192:195], v[228:231], v[112:115], v[192:195]
    v_mfma_f32_16x16x32_bf16 v[196:199], v[228:231], v[116:119], v[196:199]
    ds_read_b64_tr_b16 v[200:201], v8 offset:49152
    ds_read_b64_tr_b16 v[202:203], v8 offset:51200
    ds_read_b64_tr_b16 v[204:205], v9 offset:49152
    ds_read_b64_tr_b16 v[206:207], v9 offset:51200
    ds_read_b64_tr_b16 v[208:209], v10 offset:49152
    ds_read_b64_tr_b16 v[210:211], v10 offset:51200
    ds_read_b64_tr_b16 v[212:213], v11 offset:49152
    ds_read_b64_tr_b16 v[214:215], v11 offset:51200
    s_lshl_b32 s98, s72, 16
    s_lshl_b32 s61, s71, 11
    s_add_u32 s98, s98, s61
    s_add_u32 s98, s98, 2097152
    s_add_u32 s99, s98, 32768
    s_waitcnt vmcnt(4)
    s_nop 0
    ds_read_b128 a[160:163], v20 offset:49152
    ds_read_b128 a[164:167], v21 offset:49152
    ds_read_b128 a[168:171], v22 offset:49152
    ds_read_b128 a[172:175], v23 offset:49152
    ds_read_b128 a[176:179], v20 offset:53248
    ds_read_b128 a[180:183], v21 offset:53248
    ds_read_b128 a[184:187], v22 offset:53248
    ds_read_b128 a[188:191], v23 offset:53248
    s_waitcnt vmcnt(0)
    s_waitcnt lgkmcnt(0)
    s_barrier
    s_cmp_eq_u32 s52, 0
    s_cbranch_scc0 SK_42
    v_mov_b32 v2, s59
    s_mov_b64 exec, 1
    buffer_store_dword v2, off, s[48:51], s63 sc1
    s_mov_b64 exec, -1
SK_42:
    v_mfma_f32_16x16x32_bf16 v[168:171], v[200:203], v[120:123], v[168:171]
    ds_read_b64_tr_b16 v[216:217], v8 offset:53248
    v_mfma_f32_16x16x32_bf16 v[172:175], v[200:203], v[124:127], v[172:175]
    ds_read_b64_tr_b16 v[218:219], v8 offset:55296
    s_add_u32 m0, s67, 0
    s_xor_b32 s66, s94, 1024
    buffer_load_dwordx4 v16, s[24:27], s66 offen offset:0 lds
    buffer_load_dwordx4 v17, s[24:27], s66 offen offset:1024 lds
    buffer_load_dwordx4 v18, s[24:27], s66 offen offset:2048 lds
    buffer_load_dwordx4 v19, s[24:27], s66 offen offset:3072 lds
    v_mfma_f32_16x16x32_bf16 v[176:179], v[204:207], v[120:123], v[176:179]
    ds_read_b64_tr_b16 v[220:221], v9 offset:53248
    v_mfma_f32_16x16x32_bf16 v[180:183], v[204:207], v[124:127], v[180:183]
    ds_read_b64_tr_b16 v[222:223], v9 offset:55296
    v_mfma_f32_16x16x32_bf16 v[184:187], v[208:211], v[120:123], v[184:187]
    ds_read_b64_tr_b16 v[224:225], v10 offset:53248
    v_mfma_f32_16x16x32_bf16 v[188:191], v[208:211], v[124:127], v[188:191]
    ds_read_b64_tr_b16 v[226:227], v10 offset:55296
    v_mfma_f32_16x16x32_bf16 v[192:195], v[212:215], v[120:123], v[192:195]
    ds_read_b64_tr_b16 v[228:229], v11 offset:53248
    v_mfma_f32_16x16x32_bf16 v[196:199], v[212:215], v[124:127], v[196:199]
    ds_read_b64_tr_b16 v[230:231], v11 offset:55296
    s_waitcnt lgkmcnt(6)
    v_mfma_f32_16x16x32_bf16 v[168:171], v[216:219], v[128:131], v[168:171]
    v_mfma_f32_16x16x32_bf16 v[172:175], v[216:219], v[132:135], v[172:175]
    s_add_u32 m0, s67, 4096
    s_xor_b32 s66, s94, 1280
    buffer_load_dwordx4 v16, s[24:27], s66 offen offset:0 lds
    buffer_load_dwordx4 v17, s[24:27], s66 offen offset:1024 lds
    buffer_load_dwordx4 v18, s[24:27], s66 offen offset:2048 lds
    buffer_load_dwordx4 v19, s[24:27], s66 offen offset:3072 lds
    s_waitcnt lgkmcnt(4)
    v_mfma_f32_16x16x32_bf16 v[176:179], v[220:223], v[128:131], v[176:179]
    v_mfma_f32_16x16x32_bf16 v[180:183], v[220:223], v[132:135], v[180:183]
    s_waitcnt lgkmcnt(2)
    v_mfma_f32_16x16x32_bf16 v[184:187], v[224:227], v[128:131], v[184:187]
    v_mfma_f32_16x16x32_bf16 v[188:191], v[224:227], v[132:135], v[188:191]
    s_waitcnt lgkmcnt(0)
    v_mfma_f32_16x16x32_bf16 v[192:195], v[228:231], v[128:131], v[192:195]
    v_mfma_f32_16x16x32_bf16 v[196:199], v[228:231], v[132:135], v[196:199]
    s_add_u32 m0, s67, -49152
    s_xor_b32 s66, s94, 1536
    buffer_load_dwordx4 v16, s[24:27], s66 offen offset:0 lds
    buffer_load_dwordx4 v17, s[24:27], s66 offen offset:1024 lds
    buffer_load_dwordx4 v18, s[24:27], s66 offen offset:2048 lds
    buffer_load_dwordx4 v19, s[24:27], s66 offen offset:3072 lds
    s_add_u32 m0, s67, -45056
    s_xor_b32 s66, s94, 1792
    buffer_load_dwordx4 v16, s[24:27], s66 offen offset:0 lds
    buffer_load_dwordx4 v17, s[24:27], s66 offen offset:1024 lds
    buffer_load_dwordx4 v18, s[24:27], s66 offen offset:2048 lds
    buffer_load_dwordx4 v19, s[24:27], s66 offen offset:3072 lds
    ds_read_b128 v[200:203], v6 offset:512
    ds_read_b128 v[204:207], v6 offset:528
    ds_read_b128 v[208:211], v6 offset:640
    ds_read_b128 v[212:215], v6 offset:656
    ds_read_b128 v[216:219], v6 offset:768
    ds_read_b128 v[220:223], v6 offset:784
    ds_read_b128 v[224:227], v6 offset:896
    ds_read_b128 v[228:231], v6 offset:912
SK_29:
L_P3:
    s_lshl2_add_u32 s72, s57, s52
    s_mul_i32 s61, s58, 7
    s_lshr_b32 s62, s61, 2
    s_add_u32 s63, s61, 6
    s_lshr_b32 s63, s63, 2
    v_and_b32 v4, 3, v0
    v_add_u32 v4, s62, v4
    v_min_u32 v4, s63, v4
    v_lshlrev_b32 v12, 2, v4
    s_and_b32 s63, s53, 1
    s_lshl2_add_u32 s63, s63, s52
    s_lshl_b32 s60, s63, 1
    v_bfe_u32 v3, v0, 2, 1
    v_add_u32 v3, s60, v3
    v_mov_b32_e64 v5, s55
    v_cndmask_b32 v3, v3, v5, s[68:69]
    v_lshl_add_u32 v3, v3, 4, v4
    v_lshlrev_b32_e64 v3, 7, v3
    s_mov_b32 s60, 163840
    s_and_b32 s62, s58, 1
    s_add_u32 s73, s61, s62
    s_lshl_b32 s75, s73, 9
    s_lshl_b32 s73, s73, 16
    s_lshl_b32 s63, s63, 13
    s_add_u32 s63, s63, 8388608
    s_add_u32 s73, s73, s63
    s_cmp_eq_u32 s62, 0
    s_cselect_b32 s74, 6, 0
    s_add_u32 s74, s74, s61
    s_lshr_b32 s76, s74, 1
    s_lshl_b32 s76, s76, 10
    s_lshl3_add_u32 s76, s62, s76
    s_lshl_b32 s74, s74, 16
    s_add_u32 s74, s74, s63
    v_add_u32 v16, 65536, v7
    v_add_u32 v17, 131072, v7
    s_lshl_b32 s78, s72, 15
    s_add_u32 s77, s78, 2097152
    s_lshl_b32 s61, s58, 12
    s_add_u32 s61, s61, s78
    s_add_u32 s78, s78, 2097152
    s_xor_b32 s80, s61, 524288
    s_add_u32 s80, s80, 12582912
    s_add_u32 s85, s61, 12582912
    s_and_b32 s61, s54, 15
    s_lshl4_add_u32 s61, s55, s61
    s_lshl2_add_u32 s61, s61, s52
    s_lshl_b32 s61, s61, 11
    s_xor_b32 s81, s61, 262144
    s_add_u32 s82, s61, 23068672
    s_add_u32 s81, s81, 23068672
    s_lshl_b32 s92, s55, 8
    s_add_u32 s92, s92, 28672
    s_lshl2_add_u32 s83, s71, s92
    s_lshl_b32 s93, s57, 7
    s_add_u32 s93, s93, 24576
    s_mul_i32 s90, s52, 28672
    s_lshl_b32 s61, s58, 7
    s_add_u32 s90, s90, s61
    s_lshl_b32 s91, s52, 12
    s_nop 0
    v_add_u32 v15, 6144, v14
    v_add_u32 v18, 12288, v14
    v_add_u32 v19, 18432, v14
    v_lshl_add_u32 v2, v1, 4, s61
    v_add_u32 v2, 115712, v2
    ds_read_b128 v[104:107], v2 offset:2688
    ds_read_b128 v[108:111], v2 offset:2752
    s_sub_u32 s84, s59, 1
    s_cmp_lt_u32 s58, 7
    s_cselect_b32 s98, s98, 33554432
    s_cselect_b32 s99, s99, 33554432
    s_cselect_b64 vcc, 1, 0
    buffer_load_dword v5, v3, s[48:51], s60 offen sc1
    s_waitcnt lgkmcnt(2)
    v_pk_fma_f32 v[168:169], v[200:201], v[232:233], v[168:169] op_sel:[0,0,0] op_sel_hi:[1,0,1] neg_lo:[0,1,0] neg_hi:[0,1,0]
    v_pk_fma_f32 v[170:171], v[202:203], v[232:233], v[170:171] op_sel:[0,0,0] op_sel_hi:[1,0,1] neg_lo:[0,1,0] neg_hi:[0,1,0]
    v_pk_fma_f32 v[172:173], v[200:201], v[232:233], v[172:173] op_sel:[0,1,0] op_sel_hi:[1,1,1] neg_lo:[0,1,0] neg_hi:[0,1,0]
    v_pk_fma_f32 v[174:175], v[202:203], v[232:233], v[174:175] op_sel:[0,1,0] op_sel_hi:[1,1,1] neg_lo:[0,1,0] neg_hi:[0,1,0]
    v_pk_fma_f32 v[168:169], v[168:169], v[234:235], v[204:205] op_sel:[0,0,0] op_sel_hi:[1,0,1]
    v_pk_fma_f32 v[170:171], v[170:171], v[234:235], v[206:207] op_sel:[0,0,0] op_sel_hi:[1,0,1]
    v_pk_fma_f32 v[172:173], v[172:173], v[234:235], v[204:205] op_sel:[0,1,0] op_sel_hi:[1,1,1]
    v_pk_fma_f32 v[174:175], v[174:175], v[234:235], v[206:207] op_sel:[0,1,0] op_sel_hi:[1,1,1]
    v_pk_mul_f32 v[200:201], v[168:169], v[168:169]
    v_pk_mul_f32 v[202:203], v[170:171], v[170:171]
    v_pk_mul_f32 v[204:205], v[172:173], v[172:173]
    v_pk_mul_f32 v[206:207], v[174:175], v[174:175]
    v_pk_fma_f32 v[200:201], v[200:201], s[96:97], v[236:237] op_sel_hi:[1,1,0]
    v_pk_fma_f32 v[202:203], v[202:203], s[96:97], v[236:237] op_sel_hi:[1,1,0]
    v_pk_fma_f32 v[204:205], v[204:205], s[96:97], v[236:237] op_sel_hi:[1,1,0]
    v_pk_fma_f32 v[206:207], v[206:207], s[96:97], v[236:237] op_sel_hi:[1,1,0]
    v_pk_mul_f32 v[200:201], v[200:201], v[168:169]
    v_pk_mul_f32 v[202:203], v[202:203], v[170:171]
    v_pk_mul_f32 v[204:205], v[204:205], v[172:173]
    v_pk_mul_f32 v[206:207], v[206:207], v[174:175]
    v_exp_f32 v200, v200
    v_exp_f32 v201, v201
    v_exp_f32 v202, v202
    v_exp_f32 v203, v203
    v_exp_f32 v204, v204
    v_exp_f32 v205, v205
    v_exp_f32 v206, v206
    v_exp_f32 v207, v207
    v_pk_add_f32 v[200:201], v[200:201], 1.0 op_sel_hi:[1,0]
    v_pk_add_f32 v[202:203], v[202:203], 1.0 op_sel_hi:[1,0]
    v_pk_add_f32 v[204:205], v[204:205], 1.0 op_sel_hi:[1,0]
    v_pk_add_f32 v[206:207], v[206:207], 1.0 op_sel_hi:[1,0]
    v_rcp_f32 v200, v200
    v_rcp_f32 v201, v201
    v_rcp_f32 v202, v202
    v_rcp_f32 v203, v203
    v_rcp_f32 v204, v204
    v_rcp_f32 v205, v205
    v_rcp_f32 v206, v206
    v_rcp_f32 v207, v207
    v_pk_mul_f32 v[168:169], v[168:169], v[200:201]
    v_pk_mul_f32 v[170:171], v[170:171], v[202:203]
    v_pk_mul_f32 v[172:173], v[172:173], v[204:205]
    v_pk_mul_f32 v[174:175], v[174:175], v[206:207]
    s_cbranch_vccz SK_43
    s_waitcnt vmcnt(1)
    ds_read_b128 a[192:195], v20 offset:49152
    ds_read_b128 a[196:199], v21 offset:49152
    ds_read_b128 a[200:203], v22 offset:49152
    ds_read_b128 a[204:207], v23 offset:49152
    ds_read_b128 a[208:211], v20 offset:53248
    ds_read_b128 a[212:215], v21 offset:53248
    ds_read_b128 a[216:219], v22 offset:53248
    ds_read_b128 a[220:223], v23 offset:53248
    s_waitcnt vmcnt(1)
    s_nop 0
    ds_read_b128 a[224:227], v20 offset:0
    ds_read_b128 a[228:231], v21 offset:0
    ds_read_b128 a[232:235], v22 offset:0
    ds_read_b128 a[236:239], v23 offset:0
    ds_read_b128 a[240:243], v20 offset:4096
    ds_read_b128 a[244:247], v21 offset:4096
    ds_read_b128 a[248:251], v22 offset:4096
    ds_read_b128 a[252:255], v23 offset:4096
SK_43:
    s_waitcnt lgkmcnt(0)
    s_barrier
    s_waitcnt vmcnt(0)
    v_cmp_ne_u32 vcc, s59, v5
    s_cbranch_vccz L_PFD
    s_mov_b32 s66, 0
L_PFL:
    s_add_u32 s66, s66, 1
    s_cmp_gt_u32 s66, 0x40000
    s_cbranch_scc1 L_PFD
L_PFF:
    buffer_load_dword v5, v3, s[48:51], s60 offen sc1
    s_waitcnt vmcnt(0)
    v_cmp_ne_u32 vcc, s59, v5
    s_cbranch_vccnz L_PFL
L_PFD:
    s_add_u32 m0, s67, 0
    s_add_u32 s79, s73, 0
    s_nop 0
    buffer_load_dwordx4 v7, s[48:51], s79 offen offset:0 sc1 lds
    buffer_load_dwordx4 v7, s[48:51], s79 offen offset:1024 sc1 lds
    buffer_load_dwordx4 v7, s[48:51], s79 offen offset:2048 sc1 lds
    buffer_load_dwordx4 v7, s[48:51], s79 offen offset:3072 sc1 lds
    s_add_u32 m0, s67, 4096
    s_add_u32 s79, s73, 4096
    buffer_load_dwordx4 v7, s[48:51], s79 offen offset:0 sc1 lds
    buffer_load_dwordx4 v7, s[48:51], s79 offen offset:1024 sc1 lds
    buffer_load_dwordx4 v7, s[48:51], s79 offen offset:2048 sc1 lds
    buffer_load_dwordx4 v7, s[48:51], s79 offen offset:3072 sc1 lds
    v_mov_b32 v79, s84
    v_mov_b32 v83, s84
    v_mov_b32 v131, s84
    v_mov_b32 v135, s84
    v_mov_b32 v139, s84
    v_mov_b32 v64, v252
    v_mov_b32 v65, v252
    v_mov_b32 v66, v252
    v_mov_b32_e64 v67, v252
    v_pk_fma_f32 v[176:177], v[208:209], v[232:233], v[176:177] op_sel:[0,0,0] op_sel_hi:[1,0,1] neg_lo:[0,1,0] neg_hi:[0,1,0]
    v_pk_fma_f32 v[178:179], v[210:211], v[232:233], v[178:179] op_sel:[0,0,0] op_sel_hi:[1,0,1] neg_lo:[0,1,0] neg_hi:[0,1,0]
    v_pk_fma_f32 v[180:181], v[208:209], v[232:233], v[180:181] op_sel:[0,1,0] op_sel_hi:[1,1,1] neg_lo:[0,1,0] neg_hi:[0,1,0]
    v_pk_fma_f32 v[182:183], v[210:211], v[232:233], v[182:183] op_sel:[0,1,0] op_sel_hi:[1,1,1] neg_lo:[0,1,0] neg_hi:[0,1,0]
    v_pk_fma_f32 v[176:177], v[176:177], v[234:235], v[212:213] op_sel:[0,0,0] op_sel_hi:[1,0,1]
    v_pk_fma_f32 v[178:179], v[178:179], v[234:235], v[214:215] op_sel:[0,0,0] op_sel_hi:[1,0,1]
    v_pk_fma_f32 v[180:181], v[180:181], v[234:235], v[212:213] op_sel:[0,1,0] op_sel_hi:[1,1,1]
    v_pk_fma_f32 v[182:183], v[182:183], v[234:235], v[214:215] op_sel:[0,1,0] op_sel_hi:[1,1,1]
    v_pk_mul_f32 v[208:209], v[176:177], v[176:177]
    v_pk_mul_f32 v[210:211], v[178:179], v[178:179]
    s_add_u32 m0, s67, -65536
    s_add_u32 s79, s73, 65536
    buffer_load_dwordx4 v7, s[48:51], s79 offen offset:0 sc1 lds
    v_pk_mul_f32 v[212:213], v[180:181], v[180:181]
    v_pk_mul_f32 v[214:215], v[182:183], v[182:183]
    v_pk_fma_f32 v[208:209], v[208:209], s[96:97], v[236:237] op_sel_hi:[1,1,0]
    v_pk_fma_f32 v[210:211], v[210:211], s[96:97], v[236:237] op_sel_hi:[1,1,0]
    v_pk_fma_f32 v[212:213], v[212:213], s[96:97], v[236:237] op_sel_hi:[1,1,0]
    v_pk_fma_f32 v[214:215], v[214:215], s[96:97], v[236:237] op_sel_hi:[1,1,0]
    v_pk_mul_f32 v[208:209], v[208:209], v[176:177]
    v_pk_mul_f32 v[210:211], v[210:211], v[178:179]
    v_pk_mul_f32 v[212:213], v[212:213], v[180:181]
    v_pk_mul_f32 v[214:215], v[214:215], v[182:183]
    v_exp_f32 v208, v208
    v_exp_f32 v209, v209
    v_exp_f32 v210, v210
    v_exp_f32 v211, v211
    v_exp_f32 v212, v212
    v_exp_f32 v213, v213
    v_exp_f32 v214, v214
    v_exp_f32 v215, v215
    v_pk_add_f32 v[208:209], v[208:209], 1.0 op_sel_hi:[1,0]
    v_pk_add_f32 v[210:211], v[210:211], 1.0 op_sel_hi:[1,0]
    v_pk_add_f32 v[212:213], v[212:213], 1.0 op_sel_hi:[1,0]
    v_pk_add_f32 v[214:215], v[214:215], 1.0 op_sel_hi:[1,0]
    v_rcp_f32 v208, v208
    v_rcp_f32 v209, v209
    v_rcp_f32 v210, v210
    v_rcp_f32 v211, v211
    v_rcp_f32 v212, v212
    v_rcp_f32 v213, v213
    v_rcp_f32 v214, v214
    v_rcp_f32 v215, v215
    v_pk_mul_f32 v[176:177], v[176:177], v[208:209]
    v_pk_mul_f32 v[178:179], v[178:179], v[210:211]
    v_pk_mul_f32 v[180:181], v[180:181], v[212:213]
    v_pk_mul_f32 v[182:183], v[182:183], v[214:215]
    v_cvt_pk_bf16_f32 v200, v168, v169
    v_cvt_pk_bf16_f32 v201, v170, v171
    v_cvt_pk_bf16_f32 v202, v176, v177
    v_cvt_pk_bf16_f32 v203, v178, v179
    v_cvt_pk_bf16_f32 v204, v172, v173
    buffer_load_dwordx4 v7, s[48:51], s79 offen offset:1024 sc1 lds
    v_cvt_pk_bf16_f32 v205, v174, v175
    v_cvt_pk_bf16_f32 v206, v180, v181
    v_cvt_pk_bf16_f32 v207, v182, v183
    v_pk_fma_f32 v[184:185], v[216:217], v[232:233], v[184:185] op_sel:[0,0,0] op_sel_hi:[1,0,1] neg_lo:[0,1,0] neg_hi:[0,1,0]
    v_pk_fma_f32 v[186:187], v[218:219], v[232:233], v[186:187] op_sel:[0,0,0] op_sel_hi:[1,0,1] neg_lo:[0,1,0] neg_hi:[0,1,0]
    v_pk_fma_f32 v[188:189], v[216:217], v[232:233], v[188:189] op_sel:[0,1,0] op_sel_hi:[1,1,1] neg_lo:[0,1,0] neg_hi:[0,1,0]
    v_pk_fma_f32 v[190:191], v[218:219], v[232:233], v[190:191] op_sel:[0,1,0] op_sel_hi:[1,1,1] neg_lo:[0,1,0] neg_hi:[0,1,0]
    v_pk_fma_f32 v[184:185], v[184:185], v[234:235], v[220:221] op_sel:[0,0,0] op_sel_hi:[1,0,1]
    v_pk_fma_f32 v[186:187], v[186:187], v[234:235], v[222:223] op_sel:[0,0,0] op_sel_hi:[1,0,1]
    v_pk_fma_f32 v[188:189], v[188:189], v[234:235], v[220:221] op_sel:[0,1,0] op_sel_hi:[1,1,1]
    v_pk_fma_f32 v[190:191], v[190:191], v[234:235], v[222:223] op_sel:[0,1,0] op_sel_hi:[1,1,1]
    v_pk_mul_f32 v[216:217], v[184:185], v[184:185]
    v_pk_mul_f32 v[218:219], v[186:187], v[186:187]
    v_pk_mul_f32 v[220:221], v[188:189], v[188:189]
    v_pk_mul_f32 v[222:223], v[190:191], v[190:191]
    v_pk_fma_f32 v[216:217], v[216:217], s[96:97], v[236:237] op_sel_hi:[1,1,0]
    v_pk_fma_f32 v[218:219], v[218:219], s[96:97], v[236:237] op_sel_hi:[1,1,0]
    v_pk_fma_f32 v[220:221], v[220:221], s[96:97], v[236:237] op_sel_hi:[1,1,0]
    v_pk_fma_f32 v[222:223], v[222:223], s[96:97], v[236:237] op_sel_hi:[1,1,0]
    v_pk_mul_f32 v[216:217], v[216:217], v[184:185]
    v_pk_mul_f32 v[218:219], v[218:219], v[186:187]
    v_pk_mul_f32 v[220:221], v[220:221], v[188:189]
    v_pk_mul_f32 v[222:223], v[222:223], v[190:191]
    v_exp_f32 v216, v216
    v_exp_f32 v217, v217
    v_exp_f32 v218, v218
    v_exp_f32 v219, v219
    v_exp_f32 v220, v220
    v_exp_f32 v221, v221
    v_exp_f32 v222, v222
    v_exp_f32 v223, v223
    v_pk_add_f32 v[216:217], v[216:217], 1.0 op_sel_hi:[1,0]
    v_pk_add_f32 v[218:219], v[218:219], 1.0 op_sel_hi:[1,0]
    v_pk_add_f32 v[220:221], v[220:221], 1.0 op_sel_hi:[1,0]
    v_pk_add_f32 v[222:223], v[222:223], 1.0 op_sel_hi:[1,0]
    v_rcp_f32 v216, v216
    v_rcp_f32 v217, v217
    v_rcp_f32 v218, v218
    v_rcp_f32 v219, v219
    v_rcp_f32_e64 v220, v220
    buffer_load_dwordx4 v7, s[48:51], s79 offen offset:2048 sc1 lds
    v_rcp_f32 v221, v221
    v_rcp_f32 v222, v222
    v_rcp_f32_e64 v223, v223
    v_pk_mul_f32 v[184:185], v[184:185], v[216:217]
    v_pk_mul_f32 v[186:187], v[186:187], v[218:219]
    v_pk_mul_f32 v[188:189], v[188:189], v[220:221]
    v_pk_mul_f32 v[190:191], v[190:191], v[222:223]
    v_pk_fma_f32 v[192:193], v[224:225], v[232:233], v[192:193] op_sel:[0,0,0] op_sel_hi:[1,0,1] neg_lo:[0,1,0] neg_hi:[0,1,0]
    v_pk_fma_f32 v[194:195], v[226:227], v[232:233], v[194:195] op_sel:[0,0,0] op_sel_hi:[1,0,1] neg_lo:[0,1,0] neg_hi:[0,1,0]
    v_pk_fma_f32 v[196:197], v[224:225], v[232:233], v[196:197] op_sel:[0,1,0] op_sel_hi:[1,1,1] neg_lo:[0,1,0] neg_hi:[0,1,0]
    v_pk_fma_f32 v[198:199], v[226:227], v[232:233], v[198:199] op_sel:[0,1,0] op_sel_hi:[1,1,1] neg_lo:[0,1,0] neg_hi:[0,1,0]
    v_pk_fma_f32 v[192:193], v[192:193], v[234:235], v[228:229] op_sel:[0,0,0] op_sel_hi:[1,0,1]
    v_pk_fma_f32 v[194:195], v[194:195], v[234:235], v[230:231] op_sel:[0,0,0] op_sel_hi:[1,0,1]
    v_pk_fma_f32 v[196:197], v[196:197], v[234:235], v[228:229] op_sel:[0,1,0] op_sel_hi:[1,1,1]
    v_pk_fma_f32 v[198:199], v[198:199], v[234:235], v[230:231] op_sel:[0,1,0] op_sel_hi:[1,1,1]
    v_pk_mul_f32 v[224:225], v[192:193], v[192:193]
    v_pk_mul_f32 v[226:227], v[194:195], v[194:195]
    v_pk_mul_f32 v[228:229], v[196:197], v[196:197]
    v_pk_mul_f32 v[230:231], v[198:199], v[198:199]
    v_pk_fma_f32 v[224:225], v[224:225], s[96:97], v[236:237] op_sel_hi:[1,1,0]
    v_pk_fma_f32 v[226:227], v[226:227], s[96:97], v[236:237] op_sel_hi:[1,1,0]
    v_pk_fma_f32 v[228:229], v[228:229], s[96:97], v[236:237] op_sel_hi:[1,1,0]
    v_pk_fma_f32 v[230:231], v[230:231], s[96:97], v[236:237] op_sel_hi:[1,1,0]
    v_pk_mul_f32 v[224:225], v[224:225], v[192:193]
    v_pk_mul_f32 v[226:227], v[226:227], v[194:195]
    v_pk_mul_f32 v[228:229], v[228:229], v[196:197]
    v_pk_mul_f32 v[230:231], v[230:231], v[198:199]
    v_exp_f32 v224, v224
    v_exp_f32 v225, v225
    v_exp_f32 v226, v226
    v_exp_f32 v227, v227
    v_exp_f32 v228, v228
    v_exp_f32 v229, v229
    v_exp_f32 v230, v230
    v_exp_f32 v231, v231
    v_pk_add_f32 v[224:225], v[224:225], 1.0 op_sel_hi:[1,0]
    v_pk_add_f32 v[226:227], v[226:227], 1.0 op_sel_hi:[1,0]
    v_pk_add_f32 v[228:229], v[228:229], 1.0 op_sel_hi:[1,0]
    v_pk_add_f32 v[230:231], v[230:231], 1.0 op_sel_hi:[1,0]
    buffer_load_dwordx4 v7, s[48:51], s79 offen offset:3072 sc1 lds
    v_rcp_f32 v224, v224
    v_rcp_f32 v225, v225
    v_rcp_f32 v226, v226
    v_rcp_f32 v227, v227
    v_rcp_f32 v228, v228
    v_rcp_f32 v229, v229
    v_rcp_f32 v230, v230
    v_rcp_f32 v231, v231
    v_pk_mul_f32 v[192:193], v[192:193], v[224:225]
    v_pk_mul_f32 v[194:195], v[194:195], v[226:227]
    v_pk_mul_f32 v[196:197], v[196:197], v[228:229]
    v_pk_mul_f32 v[198:199], v[198:199], v[230:231]
    v_cvt_pk_bf16_f32 v216, v184, v185
    v_cvt_pk_bf16_f32 v217, v186, v187
    v_cvt_pk_bf16_f32 v218, v192, v193
    v_cvt_pk_bf16_f32 v219, v194, v195
    v_cvt_pk_bf16_f32 v220, v188, v189
    v_cvt_pk_bf16_f32 v221, v190, v191
    v_cvt_pk_bf16_f32 v222, v196, v197
    v_cvt_pk_bf16_f32 v223, v198, v199
    s_cmp_eq_u32 s87, 0
    s_cbranch_scc1 WT_44
    buffer_store_dwordx4 v[200:203], v7, s[48:51], s98 offen offset:0
    buffer_store_dwordx4 v[204:207], v7, s[48:51], s99 offen offset:0
WB_45:
    s_cmp_eq_u32 s87, 0
    s_cbranch_scc1 WT_46
    buffer_store_dwordx4 v[216:219], v7, s[48:51], s98 offen offset:1024
    buffer_store_dwordx4 v[220:223], v7, s[48:51], s99 offen offset:1024
WB_47:
    s_waitcnt vmcnt(14)
    s_barrier
    ds_read_b128 v[24:27], v17 offset:0
    ds_read_b128 v[28:31], v17 offset:8192
    ds_read_b128 v[32:35], v17 offset:16384
    ds_read_b128 v[36:39], v17 offset:24576
    ds_read_b128 v[40:43], v17 offset:1024
    s_waitcnt lgkmcnt(4)
    v_mfma_f32_16x16x32_bf16 v[56:59], v[24:27], a[0:3], 0
    ds_read_b128 v[44:47], v17 offset:9216
    v_mfma_f32_16x16x32_bf16 v[140:143], v[24:27], a[128:131], v[64:67]
    s_add_u32 m0, s67, -61440
    s_add_u32 s79, s73, 69632
    s_waitcnt lgkmcnt(3)
    v_mfma_f32_16x16x32_bf16 v[56:59], v[28:31], a[32:35], v[56:59]
    ds_read_b128 v[48:51], v17 offset:17408
    v_mfma_f32_16x16x32_bf16 v[140:143], v[28:31], a[160:163], v[140:143]
    buffer_load_dwordx4 v7, s[48:51], s79 offen offset:0 sc1 lds
    v_mfma_f32_16x16x32_bf16 v[56:59], v[32:35], a[64:67], v[56:59]
    ds_read_b128 v[52:55], v17 offset:25600
    v_mfma_f32_16x16x32_bf16 v[140:143], v[32:35], a[192:195], v[140:143]
    s_waitcnt lgkmcnt(2)
    v_mfma_f32_16x16x32_bf16 v[56:59], v[36:39], a[96:99], v[56:59]
    s_waitcnt vmcnt(13)
    s_barrier
    ds_read_b128 v[24:27], v17 offset:2048
    v_mfma_f32_16x16x32_bf16 v[140:143], v[36:39], a[224:227], v[140:143]
    buffer_load_dwordx4 v7, s[48:51], s79 offen offset:1024 sc1 lds
    v_mfma_f32_16x16x32_bf16 v[56:59], v[40:43], a[4:7], v[56:59]
    ds_read_b128 v[28:31], v17 offset:10240
    v_mfma_f32_16x16x32_bf16 v[140:143], v[40:43], a[132:135], v[140:143]
    v_mfma_f32_16x16x32_bf16 v[56:59], v[44:47], a[36:39], v[56:59]
    ds_read_b128 v[32:35], v17 offset:18432
    v_mfma_f32_16x16x32_bf16 v[140:143], v[44:47], a[164:167], v[140:143]
    s_waitcnt lgkmcnt(2)
    v_mfma_f32_16x16x32_bf16 v[56:59], v[48:51], a[68:71], v[56:59]
    ds_read_b128 v[36:39], v17 offset:26624
    v_mfma_f32_16x16x32_bf16 v[140:143], v[48:51], a[196:199], v[140:143]
    v_mfma_f32_16x16x32_bf16 v[56:59], v[52:55], a[100:103], v[56:59]
    ds_read_b128 v[40:43], v17 offset:3072
    v_mfma_f32_16x16x32_bf16 v[140:143], v[52:55], a[228:231], v[140:143]
    buffer_load_dwordx4 v7, s[48:51], s79 offen offset:2048 sc1 lds
    v_mfma_f32_16x16x32_bf16 v[56:59], v[24:27], a[8:11], v[56:59]
    ds_read_b128 v[44:47], v17 offset:11264
    v_mfma_f32_16x16x32_bf16 v[140:143], v[24:27], a[136:139], v[140:143]
    s_waitcnt lgkmcnt(2)
    v_mfma_f32_16x16x32_bf16 v[56:59], v[28:31], a[40:43], v[56:59]
    ds_read_b128 v[48:51], v17 offset:19456
    v_mfma_f32_16x16x32_bf16 v[140:143], v[28:31], a[168:171], v[140:143]
    v_mfma_f32_16x16x32_bf16 v[56:59], v[32:35], a[72:75], v[56:59]
    ds_read_b128 v[52:55], v17 offset:27648
    v_mfma_f32_16x16x32_bf16 v[140:143], v[32:35], a[200:203], v[140:143]
    buffer_load_dwordx4 v7, s[48:51], s79 offen offset:3072 sc1 lds
    v_mfma_f32_16x16x32_bf16 v[56:59], v[36:39], a[104:107], v[56:59]
    s_waitcnt vmcnt(14)
    s_barrier
    ds_read_b128 v[24:27], v17 offset:4096
    v_mfma_f32_16x16x32_bf16 v[140:143], v[36:39], a[232:235], v[140:143]
    s_waitcnt lgkmcnt(2)
    v_mfma_f32_16x16x32_bf16 v[56:59], v[40:43], a[12:15], v[56:59]
    ds_read_b128 v[28:31], v17 offset:12288
    v_mfma_f32_16x16x32_bf16 v[140:143], v[40:43], a[140:143], v[140:143]
    v_mfma_f32_16x16x32_bf16 v[56:59], v[44:47], a[44:47], v[56:59]
    ds_read_b128 v[32:35], v17 offset:20480
    v_mfma_f32_16x16x32_bf16 v[140:143], v[44:47], a[172:175], v[140:143]
    v_mfma_f32_16x16x32_bf16 v[56:59], v[48:51], a[76:79], v[56:59]
    ds_read_b128 v[36:39], v17 offset:28672
    v_mfma_f32_16x16x32_bf16 v[140:143], v[48:51], a[204:207], v[140:143]
    s_add_u32 m0, s67, -32768
    s_add_u32 s79, s73, 131072
    s_waitcnt lgkmcnt(2)
    v_mfma_f32_16x16x32_bf16 v[56:59], v[52:55], a[108:111], v[56:59]
    ds_read_b128 v[40:43], v17 offset:5120
    v_mfma_f32_16x16x32_bf16 v[140:143], v[52:55], a[236:239], v[140:143]
    buffer_load_dwordx4 v7, s[48:51], s79 offen offset:0 sc1 lds
    v_mfma_f32_16x16x32_bf16 v[56:59], v[24:27], a[16:19], v[56:59]
    ds_read_b128 v[44:47], v17 offset:13312
    v_mfma_f32_16x16x32_bf16 v[140:143], v[24:27], a[144:147], v[140:143]
    v_mfma_f32_16x16x32_bf16 v[56:59], v[28:31], a[48:51], v[56:59]
    ds_read_b128 v[48:51], v17 offset:21504
    v_mfma_f32_16x16x32_bf16 v[140:143], v[28:31], a[176:179], v[140:143]
    buffer_load_dwordx4 v7, s[48:51], s79 offen offset:1024 sc1 lds
    s_waitcnt lgkmcnt(2)
    v_mfma_f32_16x16x32_bf16 v[56:59], v[32:35], a[80:83], v[56:59]
    ds_read_b128 v[52:55], v17 offset:29696
    v_mfma_f32_16x16x32_bf16 v[140:143], v[32:35], a[208:211], v[140:143]
    v_mfma_f32_16x16x32_bf16 v[56:59], v[36:39], a[112:115], v[56:59]
    s_waitcnt vmcnt(14)
    s_barrier
    ds_read_b128 v[24:27], v17 offset:6144
    v_mfma_f32_16x16x32_bf16 v[140:143], v[36:39], a[240:243], v[140:143]
    v_mfma_f32_16x16x32_bf16 v[56:59], v[40:43], a[20:23], v[56:59]
    ds_read_b128 v[28:31], v17 offset:14336
    v_mfma_f32_16x16x32_bf16 v[140:143], v[40:43], a[148:151], v[140:143]
    s_waitcnt lgkmcnt(2)
    v_mfma_f32_16x16x32_bf16 v[56:59], v[44:47], a[52:55], v[56:59]
    ds_read_b128 v[32:35], v17 offset:22528
    v_mfma_f32_16x16x32_bf16 v[140:143], v[44:47], a[180:183], v[140:143]
    buffer_load_dwordx4 v7, s[48:51], s79 offen offset:2048 sc1 lds
    v_mfma_f32_16x16x32_bf16 v[56:59], v[48:51], a[84:87], v[56:59]
    ds_read_b128 v[36:39], v17 offset:30720
    v_mfma_f32_16x16x32_bf16 v[140:143], v[48:51], a[212:215], v[140:143]
    v_mfma_f32_16x16x32_bf16 v[56:59], v[52:55], a[116:119], v[56:59]
    ds_read_b128 v[40:43], v17 offset:7168
    v_mfma_f32_16x16x32_bf16 v[140:143], v[52:55], a[244:247], v[140:143]
    s_waitcnt lgkmcnt(2)
    v_mfma_f32_16x16x32_bf16 v[56:59], v[24:27], a[24:27], v[56:59]
    ds_read_b128 v[44:47], v17 offset:15360
    v_mfma_f32_16x16x32_bf16 v[140:143], v[24:27], a[152:155], v[140:143]
    buffer_load_dwordx4 v7, s[48:51], s79 offen offset:3072 sc1 lds
    v_mfma_f32_16x16x32_bf16 v[56:59], v[28:31], a[56:59], v[56:59]
    ds_read_b128 v[48:51], v17 offset:23552
    v_mfma_f32_16x16x32_bf16 v[140:143], v[28:31], a[184:187], v[140:143]
    s_add_u32 m0, s91, 0
    s_add_u32 s63, s90, 0
    v_mfma_f32_16x16x32_bf16 v[56:59], v[32:35], a[88:91], v[56:59]
    ds_read_b128 v[52:55], v17 offset:31744
    v_mfma_f32_16x16x32_bf16 v[140:143], v[32:35], a[216:219], v[140:143]
    buffer_load_dwordx4 v14, s[32:35], s63 offen offset:0 lds
    s_waitcnt lgkmcnt(2)
    v_mfma_f32_16x16x32_bf16 v[56:59], v[36:39], a[120:123], v[56:59]
    s_waitcnt vmcnt(13)
    s_waitcnt vmcnt(9)
    s_barrier
    s_cmp_lt_u32 s58, 7
    s_cbranch_scc0 SK_48
    s_cmp_eq_u32 s52, 0
    s_cbranch_scc0 SK_49
    v_mov_b32 v2, s59
    s_mov_b64 exec, 1
    s_cmp_eq_u32 s87, 0
    s_cbranch_scc1 WT_50
    buffer_store_dword v2, off, s[48:51], s83
WB_51:
    s_mov_b64 exec, -1
SK_49:
SK_48:
    ds_read_b128 v[24:27], v16 offset:0
    v_mfma_f32_16x16x32_bf16 v[140:143], v[36:39], a[248:251], v[140:143]
    v_mfma_f32_16x16x32_bf16 v[56:59], v[40:43], a[28:31], v[56:59]
    ds_read_b128 v[28:31], v16 offset:8192
    v_mfma_f32_16x16x32_bf16 v[140:143], v[40:43], a[156:159], v[140:143]
    s_add_u32 m0, s67, -28672
    s_add_u32 s79, s73, 135168
    v_mfma_f32_16x16x32_bf16 v[56:59], v[44:47], a[60:63], v[56:59]
    ds_read_b128 v[32:35], v16 offset:16384
    v_mfma_f32_16x16x32_bf16 v[140:143], v[44:47], a[188:191], v[140:143]
    buffer_load_dwordx4 v7, s[48:51], s79 offen offset:0 sc1 lds
    s_waitcnt lgkmcnt(2)
    v_mfma_f32_16x16x32_bf16 v[56:59], v[48:51], a[92:95], v[56:59]
    ds_read_b128 v[36:39], v16 offset:24576
    v_mfma_f32_16x16x32_bf16 v[140:143], v[48:51], a[220:223], v[140:143]
    v_mfma_f32_16x16x32_bf16 v[56:59], v[52:55], a[124:127], v[56:59]
    ds_read_b128 v[40:43], v16 offset:1024
    v_mfma_f32_16x16x32_bf16 v[140:143], v[52:55], a[252:255], v[140:143]
    buffer_load_dwordx4 v7, s[48:51], s79 offen offset:1024 sc1 lds
    v_mfma_f32_16x16x32_bf16 v[60:63], v[24:27], a[0:3], 0
    ds_read_b128 v[44:47], v16 offset:9216
    v_mfma_f32_16x16x32_bf16 v[144:147], v[24:27], a[128:131], v[64:67]
    s_add_u32 m0, s91, 0
    s_nop 0
    buffer_load_dwordx4 v15, s[32:35], s63 offen offset:1024 lds
    s_waitcnt lgkmcnt(2)
    v_mfma_f32_16x16x32_bf16 v[60:63], v[28:31], a[32:35], v[60:63]
    ds_read_b128 v[48:51], v16 offset:17408
    v_mfma_f32_16x16x32_bf16 v[144:147], v[28:31], a[160:163], v[144:147]
    v_mfma_f32_16x16x32_bf16 v[60:63], v[32:35], a[64:67], v[60:63]
    ds_read_b128 v[52:55], v16 offset:25600
    v_mfma_f32_16x16x32_bf16 v[144:147], v[32:35], a[192:195], v[144:147]
    v_mfma_f32_16x16x32_bf16 v[60:63], v[36:39], a[96:99], v[60:63]
    ds_read_b128 v[24:27], v16 offset:2048
    v_mfma_f32_16x16x32_bf16 v[144:147], v[36:39], a[224:227], v[144:147]
    s_add_u32 m0, s67, -28672
    s_nop 0
    buffer_load_dwordx4 v7, s[48:51], s79 offen offset:2048 sc1 lds
    s_waitcnt lgkmcnt(2)
    v_mfma_f32_16x16x32_bf16 v[60:63], v[40:43], a[4:7], v[60:63]
    ds_read_b128 v[28:31], v16 offset:10240
    v_mfma_f32_16x16x32_bf16 v[144:147], v[40:43], a[132:135], v[144:147]
    v_cvt_pk_bf16_f32 v76, v56, v57
    v_mfma_f32_16x16x32_bf16 v[60:63], v[44:47], a[36:39], v[60:63]
    ds_read_b128 v[32:35], v16 offset:18432
    v_mfma_f32_16x16x32_bf16 v[144:147], v[44:47], a[164:167], v[144:147]
    v_cvt_pk_bf16_f32 v77, v58, v59
    v_mfma_f32_16x16x32_bf16 v[60:63], v[48:51], a[68:71], v[60:63]
    ds_read_b128 v[36:39], v16 offset:26624
    v_mfma_f32_16x16x32_bf16 v[144:147], v[48:51], a[196:199], v[144:147]
    buffer_load_dwordx4 v7, s[48:51], s79 offen offset:3072 sc1 lds
    s_waitcnt lgkmcnt(2)
    v_mfma_f32_16x16x32_bf16 v[60:63], v[52:55], a[100:103], v[60:63]
    ds_read_b128 v[40:43], v16 offset:3072
    v_mfma_f32_16x16x32_bf16 v[144:147], v[52:55], a[228:231], v[144:147]
    v_mfma_f32_16x16x32_bf16 v[60:63], v[24:27], a[8:11], v[60:63]
    ds_read_b128 v[44:47], v16 offset:11264
    v_mfma_f32_16x16x32_bf16 v[144:147], v[24:27], a[136:139], v[144:147]
    s_add_u32 m0, s91, 0
    s_nop 0
    buffer_load_dwordx4 v18, s[32:35], s63 offen offset:2048 lds
    v_mfma_f32_16x16x32_bf16 v[60:63], v[28:31], a[40:43], v[60:63]
    ds_read_b128 v[48:51], v16 offset:19456
    v_mfma_f32_16x16x32_bf16 v[144:147], v[28:31], a[168:171], v[144:147]
    s_waitcnt lgkmcnt(2)
    v_mfma_f32_16x16x32_bf16 v[60:63], v[32:35], a[72:75], v[60:63]
    ds_read_b128 v[52:55], v16 offset:27648
    v_mfma_f32_16x16x32_bf16 v[144:147], v[32:35], a[200:203], v[144:147]
    s_add_u32 m0, s67, 0
    s_add_u32 s79, s73, 196608
    v_mfma_f32_16x16x32_bf16 v[60:63], v[36:39], a[104:107], v[60:63]
    s_waitcnt vmcnt(11)
    s_barrier
    ds_read_b128 v[24:27], v16 offset:4096
    v_mfma_f32_16x16x32_bf16 v[144:147], v[36:39], a[232:235], v[144:147]
    buffer_load_dwordx4 v7, s[48:51], s79 offen offset:0 sc1 lds
    v_mfma_f32_16x16x32_bf16 v[60:63], v[40:43], a[12:15], v[60:63]
    ds_read_b128 v[28:31], v16 offset:12288
    v_mfma_f32_16x16x32_bf16 v[144:147], v[40:43], a[140:143], v[144:147]
    s_waitcnt lgkmcnt(2)
    v_mfma_f32_16x16x32_bf16 v[60:63], v[44:47], a[44:47], v[60:63]
    ds_read_b128 v[32:35], v16 offset:20480
    v_mfma_f32_16x16x32_bf16 v[144:147], v[44:47], a[172:175], v[144:147]
    buffer_load_dwordx4 v7, s[48:51], s79 offen offset:1024 sc1 lds
    v_mfma_f32_16x16x32_bf16 v[60:63], v[48:51], a[76:79], v[60:63]
    ds_read_b128 v[36:39], v16 offset:28672
    v_mfma_f32_16x16x32_bf16 v[144:147], v[48:51], a[204:207], v[144:147]
    v_mfma_f32_16x16x32_bf16 v[60:63], v[52:55], a[108:111], v[60:63]
    ds_read_b128 v[40:43], v16 offset:5120
    v_mfma_f32_16x16x32_bf16 v[144:147], v[52:55], a[236:239], v[144:147]
    s_waitcnt lgkmcnt(2)
    v_mfma_f32_16x16x32_bf16 v[60:63], v[24:27], a[16:19], v[60:63]
    ds_read_b128 v[44:47], v16 offset:13312
    v_mfma_f32_16x16x32_bf16 v[144:147], v[24:27], a[144:147], v[144:147]
    s_add_u32 m0, s91, 0
    s_nop 0
    buffer_load_dwordx4 v19, s[32:35], s63 offen offset:3072 lds
    v_mfma_f32_16x16x32_bf16 v[60:63], v[28:31], a[48:51], v[60:63]
    ds_read_b128 v[48:51], v16 offset:21504
    v_mfma_f32_16x16x32_bf16 v[144:147], v[28:31], a[176:179], v[144:147]
    s_add_u32 m0, s67, 0
    v_mfma_f32_16x16x32_bf16 v[60:63], v[32:35], a[80:83], v[60:63]
    ds_read_b128 v[52:55], v16 offset:29696
    v_mfma_f32_16x16x32_bf16 v[144:147], v[32:35], a[208:211], v[144:147]
    buffer_load_dwordx4 v7, s[48:51], s79 offen offset:2048 sc1 lds
    s_waitcnt lgkmcnt(2)
    v_mfma_f32_16x16x32_bf16 v[60:63], v[36:39], a[112:115], v[60:63]
    ds_read_b128 v[24:27], v16 offset:6144
    v_mfma_f32_16x16x32_bf16 v[144:147], v[36:39], a[240:243], v[144:147]
    v_mfma_f32_16x16x32_bf16 v[60:63], v[40:43], a[20:23], v[60:63]
    ds_read_b128 v[28:31], v16 offset:14336
    v_mfma_f32_16x16x32_bf16 v[144:147], v[40:43], a[148:151], v[144:147]
    buffer_load_dwordx4 v7, s[48:51], s79 offen offset:3072 sc1 lds
    v_mfma_f32_16x16x32_bf16 v[60:63], v[44:47], a[52:55], v[60:63]
    ds_read_b128 v[32:35], v16 offset:22528
    v_mfma_f32_16x16x32_bf16 v[144:147], v[44:47], a[180:183], v[144:147]
    s_waitcnt lgkmcnt(2)
    v_mfma_f32_16x16x32_bf16 v[60:63], v[48:51], a[84:87], v[60:63]
    ds_read_b128 v[36:39], v16 offset:30720
    v_mfma_f32_16x16x32_bf16 v[144:147], v[48:51], a[212:215], v[144:147]
    v_mfma_f32_16x16x32_bf16 v[60:63], v[52:55], a[116:119], v[60:63]
    ds_read_b128 v[40:43], v16 offset:7168
    v_mfma_f32_16x16x32_bf16 v[144:147], v[52:55], a[244:247], v[144:147]
    v_mfma_f32_16x16x32_bf16 v[60:63], v[24:27], a[24:27], v[60:63]
    ds_read_b128 v[44:47], v16 offset:15360
    v_mfma_f32_16x16x32_bf16 v[144:147], v[24:27], a[152:155], v[144:147]
    s_add_u32 m0, s67, 4096
    s_add_u32 s79, s73, 200704
    s_waitcnt lgkmcnt(2)
    v_mfma_f32_16x16x32_bf16 v[60:63], v[28:31], a[56:59], v[60:63]
    ds_read_b128 v[48:51], v16 offset:23552
    v_mfma_f32_16x16x32_bf16 v[144:147], v[28:31], a[184:187], v[144:147]
    buffer_load_dwordx4 v7, s[48:51], s79 offen offset:0 sc1 lds
    v_mfma_f32_16x16x32_bf16 v[60:63], v[32:35], a[88:91], v[60:63]
    ds_read_b128 v[52:55], v16 offset:31744
    v_mfma_f32_16x16x32_bf16 v[144:147], v[32:35], a[216:219], v[144:147]
    s_add_u32 m0, s91, 16384
    s_add_u32 s63, s90, 114688
    v_mfma_f32_16x16x32_bf16 v[60:63], v[36:39], a[120:123], v[60:63]
    s_waitcnt vmcnt(7)
    s_barrier
    ds_read_b128 v[24:27], v16 offset:32768
    v_mfma_f32_16x16x32_bf16 v[144:147], v[36:39], a[248:251], v[144:147]
    buffer_load_dwordx4 v14, s[32:35], s63 offen offset:0 lds
    s_waitcnt lgkmcnt(1)
    v_mfma_f32_16x16x32_bf16 v[60:63], v[40:43], a[28:31], v[60:63]
    ds_read_b128 v[28:31], v16 offset:40960
    v_mfma_f32_16x16x32_bf16 v[144:147], v[40:43], a[156:159], v[144:147]
    s_add_u32 m0, s67, 4096
    s_nop 0
    buffer_load_dwordx4 v7, s[48:51], s79 offen offset:1024 sc1 lds
    v_mfma_f32_16x16x32_bf16 v[60:63], v[44:47], a[60:63], v[60:63]
    ds_read_b128 v[32:35], v16 offset:49152
    v_mfma_f32_16x16x32_bf16 v[144:147], v[44:47], a[188:191], v[144:147]
    v_mfma_f32_16x16x32_bf16 v[60:63], v[48:51], a[92:95], v[60:63]
    ds_read_b128 v[36:39], v16 offset:57344
    v_mfma_f32_16x16x32_bf16 v[144:147], v[48:51], a[220:223], v[144:147]
    v_mfma_f32_16x16x32_bf16 v[60:63], v[52:55], a[124:127], v[60:63]
    ds_read_b128 v[40:43], v16 offset:33792
    v_mfma_f32_16x16x32_bf16 v[144:147], v[52:55], a[252:255], v[144:147]
    buffer_load_dwordx4 v7, s[48:51], s79 offen offset:2048 sc1 lds
    s_waitcnt lgkmcnt(2)
    v_mfma_f32_16x16x32_bf16 v[56:59], v[24:27], a[0:3], 0
    ds_read_b128 v[44:47], v16 offset:41984
    v_mfma_f32_16x16x32_bf16 v[148:151], v[24:27], a[128:131], v[64:67]
    v_mfma_f32_16x16x32_bf16 v[56:59], v[28:31], a[32:35], v[56:59]
    ds_read_b128 v[48:51], v16 offset:50176
    v_mfma_f32_16x16x32_bf16 v[148:151], v[28:31], a[160:163], v[148:151]
    s_add_u32 m0, s91, 16384
    s_nop 0
    buffer_load_dwordx4 v15, s[32:35], s63 offen offset:1024 lds
    v_mfma_f32_16x16x32_bf16 v[56:59], v[32:35], a[64:67], v[56:59]
    ds_read_b128 v[52:55], v16 offset:58368
    v_mfma_f32_16x16x32_bf16 v[148:151], v[32:35], a[192:195], v[148:151]
    s_add_u32 m0, s67, 4096
    s_waitcnt lgkmcnt(2)
    v_mfma_f32_16x16x32_bf16 v[56:59], v[36:39], a[96:99], v[56:59]
    ds_read_b128 v[24:27], v16 offset:34816
    v_mfma_f32_16x16x32_bf16 v[148:151], v[36:39], a[224:227], v[148:151]
    buffer_load_dwordx4 v7, s[48:51], s79 offen offset:3072 sc1 lds
    v_mfma_f32_16x16x32_bf16 v[56:59], v[40:43], a[4:7], v[56:59]
    ds_read_b128 v[28:31], v16 offset:43008
    v_mfma_f32_16x16x32_bf16 v[148:151], v[40:43], a[132:135], v[148:151]
    v_cvt_pk_bf16_f32 v78, v60, v61
    v_cvt_pk_bf16_f32 v80, v62, v63
    v_mfma_f32_16x16x32_bf16 v[56:59], v[44:47], a[36:39], v[56:59]
    ds_read_b128 v[32:35], v16 offset:51200
    v_mfma_f32_16x16x32_bf16 v[148:151], v[44:47], a[164:167], v[148:151]
    buffer_store_dwordx4 v[76:79], v7, s[48:51], s80 offen offset:0 sc1
    s_waitcnt lgkmcnt(2)
    v_mfma_f32_16x16x32_bf16 v[56:59], v[48:51], a[68:71], v[56:59]
    ds_read_b128 v[36:39], v16 offset:59392
    v_mfma_f32_16x16x32_bf16 v[148:151], v[48:51], a[196:199], v[148:151]
    v_mfma_f32_16x16x32_bf16 v[56:59], v[52:55], a[100:103], v[56:59]
    ds_read_b128 v[40:43], v16 offset:35840
    v_mfma_f32_16x16x32_bf16 v[148:151], v[52:55], a[228:231], v[148:151]
    s_add_u32 m0, s67, -65536
    s_add_u32 s79, s73, 262144
    v_mfma_f32_16x16x32_bf16 v[56:59], v[24:27], a[8:11], v[56:59]
    ds_read_b128 v[44:47], v16 offset:44032
    v_mfma_f32_16x16x32_bf16 v[148:151], v[24:27], a[136:139], v[148:151]
    buffer_load_dwordx4 v7, s[48:51], s79 offen offset:0 sc1 lds
    s_waitcnt lgkmcnt(2)
    v_mfma_f32_16x16x32_bf16 v[56:59], v[28:31], a[40:43], v[56:59]
    ds_read_b128 v[48:51], v16 offset:52224
    v_mfma_f32_16x16x32_bf16 v[148:151], v[28:31], a[168:171], v[148:151]
    buffer_load_dwordx4 v7, s[48:51], s79 offen offset:1024 sc1 lds
    v_mfma_f32_16x16x32_bf16 v[56:59], v[32:35], a[72:75], v[56:59]
    ds_read_b128 v[52:55], v16 offset:60416
    v_mfma_f32_16x16x32_bf16 v[148:151], v[32:35], a[200:203], v[148:151]
    s_add_u32 m0, s91, 16384
    s_nop 0
    buffer_load_dwordx4 v18, s[32:35], s63 offen offset:2048 lds
    v_mfma_f32_16x16x32_bf16 v[56:59], v[36:39], a[104:107], v[56:59]
    ds_read_b128 v[24:27], v16 offset:36864
    v_mfma_f32_16x16x32_bf16 v[148:151], v[36:39], a[232:235], v[148:151]
    s_waitcnt lgkmcnt(2)
    v_mfma_f32_16x16x32_bf16 v[56:59], v[40:43], a[12:15], v[56:59]
    ds_read_b128 v[28:31], v16 offset:45056
    v_mfma_f32_16x16x32_bf16 v[148:151], v[40:43], a[140:143], v[148:151]
    buffer_load_dword v13, v12, s[48:51], s92 offen sc1
    v_mfma_f32_16x16x32_bf16 v[56:59], v[44:47], a[44:47], v[56:59]
    ds_read_b128 v[32:35], v16 offset:53248
    v_mfma_f32_16x16x32_bf16 v[148:151], v[44:47], a[172:175], v[148:151]
    s_add_u32 m0, s67, -65536
    s_nop 0
    buffer_load_dwordx4 v7, s[48:51], s79 offen offset:2048 sc1 lds
    v_mfma_f32_16x16x32_bf16 v[56:59], v[48:51], a[76:79], v[56:59]
    ds_read_b128 v[36:39], v16 offset:61440
    v_mfma_f32_16x16x32_bf16 v[148:151], v[48:51], a[204:207], v[148:151]
    s_waitcnt lgkmcnt(2)
    v_mfma_f32_16x16x32_bf16 v[56:59], v[52:55], a[108:111], v[56:59]
    ds_read_b128 v[40:43], v16 offset:37888
    v_mfma_f32_16x16x32_bf16 v[148:151], v[52:55], a[236:239], v[148:151]
    v_mfma_f32_16x16x32_bf16 v[56:59], v[24:27], a[16:19], v[56:59]
    ds_read_b128 v[44:47], v16 offset:46080
    v_mfma_f32_16x16x32_bf16 v[148:151], v[24:27], a[144:147], v[148:151]
    buffer_load_dwordx4 v7, s[48:51], s79 offen offset:3072 sc1 lds
    v_mfma_f32_16x16x32_bf16 v[56:59], v[28:31], a[48:51], v[56:59]
    ds_read_b128 v[48:51], v16 offset:54272
    v_mfma_f32_16x16x32_bf16 v[148:151], v[28:31], a[176:179], v[148:151]
    s_add_u32 m0, s91, 16384
    s_nop 0
    buffer_load_dwordx4 v19, s[32:35], s63 offen offset:3072 lds
    s_waitcnt lgkmcnt(2)
    v_mfma_f32_16x16x32_bf16 v[56:59], v[32:35], a[80:83], v[56:59]
    ds_read_b128 v[52:55], v16 offset:62464
    v_mfma_f32_16x16x32_bf16 v[148:151], v[32:35], a[208:211], v[148:151]
    v_mfma_f32_16x16x32_bf16 v[56:59], v[36:39], a[112:115], v[56:59]
    ds_read_b128 v[24:27], v16 offset:38912
    v_mfma_f32_16x16x32_bf16 v[148:151], v[36:39], a[240:243], v[148:151]
    v_mfma_f32_16x16x32_bf16 v[56:59], v[40:43], a[20:23], v[56:59]
    ds_read_b128 v[28:31], v16 offset:47104
    v_mfma_f32_16x16x32_bf16 v[148:151], v[40:43], a[148:151], v[148:151]
    s_add_u32 m0, s67, -61440
    s_add_u32 s79, s73, 266240
    s_waitcnt lgkmcnt(2)
    v_mfma_f32_16x16x32_bf16 v[56:59], v[44:47], a[52:55], v[56:59]
    ds_read_b128 v[32:35], v16 offset:55296
    v_mfma_f32_16x16x32_bf16 v[148:151], v[44:47], a[180:183], v[148:151]
    buffer_load_dwordx4 v7, s[48:51], s79 offen offset:0 sc1 lds
    v_mfma_f32_16x16x32_bf16 v[56:59], v[48:51], a[84:87], v[56:59]
    ds_read_b128 v[36:39], v16 offset:63488
    v_mfma_f32_16x16x32_bf16 v[148:151], v[48:51], a[212:215], v[148:151]
    v_mfma_f32_16x16x32_bf16 v[56:59], v[52:55], a[116:119], v[56:59]
    ds_read_b128 v[40:43], v16 offset:39936
    v_mfma_f32_16x16x32_bf16 v[148:151], v[52:55], a[244:247], v[148:151]
    buffer_load_dwordx4 v7, s[48:51], s79 offen offset:1024 sc1 lds
    s_waitcnt lgkmcnt(2)
    v_mfma_f32_16x16x32_bf16 v[56:59], v[24:27], a[24:27], v[56:59]
    ds_read_b128 v[44:47], v16 offset:48128
    v_mfma_f32_16x16x32_bf16 v[148:151], v[24:27], a[152:155], v[148:151]
    v_mfma_f32_16x16x32_bf16 v[56:59], v[28:31], a[56:59], v[56:59]
    ds_read_b128 v[48:51], v16 offset:56320
    v_mfma_f32_16x16x32_bf16 v[148:151], v[28:31], a[184:187], v[148:151]
    v_mfma_f32_16x16x32_bf16 v[56:59], v[32:35], a[88:91], v[56:59]
    ds_read_b128 v[52:55], v16 offset:64512
    v_mfma_f32_16x16x32_bf16 v[148:151], v[32:35], a[216:219], v[148:151]
    s_add_u32 m0, s91, 32768
    s_add_u32 s63, s90, 229376
    s_waitcnt lgkmcnt(2)
    v_mfma_f32_16x16x32_bf16 v[56:59], v[36:39], a[120:123], v[56:59]
    s_waitcnt vmcnt(10)
    s_barrier
    ds_read_b128 v[24:27], v17 offset:0
    v_mfma_f32_16x16x32_bf16 v[148:151], v[36:39], a[248:251], v[148:151]
    buffer_load_dwordx4 v14, s[32:35], s63 offen offset:0 lds
    v_mfma_f32_16x16x32_bf16 v[56:59], v[40:43], a[28:31], v[56:59]
    ds_read_b128 v[28:31], v17 offset:8192
    v_mfma_f32_16x16x32_bf16 v[148:151], v[40:43], a[156:159], v[148:151]
    s_add_u32 m0, s67, -61440
    s_nop 0
    buffer_load_dwordx4 v7, s[48:51], s79 offen offset:2048 sc1 lds
    v_mfma_f32_16x16x32_bf16 v[56:59], v[44:47], a[60:63], v[56:59]
    ds_read_b128 v[32:35], v17 offset:16384
    v_mfma_f32_16x16x32_bf16 v[148:151], v[44:47], a[188:191], v[148:151]
    s_waitcnt lgkmcnt(2)
    v_mfma_f32_16x16x32_bf16 v[56:59], v[48:51], a[92:95], v[56:59]
    ds_read_b128 v[36:39], v17 offset:24576
    v_mfma_f32_16x16x32_bf16 v[148:151], v[48:51], a[220:223], v[148:151]
    buffer_load_dwordx4 v7, s[48:51], s79 offen offset:3072 sc1 lds
    v_mfma_f32_16x16x32_bf16 v[56:59], v[52:55], a[124:127], v[56:59]
    ds_read_b128 v[40:43], v17 offset:1024
    v_mfma_f32_16x16x32_bf16 v[148:151], v[52:55], a[252:255], v[148:151]
    v_mfma_f32_16x16x32_bf16 v[60:63], v[24:27], a[0:3], 0
    ds_read_b128 v[44:47], v17 offset:9216
    v_mfma_f32_16x16x32_bf16 v[152:155], v[24:27], a[128:131], v[64:67]
    s_waitcnt lgkmcnt(2)
    v_mfma_f32_16x16x32_bf16 v[60:63], v[28:31], a[32:35], v[60:63]
    ds_read_b128 v[48:51], v17 offset:17408
    v_mfma_f32_16x16x32_bf16 v[152:155], v[28:31], a[160:163], v[152:155]
    v_mfma_f32_16x16x32_bf16 v[60:63], v[32:35], a[64:67], v[60:63]
    ds_read_b128 v[52:55], v17 offset:25600
    v_mfma_f32_16x16x32_bf16 v[152:155], v[32:35], a[192:195], v[152:155]
    s_add_u32 m0, s67, -32768
    s_add_u32 s79, s73, 327680
    v_mfma_f32_16x16x32_bf16 v[60:63], v[36:39], a[96:99], v[60:63]
    ds_read_b128 v[24:27], v17 offset:2048
    v_mfma_f32_16x16x32_bf16 v[152:155], v[36:39], a[224:227], v[152:155]
    buffer_load_dwordx4 v7, s[48:51], s79 offen offset:0 sc1 lds
    s_waitcnt lgkmcnt(2)
    v_mfma_f32_16x16x32_bf16 v[60:63], v[40:43], a[4:7], v[60:63]
    ds_read_b128 v[28:31], v17 offset:10240
    v_mfma_f32_16x16x32_bf16 v[152:155], v[40:43], a[132:135], v[152:155]
    v_cvt_pk_bf16_f32 v81, v56, v57
    v_cvt_pk_bf16_f32 v82, v58, v59
    v_mfma_f32_16x16x32_bf16 v[60:63], v[44:47], a[36:39], v[60:63]
    ds_read_b128 v[32:35], v17 offset:18432
    v_mfma_f32_16x16x32_bf16 v[152:155], v[44:47], a[164:167], v[152:155]
    buffer_store_dwordx4 v[80:83], v7, s[48:51], s80 offen offset:1024 sc1
    v_mfma_f32_16x16x32_bf16 v[60:63], v[48:51], a[68:71], v[60:63]
    ds_read_b128 v[36:39], v17 offset:26624
    v_mfma_f32_16x16x32_bf16 v[152:155], v[48:51], a[196:199], v[152:155]
    s_waitcnt lgkmcnt(2)
    v_mfma_f32_16x16x32_bf16 v[60:63], v[52:55], a[100:103], v[60:63]
    ds_read_b128 v[40:43], v17 offset:3072
    v_mfma_f32_16x16x32_bf16 v[152:155], v[52:55], a[228:231], v[152:155]
    s_add_u32 m0, s91, 32768
    s_nop 0
    buffer_load_dwordx4 v15, s[32:35], s63 offen offset:1024 lds
    v_mfma_f32_16x16x32_bf16 v[60:63], v[24:27], a[8:11], v[60:63]
    ds_read_b128 v[44:47], v17 offset:11264
    v_mfma_f32_16x16x32_bf16 v[152:155], v[24:27], a[136:139], v[152:155]
    s_add_u32 m0, s67, -32768
    v_mfma_f32_16x16x32_bf16 v[60:63], v[28:31], a[40:43], v[60:63]
    ds_read_b128 v[48:51], v17 offset:19456
    v_mfma_f32_16x16x32_bf16 v[152:155], v[28:31], a[168:171], v[152:155]
    buffer_load_dwordx4 v7, s[48:51], s79 offen offset:1024 sc1 lds
    s_waitcnt lgkmcnt(2)
    v_mfma_f32_16x16x32_bf16 v[60:63], v[32:35], a[72:75], v[60:63]
    ds_read_b128 v[52:55], v17 offset:27648
    v_mfma_f32_16x16x32_bf16 v[152:155], v[32:35], a[200:203], v[152:155]
    buffer_load_dwordx4 v7, s[48:51], s79 offen offset:2048 sc1 lds
    v_mfma_f32_16x16x32_bf16 v[60:63], v[36:39], a[104:107], v[60:63]
    ds_read_b128 v[24:27], v17 offset:4096
    v_mfma_f32_16x16x32_bf16 v[152:155], v[36:39], a[232:235], v[152:155]
    s_add_u32 m0, s91, 32768
    s_nop 0
    buffer_load_dwordx4 v18, s[32:35], s63 offen offset:2048 lds
    v_mfma_f32_16x16x32_bf16 v[60:63], v[40:43], a[12:15], v[60:63]
    ds_read_b128 v[28:31], v17 offset:12288
    v_mfma_f32_16x16x32_bf16 v[152:155], v[40:43], a[140:143], v[152:155]
    s_add_u32 s60, s77, s75
    s_waitcnt lgkmcnt(2)
    v_mfma_f32_16x16x32_bf16 v[60:63], v[44:47], a[44:47], v[60:63]
    ds_read_b128 v[32:35], v17 offset:20480
    v_mfma_f32_16x16x32_bf16 v[152:155], v[44:47], a[172:175], v[152:155]
    s_add_u32 s61, s77, s76
    s_waitcnt vmcnt(14)
    v_cmp_ne_u32 vcc, s59, v13
    s_cbranch_vccnz L_PZ
L_PZD:
    v_mfma_f32_16x16x32_bf16 v[60:63], v[48:51], a[76:79], v[60:63]
    ds_read_b128 v[36:39], v17 offset:28672
    v_mfma_f32_16x16x32_bf16 v[152:155], v[48:51], a[204:207], v[152:155]
    v_mfma_f32_16x16x32_bf16 v[60:63], v[52:55], a[108:111], v[60:63]
    ds_read_b128 v[40:43], v17 offset:5120
    v_mfma_f32_16x16x32_bf16 v[152:155], v[52:55], a[236:239], v[152:155]
    buffer_load_dwordx4 v[112:115], v7, s[48:51], s60 offen offset:0 sc1
    s_waitcnt lgkmcnt(2)
    v_mfma_f32_16x16x32_bf16 v[60:63], v[24:27], a[16:19], v[60:63]
    ds_read_b128 v[44:47], v17 offset:13312
    v_mfma_f32_16x16x32_bf16 v[152:155], v[24:27], a[144:147], v[152:155]
    buffer_load_dwordx4 v[116:119], v7, s[48:51], s60 offen offset:1024 sc1
    v_mfma_f32_16x16x32_bf16 v[60:63], v[28:31], a[48:51], v[60:63]
    ds_read_b128 v[48:51], v17 offset:21504
    v_mfma_f32_16x16x32_bf16 v[152:155], v[28:31], a[176:179], v[152:155]
    buffer_load_dwordx4 v[120:123], v7, s[48:51], s60 offen offset:2048 sc1
    v_mfma_f32_16x16x32_bf16 v[60:63], v[32:35], a[80:83], v[60:63]
    ds_read_b128 v[52:55], v17 offset:29696
    v_mfma_f32_16x16x32_bf16 v[152:155], v[32:35], a[208:211], v[152:155]
    buffer_load_dwordx2 v[124:125], v7, s[48:51], s61 offen sc1
    s_waitcnt lgkmcnt(2)
    v_mfma_f32_16x16x32_bf16 v[60:63], v[36:39], a[112:115], v[60:63]
    ds_read_b128 v[24:27], v17 offset:6144
    v_mfma_f32_16x16x32_bf16 v[152:155], v[36:39], a[240:243], v[152:155]
    s_add_u32 s75, s75, s78
    v_mfma_f32_16x16x32_bf16 v[60:63], v[40:43], a[20:23], v[60:63]
    ds_read_b128 v[28:31], v17 offset:14336
    v_mfma_f32_16x16x32_bf16 v[152:155], v[40:43], a[148:151], v[152:155]
    s_add_u32 s76, s76, s78
    s_add_u32 m0, s67, -32768
    v_mfma_f32_16x16x32_bf16 v[60:63], v[44:47], a[52:55], v[60:63]
    ds_read_b128 v[32:35], v17 offset:22528
    v_mfma_f32_16x16x32_bf16 v[152:155], v[44:47], a[180:183], v[152:155]
    buffer_load_dwordx4 v7, s[48:51], s79 offen offset:3072 sc1 lds
    s_waitcnt lgkmcnt(2)
    v_mfma_f32_16x16x32_bf16 v[60:63], v[48:51], a[84:87], v[60:63]
    ds_read_b128 v[36:39], v17 offset:30720
    v_mfma_f32_16x16x32_bf16 v[152:155], v[48:51], a[212:215], v[152:155]
    s_add_u32 m0, s67, -28672
    s_add_u32 s79, s73, 331776
    v_mfma_f32_16x16x32_bf16 v[60:63], v[52:55], a[116:119], v[60:63]
    ds_read_b128 v[40:43], v17 offset:7168
    v_mfma_f32_16x16x32_bf16 v[152:155], v[52:55], a[244:247], v[152:155]
    buffer_load_dwordx4 v7, s[48:51], s79 offen offset:0 sc1 lds
    v_mfma_f32_16x16x32_bf16 v[60:63], v[24:27], a[24:27], v[60:63]
    ds_read_b128 v[44:47], v17 offset:15360
    v_mfma_f32_16x16x32_bf16 v[152:155], v[24:27], a[152:155], v[152:155]
    s_add_u32 m0, s91, 32768
    s_nop 0
    buffer_load_dwordx4 v19, s[32:35], s63 offen offset:3072 lds
    s_waitcnt lgkmcnt(2)
    v_mfma_f32_16x16x32_bf16 v[60:63], v[28:31], a[56:59], v[60:63]
    ds_read_b128 v[48:51], v17 offset:23552
    v_mfma_f32_16x16x32_bf16 v[152:155], v[28:31], a[184:187], v[152:155]
    s_add_u32 m0, s67, -28672
    v_mfma_f32_16x16x32_bf16 v[60:63], v[32:35], a[88:91], v[60:63]
    ds_read_b128 v[52:55], v17 offset:31744
    v_mfma_f32_16x16x32_bf16 v[152:155], v[32:35], a[216:219], v[152:155]
    buffer_load_dwordx4 v7, s[48:51], s79 offen offset:1024 sc1 lds
    v_mfma_f32_16x16x32_bf16 v[60:63], v[36:39], a[120:123], v[60:63]
    s_waitcnt vmcnt(14)
    s_barrier
    ds_read_b128 v[24:27], v16 offset:0
    v_mfma_f32_16x16x32_bf16 v[152:155], v[36:39], a[248:251], v[152:155]
    buffer_load_dwordx4 v7, s[48:51], s79 offen offset:2048 sc1 lds
    s_waitcnt lgkmcnt(1)
    v_mfma_f32_16x16x32_bf16 v[60:63], v[40:43], a[28:31], v[60:63]
    ds_read_b128 v[28:31], v16 offset:8192
    v_mfma_f32_16x16x32_bf16 v[152:155], v[40:43], a[156:159], v[152:155]
    buffer_load_dwordx4 v7, s[48:51], s79 offen offset:3072 sc1 lds
    v_mfma_f32_16x16x32_bf16 v[60:63], v[44:47], a[60:63], v[60:63]
    ds_read_b128 v[32:35], v16 offset:16384
    v_mfma_f32_16x16x32_bf16 v[152:155], v[44:47], a[188:191], v[152:155]
    s_add_u32 m0, s91, 49152
    s_add_u32 s63, s90, 344064
    v_mfma_f32_16x16x32_bf16 v[60:63], v[48:51], a[92:95], v[60:63]
    ds_read_b128 v[36:39], v16 offset:24576
    v_mfma_f32_16x16x32_bf16 v[152:155], v[48:51], a[220:223], v[152:155]
    buffer_load_dwordx4 v14, s[32:35], s63 offen offset:0 lds
    v_mfma_f32_16x16x32_bf16 v[60:63], v[52:55], a[124:127], v[60:63]
    ds_read_b128 v[40:43], v16 offset:1024
    v_mfma_f32_16x16x32_bf16 v[152:155], v[52:55], a[252:255], v[152:155]
    s_waitcnt lgkmcnt(2)
    v_mfma_f32_16x16x32_bf16 v[56:59], v[24:27], a[0:3], 0
    ds_read_b128 v[44:47], v16 offset:9216
    v_mfma_f32_16x16x32_bf16 v[156:159], v[24:27], a[128:131], v[64:67]
    v_mfma_f32_16x16x32_bf16 v[56:59], v[28:31], a[32:35], v[56:59]
    ds_read_b128 v[48:51], v16 offset:17408
    v_mfma_f32_16x16x32_bf16 v[156:159], v[28:31], a[160:163], v[156:159]
    s_add_u32 m0, s67, 0
    s_add_u32 s79, s74, 0
    v_mfma_f32_16x16x32_bf16 v[56:59], v[32:35], a[64:67], v[56:59]
    ds_read_b128 v[52:55], v16 offset:25600
    v_mfma_f32_16x16x32_bf16 v[156:159], v[32:35], a[192:195], v[156:159]
    buffer_load_dwordx4 v7, s[48:51], s79 offen offset:0 sc1 lds
    s_waitcnt lgkmcnt(2)
    v_mfma_f32_16x16x32_bf16 v[56:59], v[36:39], a[96:99], v[56:59]
    ds_read_b128 v[24:27], v16 offset:2048
    v_mfma_f32_16x16x32_bf16 v[156:159], v[36:39], a[224:227], v[156:159]
    buffer_load_dwordx4 v7, s[48:51], s79 offen offset:1024 sc1 lds
    v_mfma_f32_16x16x32_bf16 v[56:59], v[40:43], a[4:7], v[56:59]
    ds_read_b128 v[28:31], v16 offset:10240
    v_mfma_f32_16x16x32_bf16 v[156:159], v[40:43], a[132:135], v[156:159]
    v_cvt_pk_bf16_f32 v128, v60, v61
    v_cvt_pk_bf16_f32 v129, v62, v63
    v_mfma_f32_16x16x32_bf16 v[56:59], v[44:47], a[36:39], v[56:59]
    ds_read_b128 v[32:35], v16 offset:18432
    v_mfma_f32_16x16x32_bf16 v[156:159], v[44:47], a[164:167], v[156:159]
    s_add_u32 m0, s91, 49152
    s_nop 0
    buffer_load_dwordx4 v15, s[32:35], s63 offen offset:1024 lds
    s_waitcnt lgkmcnt(1)
    v_mfma_f32_16x16x32_bf16 v[56:59], v[48:51], a[68:71], v[56:59]
    ds_read_b128 v[36:39], v16 offset:26624
    v_mfma_f32_16x16x32_bf16 v[156:159], v[48:51], a[196:199], v[156:159]
    s_add_u32 m0, s67, 0
    v_mfma_f32_16x16x32_bf16 v[56:59], v[52:55], a[100:103], v[56:59]
    ds_read_b128 v[40:43], v16 offset:3072
    v_mfma_f32_16x16x32_bf16 v[156:159], v[52:55], a[228:231], v[156:159]
    buffer_load_dwordx4 v7, s[48:51], s79 offen offset:2048 sc1 lds
    v_mfma_f32_16x16x32_bf16 v[56:59], v[24:27], a[8:11], v[56:59]
    ds_read_b128 v[44:47], v16 offset:11264
    v_mfma_f32_16x16x32_bf16 v[156:159], v[24:27], a[136:139], v[156:159]
    buffer_load_dwordx4 v7, s[48:51], s79 offen offset:3072 sc1 lds
    v_mfma_f32_16x16x32_bf16 v[56:59], v[28:31], a[40:43], v[56:59]
    ds_read_b128 v[48:51], v16 offset:19456
    v_mfma_f32_16x16x32_bf16 v[156:159], v[28:31], a[168:171], v[156:159]
    s_waitcnt vmcnt(15)
    v_lshlrev_b32 v168, 16, v112
    v_and_b32 v169, s70, v112
    s_waitcnt lgkmcnt(1)
    v_mfma_f32_16x16x32_bf16 v[56:59], v[32:35], a[72:75], v[56:59]
    ds_read_b128 v[52:55], v16 offset:27648
    v_mfma_f32_16x16x32_bf16 v[156:159], v[32:35], a[200:203], v[156:159]
    v_lshlrev_b32 v170, 16, v113
    v_and_b32_e64 v171, s70, v113
    v_mfma_f32_16x16x32_bf16 v[56:59], v[36:39], a[104:107], v[56:59]
    ds_read_b128 v[24:27], v16 offset:4096
    v_mfma_f32_16x16x32_bf16 v[156:159], v[36:39], a[232:235], v[156:159]
    s_add_u32 m0, s91, 49152
    s_nop 0
    buffer_load_dwordx4 v18, s[32:35], s63 offen offset:2048 lds
    v_mfma_f32_16x16x32_bf16 v[56:59], v[40:43], a[12:15], v[56:59]
    ds_read_b128 v[28:31], v16 offset:12288
    v_mfma_f32_16x16x32_bf16 v[156:159], v[40:43], a[140:143], v[156:159]
    s_add_u32 m0, s67, 4096
    v_mfma_f32_16x16x32_bf16 v[56:59], v[44:47], a[44:47], v[56:59]
    ds_read_b128 v[32:35], v16 offset:20480
    v_mfma_f32_16x16x32_bf16 v[156:159], v[44:47], a[172:175], v[156:159]
    s_add_u32 s79, s74, 4096
    buffer_load_dwordx4 v7, s[48:51], s79 offen offset:0 sc1 lds
    s_waitcnt lgkmcnt(2)
    v_mfma_f32_16x16x32_bf16 v[56:59], v[48:51], a[76:79], v[56:59]
    ds_read_b128 v[36:39], v16 offset:28672
    v_mfma_f32_16x16x32_bf16 v[156:159], v[48:51], a[204:207], v[156:159]
    buffer_load_dwordx4 v[84:87], v7, s[48:51], s85 offen offset:0 sc1
    v_mfma_f32_16x16x32_bf16 v[56:59], v[52:55], a[108:111], v[56:59]
    ds_read_b128 v[40:43], v16 offset:5120
    v_mfma_f32_16x16x32_bf16 v[156:159], v[52:55], a[236:239], v[156:159]
    buffer_load_dwordx4 v[88:91], v7, s[48:51], s85 offen offset:1024 sc1
    v_mfma_f32_16x16x32_bf16 v[56:59], v[24:27], a[16:19], v[56:59]
    ds_read_b128 v[44:47], v16 offset:13312
    v_mfma_f32_16x16x32_bf16 v[156:159], v[24:27], a[144:147], v[156:159]
    buffer_load_dword v13, off, s[48:51], s93 sc1
    s_waitcnt lgkmcnt(2)
    v_mfma_f32_16x16x32_bf16 v[56:59], v[28:31], a[48:51], v[56:59]
    ds_read_b128 v[48:51], v16 offset:21504
    v_mfma_f32_16x16x32_bf16 v[156:159], v[28:31], a[176:179], v[156:159]
    buffer_load_dwordx4 v7, s[48:51], s79 offen offset:1024 sc1 lds
    v_mfma_f32_16x16x32_bf16 v[56:59], v[32:35], a[80:83], v[56:59]
    ds_read_b128 v[52:55], v16 offset:29696
    v_mfma_f32_16x16x32_bf16 v[156:159], v[32:35], a[208:211], v[156:159]
    v_lshlrev_b32 v172, 16, v114
    v_mfma_f32_16x16x32_bf16 v[56:59], v[36:39], a[112:115], v[56:59]
    ds_read_b128 v[24:27], v16 offset:6144
    v_mfma_f32_16x16x32_bf16 v[156:159], v[36:39], a[240:243], v[156:159]
    buffer_load_dwordx4 v7, s[48:51], s79 offen offset:2048 sc1 lds
    s_waitcnt lgkmcnt(2)
    v_mfma_f32_16x16x32_bf16 v[56:59], v[40:43], a[20:23], v[56:59]
    ds_read_b128 v[28:31], v16 offset:14336
    v_mfma_f32_16x16x32_bf16 v[156:159], v[40:43], a[148:151], v[156:159]
    s_add_u32 m0, s91, 49152
    s_nop 0
    buffer_load_dwordx4 v19, s[32:35], s63 offen offset:3072 lds
    v_mfma_f32_16x16x32_bf16 v[56:59], v[44:47], a[52:55], v[56:59]
    ds_read_b128 v[32:35], v16 offset:22528
    v_mfma_f32_16x16x32_bf16 v[156:159], v[44:47], a[180:183], v[156:159]
    v_and_b32_e64 v173, s70, v114
    v_mfma_f32_16x16x32_bf16 v[56:59], v[48:51], a[84:87], v[56:59]
    ds_read_b128 v[36:39], v16 offset:30720
    v_mfma_f32_16x16x32_bf16 v[156:159], v[48:51], a[212:215], v[156:159]
    s_add_u32 m0, s67, 4096
    s_nop 0
    buffer_load_dwordx4 v7, s[48:51], s79 offen offset:3072 sc1 lds
    s_waitcnt lgkmcnt(2)
    v_mfma_f32_16x16x32_bf16 v[56:59], v[52:55], a[116:119], v[56:59]
    ds_read_b128 v[40:43], v16 offset:7168
    v_mfma_f32_16x16x32_bf16 v[156:159], v[52:55], a[244:247], v[156:159]
    v_lshlrev_b32_e64 v174, 16, v115
    v_mfma_f32_16x16x32_bf16 v[56:59], v[24:27], a[24:27], v[56:59]
    ds_read_b128 v[44:47], v16 offset:15360
    v_mfma_f32_16x16x32_bf16 v[156:159], v[24:27], a[152:155], v[156:159]
    v_and_b32 v175, s70, v115
    s_waitcnt vmcnt(23)
    v_lshlrev_b32_e64 v176, 16, v116
    v_mfma_f32_16x16x32_bf16 v[56:59], v[28:31], a[56:59], v[56:59]
    ds_read_b128 v[48:51], v16 offset:23552
    v_mfma_f32_16x16x32_bf16 v[156:159], v[28:31], a[184:187], v[156:159]
    v_and_b32_e64 v177, s70, v116
    v_lshlrev_b32 v178, 16, v117
    s_waitcnt lgkmcnt(1)
    v_mfma_f32_16x16x32_bf16 v[56:59], v[32:35], a[88:91], v[56:59]
    ds_read_b128 v[52:55], v16 offset:31744
    v_mfma_f32_16x16x32_bf16 v[156:159], v[32:35], a[216:219], v[156:159]
    v_and_b32 v179, s70, v117
    v_lshlrev_b32 v180, 16, v118
    v_mfma_f32_16x16x32_bf16 v[56:59], v[36:39], a[120:123], v[56:59]
    s_waitcnt vmcnt(15)
    s_barrier
    ds_read_b128 v[24:27], v16 offset:32768
    v_mfma_f32_16x16x32_bf16 v[156:159], v[36:39], a[248:251], v[156:159]
    v_and_b32 v181, s70, v118
    v_lshlrev_b32 v182, 16, v119
    v_mfma_f32_16x16x32_bf16 v[56:59], v[40:43], a[28:31], v[56:59]
    ds_read_b128 v[28:31], v16 offset:40960
    v_mfma_f32_16x16x32_bf16 v[156:159], v[40:43], a[156:159], v[156:159]
    v_and_b32 v183, s70, v119
    v_lshlrev_b32 v184, 16, v120
    v_mfma_f32_16x16x32_bf16 v[56:59], v[44:47], a[60:63], v[56:59]
    ds_read_b128 v[32:35], v16 offset:49152
    v_mfma_f32_16x16x32_bf16 v[156:159], v[44:47], a[188:191], v[156:159]
    v_and_b32_e64 v185, s70, v120
    v_lshlrev_b32 v186, 16, v121
    s_waitcnt lgkmcnt(1)
    v_mfma_f32_16x16x32_bf16 v[56:59], v[48:51], a[92:95], v[56:59]
    ds_read_b128 v[36:39], v16 offset:57344
    v_mfma_f32_16x16x32_bf16 v[156:159], v[48:51], a[220:223], v[156:159]
    v_and_b32 v187, s70, v121
    v_lshlrev_b32 v188, 16, v122
    v_mfma_f32_16x16x32_bf16 v[56:59], v[52:55], a[124:127], v[56:59]
    ds_read_b128 v[40:43], v16 offset:33792
    v_mfma_f32_16x16x32_bf16 v[156:159], v[52:55], a[252:255], v[156:159]
    v_and_b32 v189, s70, v122
    v_lshlrev_b32 v190, 16, v123
    v_mfma_f32_16x16x32_bf16 v[60:63], v[24:27], a[0:3], 0
    ds_read_b128 v[44:47], v16 offset:41984
    v_mfma_f32_16x16x32_bf16 v[160:163], v[24:27], a[128:131], v[64:67]
    s_add_u32 m0, s91, 65536
    s_add_u32 s63, s90, 458752
    v_mfma_f32_16x16x32_bf16 v[60:63], v[28:31], a[32:35], v[60:63]
    ds_read_b128 v[48:51], v16 offset:50176
    v_mfma_f32_16x16x32_bf16 v[160:163], v[28:31], a[160:163], v[160:163]
    buffer_load_dwordx4 v14, s[32:35], s63 offen offset:0 lds
    s_waitcnt lgkmcnt(2)
    v_mfma_f32_16x16x32_bf16 v[60:63], v[32:35], a[64:67], v[60:63]
    ds_read_b128 v[52:55], v16 offset:58368
    v_mfma_f32_16x16x32_bf16 v[160:163], v[32:35], a[192:195], v[160:163]
    v_and_b32 v191, s70, v123
    v_lshlrev_b32_e64 v192, 16, v124
    v_mfma_f32_16x16x32_bf16 v[60:63], v[36:39], a[96:99], v[60:63]
    ds_read_b128 v[24:27], v16 offset:34816
    v_mfma_f32_16x16x32_bf16 v[160:163], v[36:39], a[224:227], v[160:163]
    buffer_load_dwordx4 v15, s[32:35], s63 offen offset:1024 lds
    v_mfma_f32_16x16x32_bf16 v[60:63], v[40:43], a[4:7], v[60:63]
    ds_read_b128 v[28:31], v16 offset:43008
    v_mfma_f32_16x16x32_bf16 v[160:163], v[40:43], a[132:135], v[160:163]
    v_cvt_pk_bf16_f32 v130, v56, v57
    v_cvt_pk_bf16_f32 v132, v58, v59
    s_waitcnt lgkmcnt(2)
    v_mfma_f32_16x16x32_bf16 v[60:63], v[44:47], a[36:39], v[60:63]
    ds_read_b128 v[32:35], v16 offset:51200
    v_mfma_f32_16x16x32_bf16 v[160:163], v[44:47], a[164:167], v[160:163]
    buffer_store_dwordx4 v[128:131], v7, s[48:51], s80 offen offset:2048 sc1
    v_mfma_f32_16x16x32_bf16 v[60:63], v[48:51], a[68:71], v[60:63]
    ds_read_b128 v[36:39], v16 offset:59392
    v_mfma_f32_16x16x32_bf16 v[160:163], v[48:51], a[196:199], v[160:163]
    v_mfma_f32_16x16x32_bf16 v[60:63], v[52:55], a[100:103], v[60:63]
    ds_read_b128 v[40:43], v16 offset:35840
    v_mfma_f32_16x16x32_bf16 v[160:163], v[52:55], a[228:231], v[160:163]
    buffer_load_dwordx4 v18, s[32:35], s63 offen offset:2048 lds
    s_waitcnt lgkmcnt(2)
    v_mfma_f32_16x16x32_bf16 v[60:63], v[24:27], a[8:11], v[60:63]
    ds_read_b128 v[44:47], v16 offset:44032
    v_mfma_f32_16x16x32_bf16 v[160:163], v[24:27], a[136:139], v[160:163]
    v_and_b32 v193, s70, v124
    v_lshlrev_b32 v194, 16, v125
    v_mfma_f32_16x16x32_bf16 v[60:63], v[28:31], a[40:43], v[60:63]
    ds_read_b128 v[48:51], v16 offset:52224
    v_mfma_f32_16x16x32_bf16 v[160:163], v[28:31], a[168:171], v[160:163]
    buffer_load_dwordx4 v19, s[32:35], s63 offen offset:3072 lds
    v_mfma_f32_16x16x32_bf16 v[60:63], v[32:35], a[72:75], v[60:63]
    ds_read_b128 v[52:55], v16 offset:60416
    v_mfma_f32_16x16x32_bf16 v[160:163], v[32:35], a[200:203], v[160:163]
    v_and_b32 v195, s70, v125
    s_waitcnt vmcnt(11)
    v_xor_b32 v87, s84, v87
    s_waitcnt lgkmcnt(1)
    v_mfma_f32_16x16x32_bf16 v[60:63], v[36:39], a[104:107], v[60:63]
    ds_read_b128 v[24:27], v16 offset:36864
    v_mfma_f32_16x16x32_bf16 v[160:163], v[36:39], a[232:235], v[160:163]
    s_waitcnt vmcnt(10)
    v_bitop3_b32 v87, v87, v91, s84 bitop3:0xf6
    v_cmp_ne_u32_e64 vcc, 0, v87
    s_cbranch_vccnz L_PM1
L_PM1D:
    v_mfma_f32_16x16x32_bf16 v[60:63], v[40:43], a[12:15], v[60:63]
    ds_read_b128 v[28:31], v16 offset:45056
    v_mfma_f32_16x16x32_bf16 v[160:163], v[40:43], a[140:143], v[160:163]
    v_mfma_f32_16x16x32_bf16 v[60:63], v[44:47], a[44:47], v[60:63]
    ds_read_b128 v[32:35], v16 offset:53248
    v_mfma_f32_16x16x32_bf16 v[160:163], v[44:47], a[172:175], v[160:163]
    s_add_u32 m0, s91, 81920
    v_mfma_f32_16x16x32_bf16 v[60:63], v[48:51], a[76:79], v[60:63]
    ds_read_b128 v[36:39], v16 offset:61440
    v_mfma_f32_16x16x32_bf16 v[160:163], v[48:51], a[204:207], v[160:163]
    s_add_u32 s63, s90, 573440
    buffer_load_dwordx4 v14, s[32:35], s63 offen offset:0 lds
    s_waitcnt lgkmcnt(2)
    v_mfma_f32_16x16x32_bf16 v[60:63], v[52:55], a[108:111], v[60:63]
    ds_read_b128 v[40:43], v16 offset:37888
    v_mfma_f32_16x16x32_bf16 v[160:163], v[52:55], a[236:239], v[160:163]
    buffer_load_dwordx4 v15, s[32:35], s63 offen offset:1024 lds
    v_mfma_f32_16x16x32_bf16 v[60:63], v[24:27], a[16:19], v[60:63]
    ds_read_b128 v[44:47], v16 offset:46080
    v_mfma_f32_16x16x32_bf16 v[160:163], v[24:27], a[144:147], v[160:163]
    v_lshlrev_b32 v72, 16, v84
    v_mfma_f32_16x16x32_bf16 v[60:63], v[28:31], a[48:51], v[60:63]
    ds_read_b128 v[48:51], v16 offset:54272
    v_mfma_f32_16x16x32_bf16 v[160:163], v[28:31], a[176:179], v[160:163]
    v_and_b32_e64 v73, s70, v84
    v_lshlrev_b32 v74, 16, v85
    s_waitcnt lgkmcnt(2)
    v_mfma_f32_16x16x32_bf16 v[60:63], v[32:35], a[80:83], v[60:63]
    ds_read_b128 v[52:55], v16 offset:62464
    v_mfma_f32_16x16x32_bf16 v[160:163], v[32:35], a[208:211], v[160:163]
    buffer_load_dwordx4 v18, s[32:35], s63 offen offset:2048 lds
    v_mfma_f32_16x16x32_bf16 v[60:63], v[36:39], a[112:115], v[60:63]
    ds_read_b128 v[24:27], v16 offset:38912
    v_mfma_f32_16x16x32_bf16 v[160:163], v[36:39], a[240:243], v[160:163]
    v_and_b32 v75, s70, v85
    v_add_f32 v140, v140, v72
    v_mfma_f32_16x16x32_bf16 v[60:63], v[40:43], a[20:23], v[60:63]
    ds_read_b128 v[28:31], v16 offset:47104
    v_mfma_f32_16x16x32_bf16 v[160:163], v[40:43], a[148:151], v[160:163]
    v_add_f32_e64 v141, v141, v73
    v_add_f32 v142, v142, v74
    s_waitcnt lgkmcnt(1)
    v_mfma_f32_16x16x32_bf16 v[60:63], v[44:47], a[52:55], v[60:63]
    ds_read_b128 v[32:35], v16 offset:55296
    v_mfma_f32_16x16x32_bf16 v[160:163], v[44:47], a[180:183], v[160:163]
    buffer_load_dwordx4 v19, s[32:35], s63 offen offset:3072 lds
    v_mfma_f32_16x16x32_bf16 v[60:63], v[48:51], a[84:87], v[60:63]
    ds_read_b128 v[36:39], v16 offset:63488
    v_mfma_f32_16x16x32_bf16 v[160:163], v[48:51], a[212:215], v[160:163]
    v_add_f32 v143, v143, v75
    v_mul_f32 v140, v140, v168
    v_mfma_f32_16x16x32_bf16 v[60:63], v[52:55], a[116:119], v[60:63]
    ds_read_b128 v[40:43], v16 offset:39936
    v_mfma_f32_16x16x32_bf16 v[160:163], v[52:55], a[244:247], v[160:163]
    v_mul_f32 v141, v141, v169
    v_mul_f32 v142, v142, v170
    v_mfma_f32_16x16x32_bf16 v[60:63], v[24:27], a[24:27], v[60:63]
    ds_read_b128 v[44:47], v16 offset:48128
    v_mfma_f32_16x16x32_bf16 v[160:163], v[24:27], a[152:155], v[160:163]
    v_mul_f32_e64 v143, v143, v171
    v_cvt_pk_bf16_f32 v112, v140, v141
    s_waitcnt lgkmcnt(1)
    v_mfma_f32_16x16x32_bf16 v[60:63], v[28:31], a[56:59], v[60:63]
    ds_read_b128 v[48:51], v16 offset:56320
    v_mfma_f32_16x16x32_bf16 v[160:163], v[28:31], a[184:187], v[160:163]
    v_cvt_pk_bf16_f32 v113, v142, v143
    v_lshlrev_b32 v72, 16, v86
    v_mfma_f32_16x16x32_bf16 v[60:63], v[32:35], a[88:91], v[60:63]
    ds_read_b128 v[52:55], v16 offset:64512
    v_mfma_f32_16x16x32_bf16 v[160:163], v[32:35], a[216:219], v[160:163]
    v_and_b32 v73, s70, v86
    v_lshlrev_b32 v74, 16, v88
    v_mfma_f32_16x16x32_bf16 v[60:63], v[36:39], a[120:123], v[60:63]
    s_waitcnt vmcnt(9)
    s_barrier
    ds_read_b128 v[24:27], v17 offset:0
    v_mfma_f32_16x16x32_bf16 v[160:163], v[36:39], a[248:251], v[160:163]
    v_and_b32 v75, s70, v88
    v_add_f32 v144, v144, v72
    v_mfma_f32_16x16x32_bf16 v[60:63], v[40:43], a[28:31], v[60:63]
    ds_read_b128 v[28:31], v17 offset:8192
    v_mfma_f32_16x16x32_bf16 v[160:163], v[40:43], a[156:159], v[160:163]
    v_add_f32_e64 v145, v145, v73
    v_add_f32 v146, v146, v74
    s_waitcnt lgkmcnt(1)
    v_mfma_f32_16x16x32_bf16 v[60:63], v[44:47], a[60:63], v[60:63]
    ds_read_b128 v[32:35], v17 offset:16384
    v_mfma_f32_16x16x32_bf16 v[160:163], v[44:47], a[188:191], v[160:163]
    v_add_f32 v147, v147, v75
    v_mul_f32 v144, v144, v172
    v_mfma_f32_16x16x32_bf16 v[60:63], v[48:51], a[92:95], v[60:63]
    ds_read_b128 v[36:39], v17 offset:24576
    v_mfma_f32_16x16x32_bf16 v[160:163], v[48:51], a[220:223], v[160:163]
    v_mul_f32 v145, v145, v173
    v_mul_f32 v146, v146, v174
    v_mfma_f32_16x16x32_bf16 v[60:63], v[52:55], a[124:127], v[60:63]
    ds_read_b128 v[40:43], v17 offset:1024
    v_mfma_f32_16x16x32_bf16 v[160:163], v[52:55], a[252:255], v[160:163]
    v_mul_f32_e64 v147, v147, v175
    v_cvt_pk_bf16_f32 v114, v144, v145
    v_mfma_f32_16x16x32_bf16 v[56:59], v[24:27], a[0:3], 0
    ds_read_b128 v[44:47], v17 offset:9216
    s_add_u32 m0, s91, 98304
    s_waitcnt lgkmcnt(1)
    v_mfma_f32_16x16x32_bf16 v[56:59], v[28:31], a[32:35], v[56:59]
    ds_read_b128 v[48:51], v17 offset:17408
    s_add_u32 s63, s90, 688128
    v_mfma_f32_16x16x32_bf16 v[56:59], v[32:35], a[64:67], v[56:59]
    ds_read_b128 v[52:55], v17 offset:25600
    buffer_load_dwordx4 v14, s[32:35], s63 offen offset:0 lds
    v_mfma_f32_16x16x32_bf16 v[56:59], v[36:39], a[96:99], v[56:59]
    ds_read_b128 a[0:3], v17 offset:2048
    v_mfma_f32_16x16x32_bf16 v[56:59], v[40:43], a[4:7], v[56:59]
    ds_read_b128 a[32:35], v17 offset:10240
    buffer_load_dwordx4 v15, s[32:35], s63 offen offset:1024 lds
    s_waitcnt lgkmcnt(2)
    v_mfma_f32_16x16x32_bf16 v[56:59], v[44:47], a[36:39], v[56:59]
    ds_read_b128 a[64:67], v17 offset:18432
    v_mfma_f32_16x16x32_bf16 v[56:59], v[48:51], a[68:71], v[56:59]
    ds_read_b128 a[96:99], v17 offset:26624
    v_cvt_pk_bf16_f32 v133, v60, v61
    v_mfma_f32_16x16x32_bf16 v[56:59], v[52:55], a[100:103], v[56:59]
    ds_read_b128 a[4:7], v17 offset:3072
    v_cvt_pk_bf16_f32 v134, v62, v63
    s_waitcnt lgkmcnt(2)
    v_mfma_f32_16x16x32_bf16 v[56:59], a[0:3], a[8:11], v[56:59]
    ds_read_b128 a[36:39], v17 offset:11264
    buffer_store_dwordx4 v[132:135], v7, s[48:51], s81 offen offset:0 sc1
    v_mfma_f32_16x16x32_bf16 v[56:59], a[32:35], a[40:43], v[56:59]
    ds_read_b128 a[68:71], v17 offset:19456
    v_mfma_f32_16x16x32_bf16 v[56:59], a[64:67], a[72:75], v[56:59]
    ds_read_b128 a[100:103], v17 offset:27648
    s_waitcnt lgkmcnt(3)
    v_mfma_f32_16x16x32_bf16 v[56:59], a[96:99], a[104:107], v[56:59]
    ds_read_b128 a[8:11], v17 offset:4096
    v_mfma_f32_16x16x32_bf16 v[56:59], a[4:7], a[12:15], v[56:59]
    ds_read_b128 a[40:43], v17 offset:12288
    buffer_load_dwordx4 v18, s[32:35], s63 offen offset:2048 lds
    s_waitcnt lgkmcnt(2)
    v_mfma_f32_16x16x32_bf16 v[56:59], a[36:39], a[44:47], v[56:59]
    ds_read_b128 a[72:75], v17 offset:20480
    v_mfma_f32_16x16x32_bf16 v[56:59], a[68:71], a[76:79], v[56:59]
    ds_read_b128 a[104:107], v17 offset:28672
    buffer_load_dwordx4 v[92:95], v7, s[48:51], s85 offen offset:2048 sc1
    v_mfma_f32_16x16x32_bf16 v[56:59], a[100:103], a[108:111], v[56:59]
    ds_read_b128 a[12:15], v17 offset:5120
    s_waitcnt lgkmcnt(3)
    v_mfma_f32_16x16x32_bf16 v[56:59], a[8:11], a[16:19], v[56:59]
    ds_read_b128 a[44:47], v17 offset:13312
    buffer_load_dwordx4 v19, s[32:35], s63 offen offset:3072 lds
    v_mfma_f32_16x16x32_bf16 v[56:59], a[40:43], a[48:51], v[56:59]
    ds_read_b128 a[76:79], v17 offset:21504
    s_waitcnt lgkmcnt(2)
    v_mfma_f32_16x16x32_bf16 v[56:59], a[72:75], a[80:83], v[56:59]
    ds_read_b128 a[108:111], v17 offset:29696
    v_cvt_pk_bf16_f32 v115, v146, v147
    v_mfma_f32_16x16x32_bf16 v[56:59], a[104:107], a[112:115], v[56:59]
    ds_read_b128 a[16:19], v17 offset:6144
    v_lshlrev_b32 v72, 16, v89
    v_mfma_f32_16x16x32_bf16 v[56:59], a[12:15], a[20:23], v[56:59]
    ds_read_b128 a[48:51], v17 offset:14336
    v_and_b32 v73, s70, v89
    s_waitcnt lgkmcnt(2)
    v_mfma_f32_16x16x32_bf16 v[56:59], a[44:47], a[52:55], v[56:59]
    ds_read_b128 a[80:83], v17 offset:22528
    v_lshlrev_b32_e64 v74, 16, v90
    v_mfma_f32_16x16x32_bf16 v[56:59], a[76:79], a[84:87], v[56:59]
    ds_read_b128 a[112:115], v17 offset:30720
    v_and_b32_e64 v75, s70, v90
    v_mfma_f32_16x16x32_bf16 v[56:59], a[108:111], a[116:119], v[56:59]
    ds_read_b128 a[20:23], v17 offset:7168
    v_add_f32 v148, v148, v72
    s_waitcnt lgkmcnt(2)
    v_mfma_f32_16x16x32_bf16 v[56:59], a[16:19], a[24:27], v[56:59]
    ds_read_b128 a[52:55], v17 offset:15360
    v_add_f32_e64 v149, v149, v73
    v_mfma_f32_16x16x32_bf16 v[56:59], a[48:51], a[56:59], v[56:59]
    ds_read_b128 a[84:87], v17 offset:23552
    v_add_f32_e64 v150, v150, v74
    v_mfma_f32_16x16x32_bf16 v[56:59], a[80:83], a[88:91], v[56:59]
    ds_read_b128 a[116:119], v17 offset:31744
    v_add_f32 v151, v151, v75
    s_waitcnt lgkmcnt(2)
    v_mfma_f32_16x16x32_bf16 v[56:59], a[112:115], a[120:123], v[56:59]
    v_mul_f32_e64 v148, v148, v176
    v_mfma_f32_16x16x32_bf16 v[56:59], a[20:23], a[28:31], v[56:59]
    v_mul_f32_e64 v149, v149, v177
    v_mfma_f32_16x16x32_bf16 v[56:59], a[52:55], a[60:63], v[56:59]
    v_mul_f32 v150, v150, v178
    s_waitcnt lgkmcnt(0)
    v_mfma_f32_16x16x32_bf16 v[56:59], a[84:87], a[92:95], v[56:59]
    v_mul_f32_e64 v151, v151, v179
    v_mfma_f32_16x16x32_bf16 v[56:59], a[116:119], a[124:127], v[56:59]
    v_cvt_pk_bf16_f32 v116, v148, v149
    v_mfma_f32_16x16x32_bf16 v[164:167], v[24:27], a[128:131], v[64:67]
    v_cvt_pk_bf16_f32 v117, v150, v151
    v_mfma_f32_16x16x32_bf16 v[164:167], v[28:31], a[160:163], v[164:167]
    v_mfma_f32_16x16x32_bf16 v[164:167], v[32:35], a[192:195], v[164:167]
    v_mfma_f32_16x16x32_bf16 v[164:167], v[36:39], a[224:227], v[164:167]
    s_nop 1
    v_cvt_pk_bf16_f32 v136, v56, v57
    v_cvt_pk_bf16_f32 v137, v58, v59
    v_mfma_f32_16x16x32_bf16 v[164:167], v[40:43], a[132:135], v[164:167]
    buffer_store_dwordx4 v[136:139], v7, s[48:51], s81 offen offset:1024 sc1
    v_mfma_f32_16x16x32_bf16 v[164:167], v[44:47], a[164:167], v[164:167]
    v_mfma_f32_16x16x32_bf16 v[164:167], v[48:51], a[196:199], v[164:167]
    v_mfma_f32_16x16x32_bf16 v[164:167], v[52:55], a[228:231], v[164:167]
    v_mfma_f32_16x16x32_bf16 v[164:167], a[0:3], a[136:139], v[164:167]
    v_mfma_f32_16x16x32_bf16 v[164:167], a[32:35], a[168:171], v[164:167]
    v_mfma_f32_16x16x32_bf16 v[164:167], a[64:67], a[200:203], v[164:167]
    v_mfma_f32_16x16x32_bf16 v[164:167], a[96:99], a[232:235], v[164:167]
    v_mfma_f32_16x16x32_bf16 v[164:167], a[4:7], a[140:143], v[164:167]
    v_mfma_f32_16x16x32_bf16 v[164:167], a[36:39], a[172:175], v[164:167]
    v_mfma_f32_16x16x32_bf16 v[164:167], a[68:71], a[204:207], v[164:167]
    s_waitcnt vmcnt(2)
    v_cmp_ne_u32 vcc, s84, v95
    s_cbranch_vccnz L_PM2
L_PM2D:
    v_mfma_f32_16x16x32_bf16 v[164:167], a[100:103], a[236:239], v[164:167]
    v_mfma_f32_16x16x32_bf16 v[164:167], a[8:11], a[144:147], v[164:167]
    buffer_load_dwordx4 v[96:99], v7, s[48:51], s82 offen sc1
    v_mfma_f32_16x16x32_bf16 v[164:167], a[40:43], a[176:179], v[164:167]
    v_lshlrev_b32 v72, 16, v92
    v_and_b32 v73, s70, v92
    v_mfma_f32_16x16x32_bf16 v[164:167], a[72:75], a[208:211], v[164:167]
    v_lshlrev_b32 v74, 16, v93
    v_and_b32 v75, s70, v93
    v_mfma_f32_16x16x32_bf16 v[164:167], a[104:107], a[240:243], v[164:167]
    v_add_f32 v152, v152, v72
    v_add_f32 v153, v153, v73
    v_mfma_f32_16x16x32_bf16 v[164:167], a[12:15], a[148:151], v[164:167]
    v_add_f32 v154, v154, v74
    v_add_f32 v155, v155, v75
    v_mfma_f32_16x16x32_bf16 v[164:167], a[44:47], a[180:183], v[164:167]
    v_mul_f32 v152, v152, v180
    v_mul_f32 v153, v153, v181
    v_mfma_f32_16x16x32_bf16 v[164:167], a[76:79], a[212:215], v[164:167]
    v_mul_f32 v154, v154, v182
    v_mul_f32 v155, v155, v183
    v_mfma_f32_16x16x32_bf16 v[164:167], a[108:111], a[244:247], v[164:167]
    v_cvt_pk_bf16_f32 v118, v152, v153
    v_cvt_pk_bf16_f32 v119, v154, v155
    v_mfma_f32_16x16x32_bf16 v[164:167], a[16:19], a[152:155], v[164:167]
    v_mfma_f32_16x16x32_bf16 v[164:167], a[48:51], a[184:187], v[164:167]
    v_mfma_f32_16x16x32_bf16 v[164:167], a[80:83], a[216:219], v[164:167]
    v_mfma_f32_16x16x32_bf16 v[164:167], a[112:115], a[248:251], v[164:167]
    v_mfma_f32_16x16x32_bf16 v[164:167], a[20:23], a[156:159], v[164:167]
    v_mfma_f32_16x16x32_bf16 v[164:167], a[52:55], a[188:191], v[164:167]
    v_mfma_f32_16x16x32_bf16 v[164:167], a[84:87], a[220:223], v[164:167]
    v_mfma_f32_16x16x32_bf16 v[164:167], a[116:119], a[252:255], v[164:167]
    s_lshl2_add_u32 s62, s58, s93
    s_cmp_eq_u32 s87, 0
    s_cbranch_scc1 WT_52
    buffer_store_dwordx4 v[112:115], v7, s[48:51], s75 offen offset:0
    buffer_store_dwordx4 v[116:119], v7, s[48:51], s75 offen offset:1024
WB_53:
    s_waitcnt vmcnt(2)
    v_cmp_ne_u32 vcc, s84, v99
    s_cbranch_vccnz L_PM4
L_PM4D:
    buffer_load_dwordx4 v[100:103], v7, s[48:51], s82 offen offset:1024 sc1
    v_lshlrev_b32 v72, 16, v94
    v_and_b32 v73, s70, v94
    v_lshlrev_b32 v74, 16, v96
    v_and_b32 v75, s70, v96
    v_pk_add_f32 v[156:157], v[156:157], v[72:73]
    v_pk_add_f32 v[158:159], v[158:159], v[74:75]
    v_pk_mul_f32 v[156:157], v[156:157], v[184:185]
    v_pk_mul_f32 v[158:159], v[158:159], v[186:187]
    v_cvt_pk_bf16_f32 v120, v156, v157
    v_cvt_pk_bf16_f32 v121, v158, v159
    v_lshlrev_b32 v72, 16, v97
    v_and_b32 v73, s70, v97
    v_lshlrev_b32 v74, 16, v98
    v_and_b32 v75, s70, v98
    v_pk_add_f32 v[160:161], v[160:161], v[72:73]
    v_pk_add_f32 v[162:163], v[162:163], v[74:75]
    v_pk_mul_f32 v[160:161], v[160:161], v[188:189]
    v_pk_mul_f32 v[162:163], v[162:163], v[190:191]
    v_cvt_pk_bf16_f32 v122, v160, v161
    v_cvt_pk_bf16_f32 v123, v162, v163
    s_cmp_eq_u32 s87, 0
    s_cbranch_scc1 WT_54
    buffer_store_dwordx4 v[120:123], v7, s[48:51], s75 offen offset:2048
WB_55:
    ds_read_b64_tr_b16 a[0:1], v8 offset:0
    ds_read_b64_tr_b16 a[2:3], v8 offset:2048
    ds_read_b64_tr_b16 a[4:5], v9 offset:0
    ds_read_b64_tr_b16 a[6:7], v9 offset:2048
    ds_read_b64_tr_b16 a[8:9], v10 offset:0
    ds_read_b64_tr_b16 a[10:11], v10 offset:2048
    ds_read_b64_tr_b16 a[12:13], v11 offset:0
    ds_read_b64_tr_b16 a[14:15], v11 offset:2048
    ds_read_b64_tr_b16 a[16:17], v8 offset:4096
    ds_read_b64_tr_b16 a[18:19], v8 offset:6144
    ds_read_b64_tr_b16 a[20:21], v9 offset:4096
    ds_read_b64_tr_b16 a[22:23], v9 offset:6144
    ds_read_b64_tr_b16 a[24:25], v10 offset:4096
    ds_read_b64_tr_b16 a[26:27], v10 offset:6144
    ds_read_b64_tr_b16 a[28:29], v11 offset:4096
    ds_read_b64_tr_b16 a[30:31], v11 offset:6144
    ds_read_b64_tr_b16 a[32:33], v8 offset:8192
    ds_read_b64_tr_b16 a[34:35], v8 offset:10240
    ds_read_b64_tr_b16 a[36:37], v9 offset:8192
    ds_read_b64_tr_b16 a[38:39], v9 offset:10240
    ds_read_b64_tr_b16 a[40:41], v10 offset:8192
    ds_read_b64_tr_b16 a[42:43], v10 offset:10240
    ds_read_b64_tr_b16 a[44:45], v11 offset:8192
    ds_read_b64_tr_b16 a[46:47], v11 offset:10240
    ds_read_b64_tr_b16 a[48:49], v8 offset:12288
    ds_read_b64_tr_b16 a[50:51], v8 offset:14336
    ds_read_b64_tr_b16 a[52:53], v9 offset:12288
    ds_read_b64_tr_b16 a[54:55], v9 offset:14336
    ds_read_b64_tr_b16 a[56:57], v10 offset:12288
    ds_read_b64_tr_b16 a[58:59], v10 offset:14336
    ds_read_b64_tr_b16 a[60:61], v11 offset:12288
    ds_read_b64_tr_b16 a[62:63], v11 offset:14336
    ds_read_b64_tr_b16 a[64:65], v8 offset:16384
    ds_read_b64_tr_b16 a[66:67], v8 offset:18432
    ds_read_b64_tr_b16 a[68:69], v9 offset:16384
    ds_read_b64_tr_b16 a[70:71], v9 offset:18432
    ds_read_b64_tr_b16 a[72:73], v10 offset:16384
    ds_read_b64_tr_b16 a[74:75], v10 offset:18432
    ds_read_b64_tr_b16 a[76:77], v11 offset:16384
    ds_read_b64_tr_b16 a[78:79], v11 offset:18432
    ds_read_b64_tr_b16 a[80:81], v8 offset:20480
    ds_read_b64_tr_b16 a[82:83], v8 offset:22528
    ds_read_b64_tr_b16 a[84:85], v9 offset:20480
    ds_read_b64_tr_b16 a[86:87], v9 offset:22528
    ds_read_b64_tr_b16 a[88:89], v10 offset:20480
    ds_read_b64_tr_b16 a[90:91], v10 offset:22528
    ds_read_b64_tr_b16 a[92:93], v11 offset:20480
    ds_read_b64_tr_b16 a[94:95], v11 offset:22528
    s_waitcnt vmcnt(1)
    v_cmp_ne_u32 vcc, s84, v103
    s_cbranch_vccz L_PM3D
    s_mov_b32 s66, 0
L_PM3L:
    s_add_u32 s66, s66, 1
    s_cmp_gt_u32 s66, 0x40000
    s_cbranch_scc1 L_PM3D
L_PM3F:
    buffer_load_dwordx4 v[100:103], v7, s[48:51], s82 offen offset:1024 sc1
    s_waitcnt vmcnt(0)
    v_cmp_ne_u32 vcc, s84, v103
    s_cbranch_vccnz L_PM3L
L_PM3D:
    v_lshlrev_b32 v72, 16, v100
    v_and_b32 v73, s70, v100
    v_lshlrev_b32 v74, 16, v101
    v_and_b32_e64 v75, s70, v101
    v_pk_add_f32 v[164:165], v[164:165], v[72:73]
    v_pk_add_f32 v[166:167], v[166:167], v[74:75]
    v_pk_mul_f32 v[164:165], v[164:165], v[192:193]
    v_pk_mul_f32 v[166:167], v[166:167], v[194:195]
    v_cvt_pk_bf16_f32 v124, v164, v165
    v_cvt_pk_bf16_f32 v125, v166, v167
    s_cmp_eq_u32 s87, 0
    s_cbranch_scc1 WT_56
    buffer_store_dwordx2 v[124:125], v7, s[48:51], s76 offen
WB_57:
    v_add_u32 v248, 57344, v8
    v_add_u32 v249, 57344, v9
    v_add_u32 v250, 57344, v10
    v_add_u32 v251, 57344, v11
    ds_read_b64_tr_b16 a[96:97], v8 offset:24576
    ds_read_b64_tr_b16 a[98:99], v8 offset:26624
    ds_read_b64_tr_b16 a[100:101], v9 offset:24576
    ds_read_b64_tr_b16 a[102:103], v9 offset:26624
    ds_read_b64_tr_b16 a[104:105], v10 offset:24576
    ds_read_b64_tr_b16 a[106:107], v10 offset:26624
    ds_read_b64_tr_b16 a[108:109], v11 offset:24576
    ds_read_b64_tr_b16 a[110:111], v11 offset:26624
    ds_read_b64_tr_b16 a[112:113], v8 offset:28672
    ds_read_b64_tr_b16 a[114:115], v8 offset:30720
    ds_read_b64_tr_b16 a[116:117], v9 offset:28672
    ds_read_b64_tr_b16 a[118:119], v9 offset:30720
    ds_read_b64_tr_b16 a[120:121], v10 offset:28672
    ds_read_b64_tr_b16 a[122:123], v10 offset:30720
    ds_read_b64_tr_b16 a[124:125], v11 offset:28672
    ds_read_b64_tr_b16 a[126:127], v11 offset:30720
    ds_read_b64_tr_b16 a[128:129], v8 offset:32768
    ds_read_b64_tr_b16 a[130:131], v8 offset:34816
    ds_read_b64_tr_b16 a[132:133], v9 offset:32768
    ds_read_b64_tr_b16 a[134:135], v9 offset:34816
    ds_read_b64_tr_b16 a[136:137], v10 offset:32768
    ds_read_b64_tr_b16 a[138:139], v10 offset:34816
    ds_read_b64_tr_b16 a[140:141], v11 offset:32768
    ds_read_b64_tr_b16 a[142:143], v11 offset:34816
    ds_read_b64_tr_b16 a[144:145], v8 offset:36864
    ds_read_b64_tr_b16 a[146:147], v8 offset:38912
    ds_read_b64_tr_b16 a[148:149], v9 offset:36864
    ds_read_b64_tr_b16 a[150:151], v9 offset:38912
    ds_read_b64_tr_b16 a[152:153], v10 offset:36864
    ds_read_b64_tr_b16 a[154:155], v10 offset:38912
    ds_read_b64_tr_b16 a[156:157], v11 offset:36864
    ds_read_b64_tr_b16 a[158:159], v11 offset:38912
    ds_read_b64_tr_b16 a[160:161], v8 offset:40960
    ds_read_b64_tr_b16 a[162:163], v8 offset:43008
    ds_read_b64_tr_b16 a[164:165], v9 offset:40960
    ds_read_b64_tr_b16 a[166:167], v9 offset:43008
    ds_read_b64_tr_b16 a[168:169], v10 offset:40960
    ds_read_b64_tr_b16 a[170:171], v10 offset:43008
    ds_read_b64_tr_b16 a[172:173], v11 offset:40960
    ds_read_b64_tr_b16 a[174:175], v11 offset:43008
    s_waitcnt vmcnt(0)
    s_waitcnt lgkmcnt(0)
    s_barrier
    s_cmp_eq_u32 s52, 0
    s_cbranch_scc0 SK_58
    v_mov_b32 v2, s59
    s_mov_b64 exec, 1
    s_cmp_eq_u32 s87, 0
    s_cbranch_scc1 WT_59
    buffer_store_dword v2, off, s[48:51], s62
WB_60:
    s_mov_b64 exec, -1
SK_58:
    s_cmp_lt_u32 s58, 7
    s_cbranch_scc0 SK_61
    v_and_b32 v3, 7, v0
    v_lshlrev_b32 v3, 2, v3
    s_lshl_b32 s61, s58, 7
    v_lshlrev_b32 v208, 16, v104
    v_and_b32 v209, s70, v104
    v_lshlrev_b32 v210, 16, v105
    v_and_b32 v211, s70, v105
    v_lshlrev_b32 v212, 16, v106
    v_and_b32 v213, s70, v106
    v_lshlrev_b32 v214, 16, v107
    v_and_b32 v215, s70, v107
    v_lshlrev_b32 v216, 16, v108
    v_and_b32 v217, s70, v108
    v_lshlrev_b32 v218, 16, v109
    v_and_b32 v219, s70, v109
    v_lshlrev_b32 v220, 16, v110
    v_and_b32 v221, s70, v110
    v_lshlrev_b32 v222, 16, v111
    v_and_b32_e64 v223, s70, v111
    ds_read_b64_tr_b16 a[176:177], v8 offset:45056
    ds_read_b64_tr_b16 a[178:179], v8 offset:47104
    ds_read_b64_tr_b16 a[180:181], v9 offset:45056
    ds_read_b64_tr_b16 a[182:183], v9 offset:47104
    ds_read_b64_tr_b16 a[184:185], v10 offset:45056
    ds_read_b64_tr_b16 a[186:187], v10 offset:47104
    ds_read_b64_tr_b16 a[188:189], v11 offset:45056
    ds_read_b64_tr_b16 a[190:191], v11 offset:47104
    ds_read_b64_tr_b16 a[192:193], v8 offset:49152
    ds_read_b64_tr_b16 a[194:195], v8 offset:51200
    ds_read_b64_tr_b16 a[196:197], v9 offset:49152
    ds_read_b64_tr_b16 a[198:199], v9 offset:51200
    ds_read_b64_tr_b16 a[200:201], v10 offset:49152
    ds_read_b64_tr_b16 a[202:203], v10 offset:51200
    ds_read_b64_tr_b16 a[204:205], v11 offset:49152
    ds_read_b64_tr_b16 a[206:207], v11 offset:51200
    ds_read_b64_tr_b16 a[208:209], v8 offset:53248
    ds_read_b64_tr_b16 a[210:211], v8 offset:55296
    ds_read_b64_tr_b16 a[212:213], v9 offset:53248
    ds_read_b64_tr_b16 a[214:215], v9 offset:55296
    ds_read_b64_tr_b16 a[216:217], v10 offset:53248
    ds_read_b64_tr_b16 a[218:219], v10 offset:55296
    ds_read_b64_tr_b16 a[220:221], v11 offset:53248
    ds_read_b64_tr_b16 a[222:223], v11 offset:55296
    s_mov_b32 s66, 0
L_PGL:
    s_add_u32 s66, s66, 1
    s_cmp_gt_u32 s66, 0x40000
    s_cbranch_scc1 L_PGD
L_PGF:
    buffer_load_dword v5, v3, s[48:51], s93 offen sc1
    s_waitcnt vmcnt(0)
    v_cmp_ne_u32 vcc, s59, v5
    s_cbranch_vccnz L_PGL
L_PGD:
    buffer_load_dwordx4 v[16:19], v7, s[48:51], s78 offen offset:0 sc1
    buffer_load_dwordx4 v[20:23], v7, s[48:51], s78 offen offset:1024 sc1
    buffer_load_dwordx4 v[24:27], v7, s[48:51], s78 offen offset:2048 sc1
    buffer_load_dwordx4 v[28:31], v7, s[48:51], s78 offen offset:3072 sc1
    s_add_u32 s78, s78, 4096
    buffer_load_dwordx4 v[32:35], v7, s[48:51], s78 offen offset:0 sc1
    buffer_load_dwordx4 v[36:39], v7, s[48:51], s78 offen offset:1024 sc1
    buffer_load_dwordx4 v[40:43], v7, s[48:51], s78 offen offset:2048 sc1
    buffer_load_dwordx4 v[44:47], v7, s[48:51], s78 offen offset:3072 sc1
    s_add_u32 s78, s78, 4096
    buffer_load_dwordx4 v[48:51], v7, s[48:51], s78 offen offset:0 sc1
    s_barrier
    s_nop 0
    ds_read_b64_tr_b16 a[224:225], v248 offset:0
    ds_read_b64_tr_b16 a[226:227], v248 offset:2048
    ds_read_b64_tr_b16 a[228:229], v249 offset:0
    ds_read_b64_tr_b16 a[230:231], v249 offset:2048
    ds_read_b64_tr_b16 a[232:233], v250 offset:0
    ds_read_b64_tr_b16 a[234:235], v250 offset:2048
    ds_read_b64_tr_b16 a[236:237], v251 offset:0
    ds_read_b64_tr_b16 a[238:239], v251 offset:2048
    ds_read_b64_tr_b16 a[240:241], v248 offset:4096
    ds_read_b64_tr_b16 a[242:243], v248 offset:6144
    ds_read_b64_tr_b16 a[244:245], v249 offset:4096
    ds_read_b64_tr_b16 a[246:247], v249 offset:6144
    ds_read_b64_tr_b16 a[248:249], v250 offset:4096
    ds_read_b64_tr_b16 a[250:251], v250 offset:6144
    ds_read_b64_tr_b16 a[252:253], v251 offset:4096
    ds_read_b64_tr_b16 a[254:255], v251 offset:6144
    v_and_b32_e64 v2, 15, v0
    v_mul_u32_u24 v2, 896, v2
    v_bfe_u32 v3, v0, 4, 1
    v_lshl_add_u32 v2, v3, 5, v2
    v_lshrrev_b32_e64 v3, 5, v0
    v_lshl_add_u32 v2, v3, 4, v2
    s_mul_i32 s60, s72, 14336
    s_add_u32 s60, s60, s61
    v_lshlrev_b32 v224, 16, v240
    v_and_b32 v225, s70, v240
    v_lshlrev_b32 v226, 16, v241
    v_and_b32 v227, s70, v241
    v_lshlrev_b32 v228, 16, v242
    v_and_b32 v229, s70, v242
    v_lshlrev_b32 v230, 16, v243
    v_and_b32 v231, s70, v243
    v_lshlrev_b32 v232, 16, v244
    v_and_b32 v233, s70, v244
    v_lshlrev_b32 v234, 16, v245
    v_and_b32 v235, s70, v245
    v_lshlrev_b32 v236, 16, v246
    v_and_b32 v237, s70, v246
    v_lshlrev_b32 v238, 16, v247
    v_and_b32 v239, s70, v247
    s_waitcnt vmcnt(8)
    v_mfma_f32_16x16x32_bf16 v[192:195], a[0:3], v[16:19], 0
    buffer_load_dwordx4 v[52:55], v7, s[48:51], s78 offen offset:1024 sc1
    ds_read_b64_tr_b16 v[128:129], v248 offset:8192
    v_mfma_f32_16x16x32_bf16 v[196:199], a[4:7], v[16:19], 0
    ds_read_b64_tr_b16 v[130:131], v248 offset:10240
    v_mfma_f32_16x16x32_bf16 v[200:203], a[8:11], v[16:19], 0
    ds_read_b64_tr_b16 v[132:133], v249 offset:8192
    v_mfma_f32_16x16x32_bf16 v[204:207], a[12:15], v[16:19], 0
    ds_read_b64_tr_b16 v[134:135], v249 offset:10240
    s_waitcnt vmcnt(8)
    v_mfma_f32_16x16x32_bf16 v[192:195], a[16:19], v[20:23], v[192:195]
    buffer_load_dwordx4 v[56:59], v7, s[48:51], s78 offen offset:2048 sc1
    ds_read_b64_tr_b16 v[136:137], v250 offset:8192
    v_mfma_f32_16x16x32_bf16 v[196:199], a[20:23], v[20:23], v[196:199]
    ds_read_b64_tr_b16 v[138:139], v250 offset:10240
    v_mfma_f32_16x16x32_bf16 v[200:203], a[24:27], v[20:23], v[200:203]
    ds_read_b64_tr_b16 v[140:141], v251 offset:8192
    v_mfma_f32_16x16x32_bf16 v[204:207], a[28:31], v[20:23], v[204:207]
    ds_read_b64_tr_b16 v[142:143], v251 offset:10240
    s_waitcnt vmcnt(8)
    v_mfma_f32_16x16x32_bf16 v[192:195], a[32:35], v[24:27], v[192:195]
    buffer_load_dwordx4 v[60:63], v7, s[48:51], s78 offen offset:3072 sc1
    s_add_u32 s78, s78, 4096
    ds_read_b64_tr_b16 v[144:145], v248 offset:12288
    v_mfma_f32_16x16x32_bf16 v[196:199], a[36:39], v[24:27], v[196:199]
    ds_read_b64_tr_b16 v[146:147], v248 offset:14336
    v_mfma_f32_16x16x32_bf16 v[200:203], a[40:43], v[24:27], v[200:203]
    ds_read_b64_tr_b16 v[148:149], v249 offset:12288
    v_mfma_f32_16x16x32_bf16 v[204:207], a[44:47], v[24:27], v[204:207]
    ds_read_b64_tr_b16 v[150:151], v249 offset:14336
    s_waitcnt vmcnt(8)
    v_mfma_f32_16x16x32_bf16 v[192:195], a[48:51], v[28:31], v[192:195]
    buffer_load_dwordx4 v[64:67], v7, s[48:51], s78 offen offset:0 sc1
    ds_read_b64_tr_b16 v[152:153], v250 offset:12288
    v_mfma_f32_16x16x32_bf16 v[196:199], a[52:55], v[28:31], v[196:199]
    ds_read_b64_tr_b16 v[154:155], v250 offset:14336
    v_mfma_f32_16x16x32_bf16 v[200:203], a[56:59], v[28:31], v[200:203]
    ds_read_b64_tr_b16 v[156:157], v251 offset:12288
    v_mfma_f32_16x16x32_bf16 v[204:207], a[60:63], v[28:31], v[204:207]
    ds_read_b64_tr_b16 v[158:159], v251 offset:14336
    s_waitcnt vmcnt(8)
    v_mfma_f32_16x16x32_bf16 v[192:195], a[64:67], v[32:35], v[192:195]
    buffer_load_dwordx4 v[68:71], v7, s[48:51], s78 offen offset:1024 sc1
    ds_read_b64_tr_b16 v[160:161], v248 offset:16384
    v_mfma_f32_16x16x32_bf16 v[196:199], a[68:71], v[32:35], v[196:199]
    ds_read_b64_tr_b16 v[162:163], v248 offset:18432
    v_mfma_f32_16x16x32_bf16 v[200:203], a[72:75], v[32:35], v[200:203]
    ds_read_b64_tr_b16 v[164:165], v249 offset:16384
    v_mfma_f32_16x16x32_bf16 v[204:207], a[76:79], v[32:35], v[204:207]
    ds_read_b64_tr_b16 v[166:167], v249 offset:18432
    s_waitcnt vmcnt(8)
    v_mfma_f32_16x16x32_bf16 v[192:195], a[80:83], v[36:39], v[192:195]
    buffer_load_dwordx4 v[72:75], v7, s[48:51], s78 offen offset:2048 sc1
    ds_read_b64_tr_b16 v[168:169], v250 offset:16384
    v_mfma_f32_16x16x32_bf16 v[196:199], a[84:87], v[36:39], v[196:199]
    ds_read_b64_tr_b16 v[170:171], v250 offset:18432
    v_mfma_f32_16x16x32_bf16 v[200:203], a[88:91], v[36:39], v[200:203]
    ds_read_b64_tr_b16 v[172:173], v251 offset:16384
    v_mfma_f32_16x16x32_bf16 v[204:207], a[92:95], v[36:39], v[204:207]
    ds_read_b64_tr_b16 v[174:175], v251 offset:18432
    s_waitcnt vmcnt(8)
    v_mfma_f32_16x16x32_bf16 v[192:195], a[96:99], v[40:43], v[192:195]
    buffer_load_dwordx4 v[76:79], v7, s[48:51], s78 offen offset:3072 sc1
    s_add_u32 s78, s78, 4096
    ds_read_b64_tr_b16 v[176:177], v248 offset:20480
    v_mfma_f32_16x16x32_bf16 v[196:199], a[100:103], v[40:43], v[196:199]
    ds_read_b64_tr_b16 v[178:179], v248 offset:22528
    v_mfma_f32_16x16x32_bf16 v[200:203], a[104:107], v[40:43], v[200:203]
    ds_read_b64_tr_b16 v[180:181], v249 offset:20480
    v_mfma_f32_16x16x32_bf16 v[204:207], a[108:111], v[40:43], v[204:207]
    ds_read_b64_tr_b16 v[182:183], v249 offset:22528
    s_waitcnt vmcnt(8)
    v_mfma_f32_16x16x32_bf16 v[192:195], a[112:115], v[44:47], v[192:195]
    buffer_load_dwordx4 v[80:83], v7, s[48:51], s78 offen offset:0 sc1
    ds_read_b64_tr_b16 v[184:185], v250 offset:20480
    v_mfma_f32_16x16x32_bf16 v[196:199], a[116:119], v[44:47], v[196:199]
    ds_read_b64_tr_b16 v[186:187], v250 offset:22528
    v_mfma_f32_16x16x32_bf16 v[200:203], a[120:123], v[44:47], v[200:203]
    ds_read_b64_tr_b16 v[188:189], v251 offset:20480
    v_mfma_f32_16x16x32_bf16 v[204:207], a[124:127], v[44:47], v[204:207]
    ds_read_b64_tr_b16 v[190:191], v251 offset:22528
    s_waitcnt vmcnt(8)
    v_mfma_f32_16x16x32_bf16 v[192:195], a[128:131], v[48:51], v[192:195]
    buffer_load_dwordx4 v[84:87], v7, s[48:51], s78 offen offset:1024 sc1
    v_mfma_f32_16x16x32_bf16 v[196:199], a[132:135], v[48:51], v[196:199]
    v_mfma_f32_16x16x32_bf16 v[200:203], a[136:139], v[48:51], v[200:203]
    v_mfma_f32_16x16x32_bf16 v[204:207], a[140:143], v[48:51], v[204:207]
    s_waitcnt vmcnt(8)
    v_mfma_f32_16x16x32_bf16 v[192:195], a[144:147], v[52:55], v[192:195]
    buffer_load_dwordx4 v[88:91], v7, s[48:51], s78 offen offset:2048 sc1
    v_mfma_f32_16x16x32_bf16 v[196:199], a[148:151], v[52:55], v[196:199]
    v_mfma_f32_16x16x32_bf16 v[200:203], a[152:155], v[52:55], v[200:203]
    v_mfma_f32_16x16x32_bf16 v[204:207], a[156:159], v[52:55], v[204:207]
    s_waitcnt vmcnt(8)
    v_mfma_f32_16x16x32_bf16 v[192:195], a[160:163], v[56:59], v[192:195]
    buffer_load_dwordx4 v[92:95], v7, s[48:51], s78 offen offset:3072 sc1
    s_add_u32 s78, s78, 4096
    v_mfma_f32_16x16x32_bf16 v[196:199], a[164:167], v[56:59], v[196:199]
    v_mfma_f32_16x16x32_bf16 v[200:203], a[168:171], v[56:59], v[200:203]
    v_mfma_f32_16x16x32_bf16 v[204:207], a[172:175], v[56:59], v[204:207]
    s_waitcnt vmcnt(8) lgkmcnt(2)
    v_mfma_f32_16x16x32_bf16 v[192:195], a[176:179], v[60:63], v[192:195]
    buffer_load_dwordx4 v[96:99], v7, s[48:51], s78 offen offset:0 sc1
    v_mfma_f32_16x16x32_bf16 v[196:199], a[180:183], v[60:63], v[196:199]
    v_mfma_f32_16x16x32_bf16 v[200:203], a[184:187], v[60:63], v[200:203]
    v_mfma_f32_16x16x32_bf16 v[204:207], a[188:191], v[60:63], v[204:207]
    s_waitcnt vmcnt(8)
    v_mfma_f32_16x16x32_bf16 v[192:195], a[192:195], v[64:67], v[192:195]
    buffer_load_dwordx4 v[100:103], v7, s[48:51], s78 offen offset:1024 sc1
    v_mfma_f32_16x16x32_bf16 v[196:199], a[196:199], v[64:67], v[196:199]
    v_mfma_f32_16x16x32_bf16 v[200:203], a[200:203], v[64:67], v[200:203]
    v_mfma_f32_16x16x32_bf16 v[204:207], a[204:207], v[64:67], v[204:207]
    s_waitcnt vmcnt(8)
    v_mfma_f32_16x16x32_bf16 v[192:195], a[208:211], v[68:71], v[192:195]
    buffer_load_dwordx4 v[104:107], v7, s[48:51], s78 offen offset:2048 sc1
    v_mfma_f32_16x16x32_bf16 v[196:199], a[212:215], v[68:71], v[196:199]
    v_mfma_f32_16x16x32_bf16 v[200:203], a[216:219], v[68:71], v[200:203]
    v_mfma_f32_16x16x32_bf16 v[204:207], a[220:223], v[68:71], v[204:207]
    s_waitcnt vmcnt(8)
    v_mfma_f32_16x16x32_bf16 v[192:195], a[224:227], v[72:75], v[192:195]
    buffer_load_dwordx4 v[108:111], v7, s[48:51], s78 offen offset:3072 sc1
    s_add_u32 s78, s78, 4096
    v_mfma_f32_16x16x32_bf16 v[196:199], a[228:231], v[72:75], v[196:199]
    v_mfma_f32_16x16x32_bf16 v[200:203], a[232:235], v[72:75], v[200:203]
    v_mfma_f32_16x16x32_bf16 v[204:207], a[236:239], v[72:75], v[204:207]
    s_waitcnt vmcnt(8)
    v_mfma_f32_16x16x32_bf16 v[192:195], a[240:243], v[76:79], v[192:195]
    buffer_load_dwordx4 v[112:115], v7, s[48:51], s78 offen offset:0 sc1
    v_mfma_f32_16x16x32_bf16 v[196:199], a[244:247], v[76:79], v[196:199]
    v_mfma_f32_16x16x32_bf16 v[200:203], a[248:251], v[76:79], v[200:203]
    v_mfma_f32_16x16x32_bf16 v[204:207], a[252:255], v[76:79], v[204:207]
    s_waitcnt vmcnt(8)
    v_mfma_f32_16x16x32_bf16 v[192:195], v[128:131], v[80:83], v[192:195]
    buffer_load_dwordx4 v[116:119], v7, s[48:51], s78 offen offset:1024 sc1
    v_mfma_f32_16x16x32_bf16 v[196:199], v[132:135], v[80:83], v[196:199]
    v_mfma_f32_16x16x32_bf16 v[200:203], v[136:139], v[80:83], v[200:203]
    v_mfma_f32_16x16x32_bf16 v[204:207], v[140:143], v[80:83], v[204:207]
    s_waitcnt vmcnt(8)
    v_mfma_f32_16x16x32_bf16 v[192:195], v[144:147], v[84:87], v[192:195]
    buffer_load_dwordx4 v[120:123], v7, s[48:51], s78 offen offset:2048 sc1
    ds_read_b64_tr_b16 v[128:129], v248 offset:24576
    ds_read_b64_tr_b16 v[130:131], v248 offset:26624
    v_mfma_f32_16x16x32_bf16 v[196:199], v[148:151], v[84:87], v[196:199]
    ds_read_b64_tr_b16 v[132:133], v249 offset:24576
    ds_read_b64_tr_b16 v[134:135], v249 offset:26624
    v_mfma_f32_16x16x32_bf16 v[200:203], v[152:155], v[84:87], v[200:203]
    ds_read_b64_tr_b16 v[136:137], v250 offset:24576
    ds_read_b64_tr_b16 v[138:139], v250 offset:26624
    v_mfma_f32_16x16x32_bf16 v[204:207], v[156:159], v[84:87], v[204:207]
    ds_read_b64_tr_b16 v[140:141], v251 offset:24576
    ds_read_b64_tr_b16 v[142:143], v251 offset:26624
    s_waitcnt vmcnt(8)
    v_mfma_f32_16x16x32_bf16 v[192:195], v[160:163], v[88:91], v[192:195]
    buffer_load_dwordx4 v[124:127], v7, s[48:51], s78 offen offset:3072 sc1
    ds_read_b64_tr_b16 v[144:145], v248 offset:28672
    ds_read_b64_tr_b16 v[146:147], v248 offset:30720
    v_mfma_f32_16x16x32_bf16 v[196:199], v[164:167], v[88:91], v[196:199]
    ds_read_b64_tr_b16 v[148:149], v249 offset:28672
    ds_read_b64_tr_b16 v[150:151], v249 offset:30720
    v_mfma_f32_16x16x32_bf16 v[200:203], v[168:171], v[88:91], v[200:203]
    ds_read_b64_tr_b16 v[152:153], v250 offset:28672
    ds_read_b64_tr_b16 v[154:155], v250 offset:30720
    v_mfma_f32_16x16x32_bf16 v[204:207], v[172:175], v[88:91], v[204:207]
    ds_read_b64_tr_b16 v[156:157], v251 offset:28672
    ds_read_b64_tr_b16 v[158:159], v251 offset:30720
    s_waitcnt vmcnt(8)
    v_mfma_f32_16x16x32_bf16 v[192:195], v[176:179], v[92:95], v[192:195]
    ds_read_b64_tr_b16 v[160:161], v248 offset:32768
    ds_read_b64_tr_b16 v[162:163], v248 offset:34816
    v_mfma_f32_16x16x32_bf16 v[196:199], v[180:183], v[92:95], v[196:199]
    ds_read_b64_tr_b16 v[164:165], v249 offset:32768
    ds_read_b64_tr_b16 v[166:167], v249 offset:34816
    v_mfma_f32_16x16x32_bf16 v[200:203], v[184:187], v[92:95], v[200:203]
    ds_read_b64_tr_b16 v[168:169], v250 offset:32768
    ds_read_b64_tr_b16 v[170:171], v250 offset:34816
    s_waitcnt lgkmcnt(14)
    v_mfma_f32_16x16x32_bf16 v[204:207], v[188:191], v[92:95], v[204:207]
    ds_read_b64_tr_b16 v[172:173], v251 offset:32768
    ds_read_b64_tr_b16 v[174:175], v251 offset:34816
    s_waitcnt vmcnt(7)
    v_mfma_f32_16x16x32_bf16 v[192:195], v[128:131], v[96:99], v[192:195]
    ds_read_b64_tr_b16 v[176:177], v248 offset:36864
    ds_read_b64_tr_b16 v[178:179], v248 offset:38912
    v_mfma_f32_16x16x32_bf16 v[196:199], v[132:135], v[96:99], v[196:199]
    ds_read_b64_tr_b16 v[180:181], v249 offset:36864
    ds_read_b64_tr_b16 v[182:183], v249 offset:38912
    v_mfma_f32_16x16x32_bf16 v[200:203], v[136:139], v[96:99], v[200:203]
    ds_read_b64_tr_b16 v[184:185], v250 offset:36864
    ds_read_b64_tr_b16 v[186:187], v250 offset:38912
    v_mfma_f32_16x16x32_bf16 v[204:207], v[140:143], v[96:99], v[204:207]
    ds_read_b64_tr_b16 v[188:189], v251 offset:36864
    ds_read_b64_tr_b16 v[190:191], v251 offset:38912
    s_waitcnt vmcnt(6) lgkmcnt(14)
    v_mfma_f32_16x16x32_bf16 v[192:195], v[144:147], v[100:103], v[192:195]
    ds_read_b64_tr_b16 v[128:129], v248 offset:40960
    ds_read_b64_tr_b16 v[130:131], v248 offset:43008
    v_mfma_f32_16x16x32_bf16 v[196:199], v[148:151], v[100:103], v[196:199]
    ds_read_b64_tr_b16 v[132:133], v249 offset:40960
    ds_read_b64_tr_b16 v[134:135], v249 offset:43008
    v_mfma_f32_16x16x32_bf16 v[200:203], v[152:155], v[100:103], v[200:203]
    ds_read_b64_tr_b16 v[136:137], v250 offset:40960
    ds_read_b64_tr_b16 v[138:139], v250 offset:43008
    v_mfma_f32_16x16x32_bf16 v[204:207], v[156:159], v[100:103], v[204:207]
    ds_read_b64_tr_b16 v[140:141], v251 offset:40960
    ds_read_b64_tr_b16 v[142:143], v251 offset:43008
    s_waitcnt vmcnt(5)
    v_mfma_f32_16x16x32_bf16 v[192:195], v[160:163], v[104:107], v[192:195]
    ds_read_b64_tr_b16 v[144:145], v248 offset:45056
    ds_read_b64_tr_b16 v[146:147], v248 offset:47104
    s_waitcnt lgkmcnt(14)
    v_mfma_f32_16x16x32_bf16 v[196:199], v[164:167], v[104:107], v[196:199]
    ds_read_b64_tr_b16 v[148:149], v249 offset:45056
    ds_read_b64_tr_b16 v[150:151], v249 offset:47104
    v_mfma_f32_16x16x32_bf16 v[200:203], v[168:171], v[104:107], v[200:203]
    ds_read_b64_tr_b16 v[152:153], v250 offset:45056
    ds_read_b64_tr_b16 v[154:155], v250 offset:47104
    v_mfma_f32_16x16x32_bf16 v[204:207], v[172:175], v[104:107], v[204:207]
    ds_read_b64_tr_b16 v[156:157], v251 offset:45056
    ds_read_b64_tr_b16 v[158:159], v251 offset:47104
    s_waitcnt vmcnt(4)
    v_mfma_f32_16x16x32_bf16 v[192:195], v[176:179], v[108:111], v[192:195]
    ds_read_b64_tr_b16 v[160:161], v248 offset:49152
    ds_read_b64_tr_b16 v[162:163], v248 offset:51200
    v_mfma_f32_16x16x32_bf16 v[196:199], v[180:183], v[108:111], v[196:199]
    ds_read_b64_tr_b16 v[164:165], v249 offset:49152
    ds_read_b64_tr_b16 v[166:167], v249 offset:51200
    s_waitcnt lgkmcnt(14)
    v_mfma_f32_16x16x32_bf16 v[200:203], v[184:187], v[108:111], v[200:203]
    ds_read_b64_tr_b16 v[168:169], v250 offset:49152
    ds_read_b64_tr_b16 v[170:171], v250 offset:51200
    v_mfma_f32_16x16x32_bf16 v[204:207], v[188:191], v[108:111], v[204:207]
    ds_read_b64_tr_b16 v[172:173], v251 offset:49152
    ds_read_b64_tr_b16 v[174:175], v251 offset:51200
    s_waitcnt vmcnt(3)
    v_mfma_f32_16x16x32_bf16 v[192:195], v[128:131], v[112:115], v[192:195]
    ds_read_b64_tr_b16 v[176:177], v248 offset:53248
    ds_read_b64_tr_b16 v[178:179], v248 offset:55296
    v_mfma_f32_16x16x32_bf16 v[196:199], v[132:135], v[112:115], v[196:199]
    ds_read_b64_tr_b16 v[180:181], v249 offset:53248
    ds_read_b64_tr_b16 v[182:183], v249 offset:55296
    v_mfma_f32_16x16x32_bf16 v[200:203], v[136:139], v[112:115], v[200:203]
    ds_read_b64_tr_b16 v[184:185], v250 offset:53248
    ds_read_b64_tr_b16 v[186:187], v250 offset:55296
    s_waitcnt lgkmcnt(14)
    v_mfma_f32_16x16x32_bf16 v[204:207], v[140:143], v[112:115], v[204:207]
    ds_read_b64_tr_b16 v[188:189], v251 offset:53248
    ds_read_b64_tr_b16 v[190:191], v251 offset:55296
    s_waitcnt vmcnt(2)
    v_mfma_f32_16x16x32_bf16 v[192:195], v[144:147], v[116:119], v[192:195]
    v_mfma_f32_16x16x32_bf16 v[196:199], v[148:151], v[116:119], v[196:199]
    v_mfma_f32_16x16x32_bf16 v[200:203], v[152:155], v[116:119], v[200:203]
    v_mfma_f32_16x16x32_bf16 v[204:207], v[156:159], v[116:119], v[204:207]
    s_waitcnt vmcnt(1) lgkmcnt(11)
    v_mfma_f32_16x16x32_bf16 v[192:195], v[160:163], v[120:123], v[192:195]
    v_mfma_f32_16x16x32_bf16 v[196:199], v[164:167], v[120:123], v[196:199]
    s_waitcnt lgkmcnt(9)
    v_mfma_f32_16x16x32_bf16 v[200:203], v[168:171], v[120:123], v[200:203]
    s_waitcnt lgkmcnt(8)
    v_mfma_f32_16x16x32_bf16 v[204:207], v[172:175], v[120:123], v[204:207]
    s_waitcnt vmcnt(0) lgkmcnt(6)
    v_mfma_f32_16x16x32_bf16 v[192:195], v[176:179], v[124:127], v[192:195]
    s_waitcnt lgkmcnt(4)
    v_mfma_f32_16x16x32_bf16 v[196:199], v[180:183], v[124:127], v[196:199]
    s_waitcnt lgkmcnt(2)
    v_mfma_f32_16x16x32_bf16 v[200:203], v[184:187], v[124:127], v[200:203]
    s_waitcnt lgkmcnt(0)
    v_mfma_f32_16x16x32_bf16 v[204:207], v[188:191], v[124:127], v[204:207]
    s_nop 1
    s_nop 0
    v_pk_fma_f32 v[224:225], v[192:193], v[208:209], v[224:225]
    v_pk_fma_f32 v[226:227], v[194:195], v[210:211], v[226:227]
    v_pk_fma_f32 v[228:229], v[196:197], v[212:213], v[228:229]
    v_pk_fma_f32 v[230:231], v[198:199], v[214:215], v[230:231]
    v_cvt_pk_bf16_f32 v16, v224, v225
    v_cvt_pk_bf16_f32 v18, v228, v229
    v_cvt_pk_bf16_f32 v17, v226, v227
    v_cvt_pk_bf16_f32 v19, v230, v231
    v_permlane16_swap_b32 v16, v18
    s_nop 0
    v_permlane16_swap_b32_e64 v17, v19
    buffer_store_dwordx4 v[16:19], v2, s[44:47], s60 offen offset:0 sc1
    v_pk_fma_f32 v[232:233], v[200:201], v[216:217], v[232:233]
    v_pk_fma_f32 v[234:235], v[202:203], v[218:219], v[234:235]
    v_pk_fma_f32 v[236:237], v[204:205], v[220:221], v[236:237]
    v_pk_fma_f32 v[238:239], v[206:207], v[222:223], v[238:239]
    v_cvt_pk_bf16_f32 v20, v232, v233
    v_cvt_pk_bf16_f32 v22, v236, v237
    v_cvt_pk_bf16_f32 v21, v234, v235
    v_cvt_pk_bf16_f32 v23, v238, v239
    v_permlane16_swap_b32 v20, v22
    s_nop 0
    v_permlane16_swap_b32_e64 v21, v23
    buffer_store_dwordx4 v[20:23], v2, s[44:47], s60 offen offset:64 sc1
SK_61:
    s_or_b32 s60, s2, s52
    s_cmp_eq_u32 s60, 0
    s_cbranch_scc0 SK_62
    v_mov_b32 v2, s59
    s_mov_b64 exec, 1
    buffer_store_dword v2, off, s[48:51], 0 sc1
    s_mov_b64 exec, -1
SK_62:
L_END:
L_EXIT:
    s_endpgm
L_PX0:
    s_mov_b32 s66, 0
L_PX0L:
    s_add_u32 s66, s66, 1
    s_cmp_gt_u32 s66, 0x40000
    s_cbranch_scc1 L_PX0D
L_PX0F:
    buffer_load_dwordx2 v[240:241], v6, s[48:51], s63 offen sc1
    s_waitcnt vmcnt(0)
    v_cmp_ne_u32 s[64:65], s59, v241
    s_nop 0
    s_cmp_eq_u64 s[64:65], 0
    s_cbranch_scc0 L_PX0L
    s_branch L_PX0D
L_PMS:
    s_mov_b32 s66, 0
L_PMSL:
    s_add_u32 s66, s66, 1
    s_cmp_gt_u32 s66, 0x40000
    s_cbranch_scc1 L_PMSD
L_PMSF:
    buffer_load_dwordx4 v[32:35], v240, s[48:51], s73 offen sc1
    buffer_load_dwordx4 v[36:39], v241, s[48:51], s73 offen sc1
    s_waitcnt vmcnt(0)
    v_xor_b32 v34, s59, v34
    v_bitop3_b32 v34, v34, v38, s59 bitop3:0xf6
    v_cmp_ne_u32 s[64:65], 0, v34
    s_nop 0
    s_cmp_eq_u64 s[64:65], 0
    s_cbranch_scc0 L_PMSL
    s_branch L_PMSD
L_PM:
    s_mov_b32 s66, 0
L_PML:
    s_add_u32 s66, s66, 1
    s_cmp_gt_u32 s66, 0x40000
    s_cbranch_scc1 L_PMD
L_PMF:
    buffer_load_dwordx4 v[32:35], v240, s[48:51], s73 offen sc1
    buffer_load_dwordx4 v[36:39], v241, s[48:51], s73 offen sc1
    s_waitcnt vmcnt(0)
    v_xor_b32_e64 v34, s59, v34
    v_bitop3_b32 v34, v34, v38, s59 bitop3:0xf6
    v_cmp_ne_u32 s[64:65], 0, v34
    s_nop 0
    s_cmp_eq_u64 s[64:65], 0
    s_cbranch_scc0 L_PML
    s_branch L_PMD
L_PU:
    s_mov_b32 s66, 0
L_PUL:
    s_add_u32 s66, s66, 1
    s_cmp_gt_u32 s66, 0x40000
    s_cbranch_scc1 L_PUD
L_PUF:
    buffer_load_dwordx4 v[168:171], v12, s[48:51], s60 offen sc1
    s_waitcnt vmcnt(0)
    v_cmp_ne_u32 vcc, s59, v171
    s_cbranch_vccnz L_PUL
    s_branch L_PUD
L_PE:
    s_mov_b32 s66, 0
L_PEL:
    s_add_u32 s66, s66, 1
    s_cmp_gt_u32 s66, 0x40000
    s_cbranch_scc1 L_PED
L_PEF:
    buffer_load_dwordx4 v[24:27], v7, s[48:51], s73 offen offset:0 sc1
    buffer_load_dwordx4 v[28:31], v7, s[48:51], s73 offen offset:1024 sc1
    buffer_load_dwordx4 v[32:35], v7, s[48:51], s73 offen offset:2048 sc1
    buffer_load_dwordx4 v[36:39], v7, s[48:51], s73 offen offset:3072 sc1
    buffer_load_dwordx4 v[40:43], v7, s[48:51], s77 offen offset:0 sc1
    buffer_load_dwordx4 v[44:47], v7, s[48:51], s77 offen offset:1024 sc1
    buffer_load_dwordx4 v[48:51], v7, s[48:51], s77 offen offset:2048 sc1
    s_waitcnt vmcnt(0)
    v_xor_b32 v26, s59, v26
    v_bitop3_b32 v26, v26, v30, s59 bitop3:0xf6
    v_bitop3_b32 v26, v26, v34, s59 bitop3:0xf6
    v_bitop3_b32 v26, v26, v38, s59 bitop3:0xf6
    v_bitop3_b32 v26, v26, v42, s59 bitop3:0xf6
    v_bitop3_b32 v26, v26, v46, s59 bitop3:0xf6
    v_bitop3_b32 v26, v26, v50, s59 bitop3:0xf6
    v_cmp_ne_u32_e64 vcc, 0, v26
    s_cbranch_vccnz L_PEL
    s_branch L_PED
L_PZ:
    s_mov_b32 s66, 0
L_PZL:
    s_add_u32 s66, s66, 1
    s_cmp_gt_u32 s66, 0x40000
    s_cbranch_scc1 L_PZD
L_PZF:
    buffer_load_dword v13, v12, s[48:51], s92 offen sc1
    s_waitcnt vmcnt(0)
    v_cmp_ne_u32 vcc, s59, v13
    s_cbranch_vccnz L_PZL
    s_branch L_PZD
L_PM1:
    s_mov_b32 s66, 0
L_PM1L:
    s_add_u32 s66, s66, 1
    s_cmp_gt_u32 s66, 0x40000
    s_cbranch_scc1 L_PM1D
L_PM1F:
    buffer_load_dwordx4 v[84:87], v7, s[48:51], s85 offen offset:0 sc1
    buffer_load_dwordx4 v[88:91], v7, s[48:51], s85 offen offset:1024 sc1
    s_waitcnt vmcnt(0)
    v_xor_b32 v87, s84, v87
    v_bitop3_b32 v87, v87, v91, s84 bitop3:0xf6
    v_cmp_ne_u32_e64 vcc, 0, v87
    s_cbranch_vccnz L_PM1L
    s_branch L_PM1D
L_PM2:
    s_mov_b32 s66, 0
L_PM2L:
    s_add_u32 s66, s66, 1
    s_cmp_gt_u32 s66, 0x40000
    s_cbranch_scc1 L_PM2D
L_PM2F:
    buffer_load_dwordx4 v[92:95], v7, s[48:51], s85 offen offset:2048 sc1
    s_waitcnt vmcnt(0)
    v_cmp_ne_u32 vcc, s84, v95
    s_cbranch_vccnz L_PM2L
    s_branch L_PM2D
L_PM4:
    s_mov_b32 s66, 0
L_PM4L:
    s_add_u32 s66, s66, 1
    s_cmp_gt_u32 s66, 0x40000
    s_cbranch_scc1 L_PM4D
L_PM4F:
    buffer_load_dwordx4 v[96:99], v7, s[48:51], s82 offen sc1
    s_waitcnt vmcnt(0)
    v_cmp_ne_u32 vcc, s84, v99
    s_cbranch_vccnz L_PM4L
    s_branch L_PM4D
WT_3:
    s_waitcnt vmcnt(0) lgkmcnt(0)
    s_nop 15
    buffer_store_dwordx4 v[96:99], v131, s[48:51], s77 offen sc1
    s_nop 1
    s_branch WB_4
WT_5:
    s_waitcnt vmcnt(0) lgkmcnt(0)
    s_nop 15
    buffer_store_dwordx4 v[104:107], v131, s[48:51], s78 offen sc1
    s_nop 1
    s_branch WB_6
WT_7:
    s_waitcnt vmcnt(0) lgkmcnt(0)
    s_nop 15
    buffer_store_dwordx4 v[112:115], v131, s[48:51], s79 offen sc1
    s_nop 1
    s_branch WB_8
WT_9:
    s_waitcnt vmcnt(0) lgkmcnt(0)
    s_nop 15
    buffer_store_dwordx4 v[120:123], v131, s[48:51], s80 offen sc1
    s_nop 1
    s_branch WB_10
WT_16:
    s_waitcnt vmcnt(0) lgkmcnt(0)
    s_nop 15
    buffer_store_dword v5, off, s[48:51], s60 sc1
    s_nop 1
    s_branch WB_17
WT_23:
    s_waitcnt vmcnt(0) lgkmcnt(0)
    s_nop 15
    buffer_store_dwordx4 v[184:187], v246, s[48:51], s79 offen offset:0 sc1
    buffer_store_dwordx4 v[188:191], v246, s[48:51], s79 offen offset:512 sc1
    s_nop 1
    s_branch WB_24
WT_27:
    s_waitcnt vmcnt(0) lgkmcnt(0)
    s_nop 15
    buffer_store_dword v5, off, s[48:51], s80 sc1
    s_nop 1
    s_branch WB_28
WT_31:
    s_waitcnt vmcnt(0) lgkmcnt(0)
    s_nop 15
    buffer_store_dword v5, off, s[48:51], s80 sc1
    s_nop 1
    s_branch WB_32
WT_33:
    s_waitcnt vmcnt(0) lgkmcnt(0)
    s_nop 15
    buffer_store_dwordx4 v[64:67], v7, s[48:51], s60 offen offset:0 sc1
    buffer_store_dwordx4 v[68:71], v7, s[48:51], s60 offen offset:1024 sc1
    s_nop 1
    s_branch WB_34
WT_35:
    s_waitcnt vmcnt(0) lgkmcnt(0)
    s_nop 15
    buffer_store_dword v72, v3, s[48:51], s63 offen sc1
    s_nop 1
    s_branch WB_36
WT_38:
    s_waitcnt vmcnt(0) lgkmcnt(0)
    s_nop 15
    buffer_store_dword v2, off, s[48:51], s64 sc1
    s_nop 1
    s_branch WB_39
WT_40:
    s_waitcnt vmcnt(0) lgkmcnt(0)
    s_nop 15
    buffer_store_dwordx4 v[216:219], v7, s[48:51], s74 offen sc1
    s_nop 1
    s_branch WB_41
WT_44:
    s_waitcnt vmcnt(0) lgkmcnt(0)
    s_nop 15
    buffer_store_dwordx4 v[200:203], v7, s[48:51], s98 offen offset:0 sc1
    buffer_store_dwordx4 v[204:207], v7, s[48:51], s99 offen offset:0 sc1
    s_nop 1
    s_branch WB_45
WT_46:
    s_waitcnt vmcnt(0) lgkmcnt(0)
    s_nop 15
    buffer_store_dwordx4 v[216:219], v7, s[48:51], s98 offen offset:1024 sc1
    buffer_store_dwordx4 v[220:223], v7, s[48:51], s99 offen offset:1024 sc1
    s_nop 1
    s_branch WB_47
WT_50:
    s_waitcnt vmcnt(0) lgkmcnt(0)
    s_nop 15
    buffer_store_dword v2, off, s[48:51], s83 sc1
    s_nop 1
    s_branch WB_51
WT_52:
    s_waitcnt vmcnt(0) lgkmcnt(0)
    s_nop 15
    buffer_store_dwordx4 v[112:115], v7, s[48:51], s75 offen offset:0 sc1
    buffer_store_dwordx4 v[116:119], v7, s[48:51], s75 offen offset:1024 sc1
    s_nop 1
    s_branch WB_53
WT_54:
    s_waitcnt vmcnt(0) lgkmcnt(0)
    s_nop 15
    buffer_store_dwordx4 v[120:123], v7, s[48:51], s75 offen offset:2048 sc1
    s_nop 1
    s_branch WB_55
WT_56:
    s_waitcnt vmcnt(0) lgkmcnt(0)
    s_nop 15
    buffer_store_dwordx2 v[124:125], v7, s[48:51], s76 offen sc1
    s_nop 1
    s_branch WB_57
WT_59:
    s_waitcnt vmcnt(0) lgkmcnt(0)
    s_nop 15
    buffer_store_dword v2, off, s[48:51], s62 sc1
    s_nop 1
    s_branch WB_60
L_CODE_END:
.section .rodata,"a"
.p2align 6
.amdhsa_kernel adaLN_cond__linear_kernel_hedgehog__mixer_gmlp__prompt_kernel
  .amdhsa_next_free_vgpr 512
  .amdhsa_next_free_sgpr 102
  .amdhsa_accum_offset 256
  .amdhsa_group_segment_fixed_size 0
  .amdhsa_kernarg_size 112
  .amdhsa_user_sgpr_count 2
  .amdhsa_user_sgpr_kernarg_segment_ptr 1
  .amdhsa_system_sgpr_workgroup_id_x 1
  .amdhsa_float_denorm_mode_32 3
.end_amdhsa_kernel
```
